```python
import torch

def _softmax(x, axis=-1):
    return torch.softmax(x, dim=axis)

def _gelu(x):
    return torch.nn.functional.gelu(x, approximate='tanh')

def _silu(x):
    return torch.nn.functional.silu(x)

def _sigmoid(x):
    return torch.sigmoid(x)

def _layernorm(x, axis=-1, eps=1e-05):
    m = x.mean(dim=axis, keepdim=True)
    v = x.var(dim=axis, keepdim=True, unbiased=False)
    return (x - m) / torch.sqrt(v + eps)

def _scatter_add(tgt, idx, src, axis=0):
    return tgt.clone().index_add_(axis, idx, src)

def _segment_sum(src, seg, n):
    out = torch.zeros((n,) + src.shape[1:], dtype=src.dtype)
    return out.index_add_(0, seg, src)

def _pad(x, pw):
    flat = tuple((v for pair in reversed(pw) for v in pair))
    return torch.nn.functional.pad(x, flat)
kernel_name = 'gated_mix__memory_aug_recurrent_mem_tr__dense_activation_squared_relu__prompt'

def setup_inputs():

    _w = lambda a: (lambda t: t.to(torch.bfloat16) if t.is_floating_point() else t)(torch.as_tensor(a))

    def _A_setup():
        B, S, Dm = (1, 2048, 512)
        H, Dh = (32, 128)
        M, seg = (8, 32)
        seg = min(seg, S)
        S = S // seg * seg
        return {'x': _w((lambda *s: torch.randn(*s, dtype=torch.bfloat16) * 0.05)(B, S, Dm)), 'mem0': _w((lambda *s: torch.randn(*s, dtype=torch.bfloat16) * 0.8)(B, M, Dm)), 'Wq': _w((lambda *s: torch.randn(*s, dtype=torch.bfloat16) * 1.6)(Dm, H, Dh) * Dm ** (-0.5)), 'Wk': _w((lambda *s: torch.randn(*s, dtype=torch.bfloat16) * 1.6)(Dm, H, Dh) * Dm ** (-0.5)), 'Wv': _w((lambda *s: torch.randn(*s, dtype=torch.bfloat16) * 0.8)(Dm, H, Dh) * Dm ** (-0.5)), 'Wo': _w((lambda *s: torch.randn(*s, dtype=torch.bfloat16) * 0.8)(H, Dh, Dm) * (H * Dh) ** (-0.5)), 'seg_len': seg}
    _A_in = _A_setup()

    def _B_setup():
        B, S, D, F = (1, 2048, 512, 1792)
        return {'x': _w((lambda *s: torch.randn(*s, dtype=torch.bfloat16) * 0.05)(B, S, D)), 'w1': _w((lambda *s: torch.randn(*s, dtype=torch.bfloat16) * 0.05)(D, F)), 'b1': _w((lambda *s: torch.randn(*s, dtype=torch.bfloat16) * 0.1)(F)), 'w2': _w((lambda *s: torch.randn(*s, dtype=torch.bfloat16) * 0.05)(F, D)), 'b2': _w((lambda *s: torch.randn(*s, dtype=torch.bfloat16) * 0.05)(D))}
    _B_in = _B_setup()
    return {'A_x': _A_in['x'], 'A_mem0': _A_in['mem0'], 'A_Wq': _A_in['Wq'], 'A_Wk': _A_in['Wk'], 'A_Wv': _A_in['Wv'], 'A_Wo': _A_in['Wo'], 'A_seg_len': _A_in['seg_len'], 'B_x': _B_in['x'], 'B_w1': _B_in['w1'], 'B_b1': _B_in['b1'], 'B_w2': _B_in['w2'], 'B_b2': _B_in['b2'], 'gate_w': _w((lambda *s: torch.randn(*s, dtype=torch.bfloat16) * 0.05)(512) * 16.0)}

def reference(A_x, A_mem0, A_Wq, A_Wk, A_Wv, A_Wo, A_seg_len, B_x, B_w1, B_b1, B_w2, B_b2, gate_w):

    def _A_ref(x, mem0, Wq, Wk, Wv, Wo, seg_len):
        B, S, Dm = x.shape
        H, Dh = (Wq.shape[1], Wq.shape[2])
        M = mem0.shape[1]
        scale = Dh ** (-0.5)
        n_seg = S // seg_len
        L = M + seg_len
        idx = torch.arange(L)
        mask = (idx[:, None] < M) | (idx[:, None] >= idx[None, :])
        mem = mem0
        outs = []
        for s in range(n_seg):
            xs = x[:, s * seg_len:(s + 1) * seg_len, :].clone()
            h = torch.concatenate([mem, xs], axis=1)
            q = torch.einsum('btd,dhe->bhte', h, Wq)
            k = torch.einsum('btd,dhe->bhte', h, Wk)
            v = torch.einsum('btd,dhe->bhte', h, Wv)
            scores = torch.einsum('bhqe,bhke->bhqk', q, k) * scale
            scores = torch.where(mask[None, None], scores, -1000000000.0)
            p = _softmax(scores, axis=-1)
            o = torch.einsum('bhqk,bhke->bhqe', p, v)
            o = torch.einsum('bhte,hed->btd', o, Wo)
            mem = o[:, :M, :].clone()
            outs.append(o[:, M:, :])
        return torch.concatenate(outs, axis=1)

    def _B_ref(x, w1, b1, w2, b2):
        h = torch.einsum('bsd,df->bsf', x, w1) + b1
        zero = torch.zeros_like(h)
        r = torch.where(h > zero, h, zero)
        h = r * r
        out = torch.einsum('bsf,fd->bsd', h, w2) + b2
        return out
    x = A_x
    g = _sigmoid((x * gate_w).sum(-1, keepdims=True))
    a = _A_ref(x, A_mem0, A_Wq, A_Wk, A_Wv, A_Wo, A_seg_len)
    b = _B_ref(x, B_w1, B_b1, B_w2, B_b2)
    return g * a + (1 - g) * b
```

```asm
; @launch grid=(256,1,1) block=(256,1,1) lds=163840
.amdgcn_target "amdgcn-amd-amdhsa--gfx950"
.text
.globl gated_mix__memory_aug_recurrent_mem_tr__dense_activation_squared_relu__prompt_kernel
.p2align 8
.type gated_mix__memory_aug_recurrent_mem_tr__dense_activation_squared_relu__prompt_kernel,@function
gated_mix__memory_aug_recurrent_mem_tr__dense_activation_squared_relu__prompt_kernel:
    s_cmp_ge_u32 s2, 256
    s_cbranch_scc1 L_end
    s_load_dwordx2 s[4:5], s[0:1], 120
    s_load_dwordx2 s[8:9], s[0:1], 112
    s_load_dwordx8 s[40:47], s[0:1], 16
    s_getreg_b32 s3, hwreg(HW_REG_XCC_ID)
    s_and_b32 s3, s3, 7
    v_lshrrev_b32 v1, 6, v0
    s_mov_b32 s6, 268435456
    s_mov_b32 s7, 0x20000
    s_mov_b32 s10, 256
    s_mov_b32 s11, 0x20000
    v_readfirstlane_b32 s16, v1
    s_waitcnt lgkmcnt(0)
    s_cmp_lg_u32 s16, 0
    s_cbranch_scc1 L_mg_noat
    s_lshl_b32 s18, s3, 2
    s_cmp_eq_u32 s3, 0
    s_cselect_b32 s18, 128, s18
    v_mov_b32 v2, s18
    v_mov_b32 v3, 1
    s_mov_b64 exec, 1
    buffer_atomic_add v3, v2, s[8:11], 0 offen sc0
    s_mov_b64 exec, -1
L_mg_noat:
    s_cmp_lg_u32 s16, 0
    s_cbranch_scc1 L_mg_norank
    s_cmp_eq_u32 s3, 0
    s_cbranch_scc1 L_mg_w0
    s_waitcnt vmcnt(0)
    s_branch L_mg_w1
L_mg_w0:
    s_waitcnt vmcnt(0)
L_mg_w1:
    v_readfirstlane_b32 s18, v3
    v_lshlrev_b32 v2, 13, v0
    s_nop 0
    v_mov_b32 v3, s18
    s_mov_b64 exec, 15
    ds_write_b32 v2, v3
    s_mov_b64 exec, -1
    s_waitcnt lgkmcnt(0)
L_mg_norank:
    s_barrier
    v_lshrrev_b32 v2, 6, v0
    v_lshlrev_b32 v2, 13, v2
    ds_read_b32 v3, v2
    s_waitcnt lgkmcnt(0)
    v_readfirstlane_b32 s18, v3
    s_nop 3
    s_cmp_ge_u32 s18, 32
    s_cbranch_scc1 L_end
    s_cmp_lg_u32 s3, 0
    s_cbranch_scc1 L_worker
    s_mov_b32 s17, s18
    s_load_dwordx2 s[52:53], s[0:1], 16
    s_load_dwordx2 s[56:57], s[0:1], 24
    s_load_dwordx2 s[60:61], s[0:1], 32
    s_load_dwordx2 s[64:65], s[0:1], 40
    s_load_dwordx2 s[68:69], s[0:1], 8
    s_mov_b32 s54, 0x400000
    s_mov_b32 s55, 0x20000
    s_mov_b32 s58, 0x400000
    s_mov_b32 s59, 0x20000
    s_mov_b32 s62, 0x400000
    s_mov_b32 s63, 0x20000
    s_mov_b32 s66, 0x400000
    s_mov_b32 s67, 0x20000
    s_mov_b32 s70, 8192
    s_mov_b32 s71, 0x20000
    s_waitcnt lgkmcnt(0)
    v_and_b32 v127, 63, v0
    v_and_b32 v126, 15, v127
    v_lshrrev_b32 v125, 4, v127
    v_lshlrev_b32 v1, 4, v127
    s_lshl_b32 s84, s16, 13
    v_add_u32 v0, s84, v1
    v_add_u32 v0, 32768, v0
    v_add_u32 v10, 65536, v0
    s_lshl_b32 s19, s16, 11
    v_add_u32 v5, s19, v1
    s_lshl_b32 s83, s17, 13
    s_add_u32 s40, s19, 1572864
    s_add_u32 s41, s83, s19
    s_add_u32 s41, s41, 1048576
    s_lshl_b32 s19, s17, 6
    s_add_u32 s43, s19, s40
    v_and_b32 v121, 1, v127
    v_bfe_u32 v122, v127, 1, 1
    v_bfe_u32 v123, v127, 2, 1
    v_bfe_u32 v124, v127, 3, 1
    v_and_b32 v120, 3, v127
    v_bfe_u32 v116, v127, 4, 1
    v_bfe_u32 v115, v127, 5, 1
    v_lshlrev_b32 v7, 5, v122
    v_lshl_add_u32 v7, v115, 4, v7
    v_lshl_add_u32 v7, v121, 3, v7
    v_lshl_add_u32 v7, v116, 2, v7
    v_mov_b32 v64, -1
    v_mov_b32 v65, -1
    v_mov_b32 v66, -1
    v_mov_b32 v67, -1
    v_lshlrev_b32 v70, 10, v115
    v_lshl_add_u32 v70, v120, 2, v70
    v_lshl_add_u32 v70, v116, 1, v70
    s_and_b32 s19, s17, 3
    s_lshl_b32 s19, s19, 11
    s_lshr_b32 s20, s17, 3
    s_lshl_b32 s20, s20, 8
    s_add_u32 s19, s19, s20
    s_and_b32 s20, s17, 4
    s_lshl_b32 s20, s20, 2
    s_add_u32 s19, s19, s20
    s_lshl_b32 s20, s16, 6
    s_add_u32 s19, s19, s20
    buffer_load_ushort v71, v70, s[68:71], s19 offen
    buffer_load_ushort v72, v70, s[68:71], s19 offen offset:32
    buffer_store_dwordx4 v[64:67], v1, s[4:7], s41 offen
    buffer_store_dwordx4 v[64:67], v1, s[4:7], s41 offen offset:1024
    v_lshrrev_b32 v119, 2, v127
    v_lshlrev_b32 v119, 13, v119
    v_lshl_add_u32 v119, v120, 4, v119
    s_add_u32 s19, s43, 8192
    buffer_store_dwordx4 v[64:67], v119, s[4:7], s19 offen
    s_add_u32 s19, s43, 139264
    buffer_store_dwordx4 v[64:67], v119, s[4:7], s19 offen
    s_add_u32 s19, s43, 270336
    buffer_store_dwordx4 v[64:67], v119, s[4:7], s19 offen
    s_add_u32 s19, s43, 401408
    buffer_store_dwordx4 v[64:67], v119, s[4:7], s19 offen
    v_mov_b32 v119, 0x4444
    v_mov_b32 v118, 0xeeee
    v_cmp_eq_u32 s[50:51], 1, v122
    s_nop 1
    v_cndmask_b32 v2, v119, v118, s[50:51]
    v_lshrrev_b32 v119, 2, v126
    v_lshl_add_u32 v118, v124, 2, v125
    v_lshlrev_b32 v118, 13, v118
    v_and_b32 v117, 7, v127
    v_lshl_add_u32 v118, v117, 3, v118
    s_lshl_b32 s19, s16, 16
    s_lshl_b32 s20, s17, 6
    s_add_u32 s19, s19, s20
    v_add_u32 v3, s19, v118
    v_lshrrev_b32 v4, 1, v1
    v_lshlrev_b32 v118, 4, v116
    v_xor_b32 v4, v4, v118
    v_lshl_add_u32 v118, v119, 1, v121
    v_lshlrev_b32 v118, 4, v118
    v_lshl_add_u32 v117, v125, 1, v122
    v_lshl_add_u32 v117, v117, 7, v118
    v_add_u32 v9, 30720, v117
    v_lshl_add_u32 v117, v125, 7, v118
    s_lshl_b32 s19, s16, 9
    v_add_u32 v117, s19, v117
    v_mov_b32 v116, 24576
    v_mov_b32 v115, 30720
    v_cndmask_b32 v116, v116, v115, s[50:51]
    v_add_u32 v8, v116, v117
    v_lshlrev_b32 v117, 5, v126
    v_lshl_add_u32 v117, v125, 3, v117
    v_lshlrev_b32 v116, 4, v123
    v_xor_b32 v117, v117, v116
    s_lshl_b32 s19, s16, 10
    s_add_u32 s19, s19, 26624
    v_add_u32 v6, s19, v117
    v_mov_b32 v117, 0x3f80
    v_mov_b32 v116, 0x3f800000
    v_cmp_eq_u32 vcc, 1, v124
    s_nop 1
    v_cndmask_b32 v11, v117, v116, vcc
    v_lshl_add_u32 v117, v123, 1, v120
    v_lshl_add_u32 v117, v122, 3, v117
    s_mov_b32 s34, 0x3e0293ee
    s_mov_b32 s44, 0x3f803f80
    s_mov_b32 s45, 0x3f803f80
    v_cmp_eq_u32 s[72:73], 0, v117
    v_cmp_eq_u32 s[74:75], 1, v117
    v_cmp_eq_u32 s[76:77], 2, v117
    v_cmp_eq_u32 s[78:79], 3, v117
    v_bfe_u32 v116, v127, 4, 1
    v_bfe_u32 v115, v127, 5, 1
    v_and_b32 v114, 7, v127
    v_lshlrev_b32 v113, 1, v115
    v_xor_b32 v114, v114, v113
    v_lshlrev_b32 v114, 4, v114
    v_lshl_add_u32 v113, v124, 1, v116
    v_lshl_add_u32 v113, v115, 2, v113
    v_lshl_add_u32 v112, v113, 13, v114
    s_lshl_b32 s19, s17, 8
    s_lshr_b32 s20, s16, 1
    s_lshl_b32 s20, s20, 7
    s_add_u32 s19, s19, s20
    s_and_b32 s20, s16, 1
    s_lshl_b32 s20, s20, 20
    s_add_u32 s19, s19, s20
    v_add_u32 v112, s19, v112
    v_xor_b32 v111, 64, v112
    v_lshrrev_b32 v113, 3, v127
    v_lshl_add_u32 v110, v113, 10, v114
    s_lshl_b32 s19, s17, 17
    s_lshl_b32 s20, s16, 8
    s_add_u32 s19, s19, s20
    v_add_u32 v110, s19, v110
    v_xor_b32 v109, 64, v110
    v_lshl_add_u32 v113, v124, 2, v116
    v_lshl_add_u32 v113, v115, 3, v113
    v_lshl_add_u32 v113, v123, 4, v113
    v_lshlrev_b32 v113, 7, v113
    v_lshl_add_u32 v113, v120, 3, v113
    v_lshl_add_u32 v114, v123, 1, v124
    s_and_b32 s19, s16, 1
    s_lshl_b32 s20, s19, 1
    v_xor_b32 v114, s20, v114
    v_lshl_add_u32 v113, v114, 5, v113
    s_lshr_b32 s20, s16, 1
    s_lshl_b32 s19, s20, 14
    v_add_u32 v100, s19, v113
    v_xor_b32 v101, 32, v100
    v_xor_b32 v102, 4096, v100
    v_xor_b32 v103, 4096, v101
    v_lshl_add_u32 v113, v124, 2, v123
    v_lshl_add_u32 v113, v115, 3, v113
    v_lshl_add_u32 v113, v116, 4, v113
    v_lshlrev_b32 v113, 7, v113
    v_lshl_add_u32 v113, v120, 3, v113
    v_lshl_add_u32 v114, v116, 1, v124
    v_lshl_add_u32 v113, v114, 5, v113
    v_add_u32 v96, s84, v113
    v_xor_b32 v97, 32, v96
    v_xor_b32 v98, 64, v96
    v_xor_b32 v99, 96, v96
    s_barrier
    s_add_u32 m0, s84, 131072
    s_mov_b32 s19, 65536
    buffer_load_dwordx4 v110, s[64:67], s19 offen lds
    s_add_u32 m0, s84, 132096
    s_mov_b32 s19, 73728
    buffer_load_dwordx4 v110, s[64:67], s19 offen lds
    s_add_u32 m0, s84, 133120
    s_mov_b32 s19, 81920
    buffer_load_dwordx4 v109, s[64:67], s19 offen lds
    s_add_u32 m0, s84, 134144
    s_mov_b32 s19, 90112
    buffer_load_dwordx4 v109, s[64:67], s19 offen lds
    s_add_u32 m0, s84, 135168
    s_mov_b32 s19, 98304
    buffer_load_dwordx4 v110, s[64:67], s19 offen lds
    s_add_u32 m0, s84, 136192
    s_mov_b32 s19, 106496
    buffer_load_dwordx4 v110, s[64:67], s19 offen lds
    s_add_u32 m0, s84, 137216
    s_mov_b32 s19, 114688
    buffer_load_dwordx4 v109, s[64:67], s19 offen lds
    s_add_u32 m0, s84, 138240
    s_mov_b32 s19, 122880
    buffer_load_dwordx4 v109, s[64:67], s19 offen lds
    s_add_u32 m0, s84, 0
    s_mov_b32 s19, 65664
    buffer_load_dwordx4 v110, s[64:67], s19 offen lds
    s_add_u32 m0, s84, 1024
    s_mov_b32 s19, 73856
    buffer_load_dwordx4 v110, s[64:67], s19 offen lds
    s_add_u32 m0, s84, 2048
    s_mov_b32 s19, 82048
    buffer_load_dwordx4 v109, s[64:67], s19 offen lds
    s_add_u32 m0, s84, 3072
    s_mov_b32 s19, 90240
    buffer_load_dwordx4 v109, s[64:67], s19 offen lds
    s_add_u32 m0, s84, 4096
    s_mov_b32 s19, 98432
    buffer_load_dwordx4 v110, s[64:67], s19 offen lds
    s_add_u32 m0, s84, 5120
    s_mov_b32 s19, 106624
    buffer_load_dwordx4 v110, s[64:67], s19 offen lds
    s_add_u32 m0, s84, 6144
    s_mov_b32 s19, 114816
    buffer_load_dwordx4 v109, s[64:67], s19 offen lds
    s_add_u32 m0, s84, 7168
    s_mov_b32 s19, 123008
    buffer_load_dwordx4 v109, s[64:67], s19 offen lds
    s_add_u32 m0, s84, 32768
    s_mov_b32 s19, 2097152
    buffer_load_dwordx4 v112, s[52:55], s19 offen lds
    s_add_u32 m0, s84, 33792
    s_mov_b32 s19, 2162688
    buffer_load_dwordx4 v112, s[52:55], s19 offen lds
    s_add_u32 m0, s84, 34816
    s_mov_b32 s19, 2228224
    buffer_load_dwordx4 v111, s[52:55], s19 offen lds
    s_add_u32 m0, s84, 35840
    s_mov_b32 s19, 2293760
    buffer_load_dwordx4 v111, s[52:55], s19 offen lds
    s_add_u32 m0, s84, 36864
    s_mov_b32 s19, 2359296
    buffer_load_dwordx4 v112, s[52:55], s19 offen lds
    s_add_u32 m0, s84, 37888
    s_mov_b32 s19, 2424832
    buffer_load_dwordx4 v112, s[52:55], s19 offen lds
    s_add_u32 m0, s84, 38912
    s_mov_b32 s19, 2490368
    buffer_load_dwordx4 v111, s[52:55], s19 offen lds
    s_add_u32 m0, s84, 39936
    s_mov_b32 s19, 2555904
    buffer_load_dwordx4 v111, s[52:55], s19 offen lds
    s_add_u32 m0, s84, 65536
    s_mov_b32 s19, 524288
    buffer_load_dwordx4 v112, s[52:55], s19 offen lds
    s_add_u32 m0, s84, 66560
    s_mov_b32 s19, 589824
    buffer_load_dwordx4 v112, s[52:55], s19 offen lds
    s_add_u32 m0, s84, 67584
    s_mov_b32 s19, 655360
    buffer_load_dwordx4 v111, s[52:55], s19 offen lds
    s_add_u32 m0, s84, 68608
    s_mov_b32 s19, 720896
    buffer_load_dwordx4 v111, s[52:55], s19 offen lds
    s_add_u32 m0, s84, 69632
    s_mov_b32 s19, 786432
    buffer_load_dwordx4 v112, s[52:55], s19 offen lds
    s_add_u32 m0, s84, 70656
    s_mov_b32 s19, 851968
    buffer_load_dwordx4 v112, s[52:55], s19 offen lds
    s_add_u32 m0, s84, 71680
    s_mov_b32 s19, 917504
    buffer_load_dwordx4 v111, s[52:55], s19 offen lds
    s_add_u32 m0, s84, 72704
    s_mov_b32 s19, 983040
    buffer_load_dwordx4 v111, s[52:55], s19 offen lds
    s_add_u32 m0, s84, 98304
    s_mov_b32 s19, 2621440
    buffer_load_dwordx4 v112, s[52:55], s19 offen lds
    s_add_u32 m0, s84, 99328
    s_mov_b32 s19, 2686976
    buffer_load_dwordx4 v112, s[52:55], s19 offen lds
    s_add_u32 m0, s84, 100352
    s_mov_b32 s19, 2752512
    buffer_load_dwordx4 v111, s[52:55], s19 offen lds
    s_add_u32 m0, s84, 101376
    s_mov_b32 s19, 2818048
    buffer_load_dwordx4 v111, s[52:55], s19 offen lds
    s_add_u32 m0, s84, 102400
    s_mov_b32 s19, 2883584
    buffer_load_dwordx4 v112, s[52:55], s19 offen lds
    s_add_u32 m0, s84, 103424
    s_mov_b32 s19, 2949120
    buffer_load_dwordx4 v112, s[52:55], s19 offen lds
    s_add_u32 m0, s84, 104448
    s_mov_b32 s19, 3014656
    buffer_load_dwordx4 v111, s[52:55], s19 offen lds
    s_add_u32 m0, s84, 105472
    s_mov_b32 s19, 3080192
    buffer_load_dwordx4 v111, s[52:55], s19 offen lds
    s_lshl_b32 s19, s16, 11
    s_add_u32 s81, s19, 8192
    s_add_u32 s82, s19, 16384
    s_add_u32 s19, s19, s83
    s_add_u32 s30, s19, 16777216
    s_add_u32 s31, s19, 33554432
    s_lshl_b32 s19, s17, 12
    s_lshl_b32 s20, s16, 10
    s_add_u32 s19, s19, s20
    s_add_u32 s33, s19, 4194304
    s_mov_b32 s85, 0
    v_add_u32 v92, 131072, v96
    v_add_u32 v93, 131072, v97
    v_add_u32 v94, 131072, v98
    v_add_u32 v95, 131072, v99
    s_waitcnt vmcnt(32)
    v_lshl_or_b32 v71, v72, 16, v71
    buffer_store_dword v71, v7, s[4:7], s43 offen
    ds_read_b64_tr_b16 a[0:1], v92 offset:0
    ds_read_b64_tr_b16 a[2:3], v92 offset:256
    ds_read_b64_tr_b16 a[4:5], v92 offset:4096
    ds_read_b64_tr_b16 a[6:7], v92 offset:4352
    ds_read_b64_tr_b16 a[8:9], v93 offset:0
    ds_read_b64_tr_b16 a[10:11], v93 offset:256
    ds_read_b64_tr_b16 a[12:13], v93 offset:4096
    ds_read_b64_tr_b16 a[14:15], v93 offset:4352
    ds_read_b64_tr_b16 a[16:17], v94 offset:0
    ds_read_b64_tr_b16 a[18:19], v94 offset:256
    ds_read_b64_tr_b16 a[20:21], v94 offset:4096
    ds_read_b64_tr_b16 a[22:23], v94 offset:4352
    ds_read_b64_tr_b16 a[24:25], v95 offset:0
    ds_read_b64_tr_b16 a[26:27], v95 offset:256
    ds_read_b64_tr_b16 a[28:29], v95 offset:4096
    ds_read_b64_tr_b16 a[30:31], v95 offset:4352
    s_waitcnt lgkmcnt(0)
    s_add_u32 m0, s84, 131072
    s_mov_b32 s19, 0
    buffer_load_dwordx4 v112, s[56:59], s19 offen lds
    s_add_u32 m0, s84, 132096
    s_mov_b32 s19, 65536
    buffer_load_dwordx4 v112, s[56:59], s19 offen lds
    s_add_u32 m0, s84, 133120
    s_mov_b32 s19, 131072
    buffer_load_dwordx4 v111, s[56:59], s19 offen lds
    s_add_u32 m0, s84, 134144
    s_mov_b32 s19, 196608
    buffer_load_dwordx4 v111, s[56:59], s19 offen lds
    s_add_u32 m0, s84, 135168
    s_mov_b32 s19, 262144
    buffer_load_dwordx4 v112, s[56:59], s19 offen lds
    s_add_u32 m0, s84, 136192
    s_mov_b32 s19, 327680
    buffer_load_dwordx4 v112, s[56:59], s19 offen lds
    s_add_u32 m0, s84, 137216
    s_mov_b32 s19, 393216
    buffer_load_dwordx4 v111, s[56:59], s19 offen lds
    s_add_u32 m0, s84, 138240
    s_mov_b32 s19, 458752
    buffer_load_dwordx4 v111, s[56:59], s19 offen lds
    v_add_u32 v92, 0, v96
    v_add_u32 v93, 0, v97
    v_add_u32 v94, 0, v98
    v_add_u32 v95, 0, v99
    s_waitcnt vmcnt(33)
    ds_read_b64_tr_b16 a[32:33], v92 offset:0
    ds_read_b64_tr_b16 a[34:35], v92 offset:256
    ds_read_b64_tr_b16 a[36:37], v92 offset:4096
    ds_read_b64_tr_b16 a[38:39], v92 offset:4352
    ds_read_b64_tr_b16 a[40:41], v93 offset:0
    ds_read_b64_tr_b16 a[42:43], v93 offset:256
    ds_read_b64_tr_b16 a[44:45], v93 offset:4096
    ds_read_b64_tr_b16 a[46:47], v93 offset:4352
    ds_read_b64_tr_b16 a[48:49], v94 offset:0
    ds_read_b64_tr_b16 a[50:51], v94 offset:256
    ds_read_b64_tr_b16 a[52:53], v94 offset:4096
    ds_read_b64_tr_b16 a[54:55], v94 offset:4352
    ds_read_b64_tr_b16 a[56:57], v95 offset:0
    ds_read_b64_tr_b16 a[58:59], v95 offset:256
    ds_read_b64_tr_b16 a[60:61], v95 offset:4096
    ds_read_b64_tr_b16 a[62:63], v95 offset:4352
    s_waitcnt lgkmcnt(0)
    s_add_u32 m0, s84, 0
    s_mov_b32 s19, 2097152
    buffer_load_dwordx4 v112, s[56:59], s19 offen lds
    s_add_u32 m0, s84, 1024
    s_mov_b32 s19, 2162688
    buffer_load_dwordx4 v112, s[56:59], s19 offen lds
    s_add_u32 m0, s84, 2048
    s_mov_b32 s19, 2228224
    buffer_load_dwordx4 v111, s[56:59], s19 offen lds
    s_add_u32 m0, s84, 3072
    s_mov_b32 s19, 2293760
    buffer_load_dwordx4 v111, s[56:59], s19 offen lds
    s_add_u32 m0, s84, 4096
    s_mov_b32 s19, 2359296
    buffer_load_dwordx4 v112, s[56:59], s19 offen lds
    s_add_u32 m0, s84, 5120
    s_mov_b32 s19, 2424832
    buffer_load_dwordx4 v112, s[56:59], s19 offen lds
    s_add_u32 m0, s84, 6144
    s_mov_b32 s19, 2490368
    buffer_load_dwordx4 v111, s[56:59], s19 offen lds
    s_add_u32 m0, s84, 7168
    s_mov_b32 s19, 2555904
    buffer_load_dwordx4 v111, s[56:59], s19 offen lds
    v_add_u32 v92, 32768, v100
    v_add_u32 v93, 32768, v101
    v_add_u32 v94, 32768, v102
    v_add_u32 v95, 32768, v103
    s_waitcnt vmcnt(33)
    s_barrier
    ds_read_b64_tr_b16 a[64:65], v92 offset:0
    ds_read_b64_tr_b16 a[66:67], v92 offset:256
    ds_read_b64_tr_b16 a[68:69], v92 offset:8192
    ds_read_b64_tr_b16 a[70:71], v92 offset:8448
    ds_read_b64_tr_b16 a[72:73], v93 offset:0
    ds_read_b64_tr_b16 a[74:75], v93 offset:256
    ds_read_b64_tr_b16 a[76:77], v93 offset:8192
    ds_read_b64_tr_b16 a[78:79], v93 offset:8448
    ds_read_b64_tr_b16 a[80:81], v94 offset:0
    ds_read_b64_tr_b16 a[82:83], v94 offset:256
    ds_read_b64_tr_b16 a[84:85], v94 offset:8192
    ds_read_b64_tr_b16 a[86:87], v94 offset:8448
    ds_read_b64_tr_b16 a[88:89], v95 offset:0
    ds_read_b64_tr_b16 a[90:91], v95 offset:256
    ds_read_b64_tr_b16 a[92:93], v95 offset:8192
    ds_read_b64_tr_b16 a[94:95], v95 offset:8448
    s_waitcnt lgkmcnt(0)
    s_barrier
    s_add_u32 m0, s84, 32768
    s_mov_b32 s19, 2621440
    buffer_load_dwordx4 v112, s[56:59], s19 offen lds
    s_add_u32 m0, s84, 33792
    s_mov_b32 s19, 2686976
    buffer_load_dwordx4 v112, s[56:59], s19 offen lds
    s_add_u32 m0, s84, 34816
    s_mov_b32 s19, 2752512
    buffer_load_dwordx4 v111, s[56:59], s19 offen lds
    s_add_u32 m0, s84, 35840
    s_mov_b32 s19, 2818048
    buffer_load_dwordx4 v111, s[56:59], s19 offen lds
    s_add_u32 m0, s84, 36864
    s_mov_b32 s19, 2883584
    buffer_load_dwordx4 v112, s[56:59], s19 offen lds
    s_add_u32 m0, s84, 37888
    s_mov_b32 s19, 2949120
    buffer_load_dwordx4 v112, s[56:59], s19 offen lds
    s_add_u32 m0, s84, 38912
    s_mov_b32 s19, 3014656
    buffer_load_dwordx4 v111, s[56:59], s19 offen lds
    s_add_u32 m0, s84, 39936
    s_mov_b32 s19, 3080192
    buffer_load_dwordx4 v111, s[56:59], s19 offen lds
    v_add_u32 v92, 65536, v100
    v_add_u32 v93, 65536, v101
    v_add_u32 v94, 65536, v102
    v_add_u32 v95, 65536, v103
    s_waitcnt vmcnt(33)
    s_barrier
    ds_read_b64_tr_b16 a[96:97], v92 offset:0
    ds_read_b64_tr_b16 a[98:99], v92 offset:256
    ds_read_b64_tr_b16 a[100:101], v92 offset:8192
    ds_read_b64_tr_b16 a[102:103], v92 offset:8448
    ds_read_b64_tr_b16 a[104:105], v93 offset:0
    ds_read_b64_tr_b16 a[106:107], v93 offset:256
    ds_read_b64_tr_b16 a[108:109], v93 offset:8192
    ds_read_b64_tr_b16 a[110:111], v93 offset:8448
    ds_read_b64_tr_b16 a[112:113], v94 offset:0
    ds_read_b64_tr_b16 a[114:115], v94 offset:256
    ds_read_b64_tr_b16 a[116:117], v94 offset:8192
    ds_read_b64_tr_b16 a[118:119], v94 offset:8448
    ds_read_b64_tr_b16 a[120:121], v95 offset:0
    ds_read_b64_tr_b16 a[122:123], v95 offset:256
    ds_read_b64_tr_b16 a[124:125], v95 offset:8192
    ds_read_b64_tr_b16 a[126:127], v95 offset:8448
    s_waitcnt lgkmcnt(0)
    s_barrier
    s_add_u32 m0, s84, 65536
    s_mov_b32 s19, 0
    buffer_load_dwordx4 v112, s[60:63], s19 offen lds
    s_add_u32 m0, s84, 66560
    s_mov_b32 s19, 65536
    buffer_load_dwordx4 v112, s[60:63], s19 offen lds
    s_add_u32 m0, s84, 67584
    s_mov_b32 s19, 131072
    buffer_load_dwordx4 v111, s[60:63], s19 offen lds
    s_add_u32 m0, s84, 68608
    s_mov_b32 s19, 196608
    buffer_load_dwordx4 v111, s[60:63], s19 offen lds
    s_add_u32 m0, s84, 69632
    s_mov_b32 s19, 262144
    buffer_load_dwordx4 v112, s[60:63], s19 offen lds
    s_add_u32 m0, s84, 70656
    s_mov_b32 s19, 327680
    buffer_load_dwordx4 v112, s[60:63], s19 offen lds
    s_add_u32 m0, s84, 71680
    s_mov_b32 s19, 393216
    buffer_load_dwordx4 v111, s[60:63], s19 offen lds
    s_add_u32 m0, s84, 72704
    s_mov_b32 s19, 458752
    buffer_load_dwordx4 v111, s[60:63], s19 offen lds
    v_add_u32 v92, 98304, v100
    v_add_u32 v93, 98304, v101
    v_add_u32 v94, 98304, v102
    v_add_u32 v95, 98304, v103
    s_waitcnt vmcnt(33)
    s_barrier
    ds_read_b64_tr_b16 a[128:129], v92 offset:0
    ds_read_b64_tr_b16 a[130:131], v92 offset:256
    ds_read_b64_tr_b16 a[132:133], v92 offset:8192
    ds_read_b64_tr_b16 a[134:135], v92 offset:8448
    ds_read_b64_tr_b16 a[136:137], v93 offset:0
    ds_read_b64_tr_b16 a[138:139], v93 offset:256
    ds_read_b64_tr_b16 a[140:141], v93 offset:8192
    ds_read_b64_tr_b16 a[142:143], v93 offset:8448
    ds_read_b64_tr_b16 a[144:145], v94 offset:0
    ds_read_b64_tr_b16 a[146:147], v94 offset:256
    ds_read_b64_tr_b16 a[148:149], v94 offset:8192
    ds_read_b64_tr_b16 a[150:151], v94 offset:8448
    ds_read_b64_tr_b16 a[152:153], v95 offset:0
    ds_read_b64_tr_b16 a[154:155], v95 offset:256
    ds_read_b64_tr_b16 a[156:157], v95 offset:8192
    ds_read_b64_tr_b16 a[158:159], v95 offset:8448
    s_waitcnt lgkmcnt(0)
    s_barrier
    s_add_u32 m0, s84, 98304
    s_mov_b32 s19, 2097152
    buffer_load_dwordx4 v112, s[60:63], s19 offen lds
    s_add_u32 m0, s84, 99328
    s_mov_b32 s19, 2162688
    buffer_load_dwordx4 v112, s[60:63], s19 offen lds
    s_add_u32 m0, s84, 100352
    s_mov_b32 s19, 2228224
    buffer_load_dwordx4 v111, s[60:63], s19 offen lds
    s_add_u32 m0, s84, 101376
    s_mov_b32 s19, 2293760
    buffer_load_dwordx4 v111, s[60:63], s19 offen lds
    s_add_u32 m0, s84, 102400
    s_mov_b32 s19, 2359296
    buffer_load_dwordx4 v112, s[60:63], s19 offen lds
    s_add_u32 m0, s84, 103424
    s_mov_b32 s19, 2424832
    buffer_load_dwordx4 v112, s[60:63], s19 offen lds
    s_add_u32 m0, s84, 104448
    s_mov_b32 s19, 2490368
    buffer_load_dwordx4 v111, s[60:63], s19 offen lds
    s_add_u32 m0, s84, 105472
    s_mov_b32 s19, 2555904
    buffer_load_dwordx4 v111, s[60:63], s19 offen lds
    v_add_u32 v92, 131072, v100
    v_add_u32 v93, 131072, v101
    v_add_u32 v94, 131072, v102
    v_add_u32 v95, 131072, v103
    s_waitcnt vmcnt(32)
    v_mov_b32 v106, 132
    v_mov_b32 v105, 1
    s_mov_b64 exec, 1
    buffer_atomic_add v105, v106, s[8:11], 0 offen
    s_mov_b64 exec, -1
    s_barrier
    ds_read_b64_tr_b16 a[160:161], v92 offset:0
    ds_read_b64_tr_b16 a[162:163], v92 offset:256
    ds_read_b64_tr_b16 a[164:165], v92 offset:8192
    ds_read_b64_tr_b16 a[166:167], v92 offset:8448
    ds_read_b64_tr_b16 a[168:169], v93 offset:0
    ds_read_b64_tr_b16 a[170:171], v93 offset:256
    ds_read_b64_tr_b16 a[172:173], v93 offset:8192
    ds_read_b64_tr_b16 a[174:175], v93 offset:8448
    ds_read_b64_tr_b16 a[176:177], v94 offset:0
    ds_read_b64_tr_b16 a[178:179], v94 offset:256
    ds_read_b64_tr_b16 a[180:181], v94 offset:8192
    ds_read_b64_tr_b16 a[182:183], v94 offset:8448
    ds_read_b64_tr_b16 a[184:185], v95 offset:0
    ds_read_b64_tr_b16 a[186:187], v95 offset:256
    ds_read_b64_tr_b16 a[188:189], v95 offset:8192
    ds_read_b64_tr_b16 a[190:191], v95 offset:8448
    s_waitcnt lgkmcnt(0)
    s_barrier
    s_add_u32 m0, s84, 131072
    s_mov_b32 s19, 524288
    buffer_load_dwordx4 v112, s[60:63], s19 offen lds
    s_add_u32 m0, s84, 132096
    s_mov_b32 s19, 589824
    buffer_load_dwordx4 v112, s[60:63], s19 offen lds
    s_add_u32 m0, s84, 133120
    s_mov_b32 s19, 655360
    buffer_load_dwordx4 v111, s[60:63], s19 offen lds
    s_add_u32 m0, s84, 134144
    s_mov_b32 s19, 720896
    buffer_load_dwordx4 v111, s[60:63], s19 offen lds
    s_add_u32 m0, s84, 135168
    s_mov_b32 s19, 786432
    buffer_load_dwordx4 v112, s[60:63], s19 offen lds
    s_add_u32 m0, s84, 136192
    s_mov_b32 s19, 851968
    buffer_load_dwordx4 v112, s[60:63], s19 offen lds
    s_add_u32 m0, s84, 137216
    s_mov_b32 s19, 917504
    buffer_load_dwordx4 v111, s[60:63], s19 offen lds
    s_add_u32 m0, s84, 138240
    s_mov_b32 s19, 983040
    buffer_load_dwordx4 v111, s[60:63], s19 offen lds
    v_add_u32 v92, 0, v100
    v_add_u32 v93, 0, v101
    v_add_u32 v94, 0, v102
    v_add_u32 v95, 0, v103
    s_waitcnt vmcnt(33)
    s_barrier
    ds_read_b64_tr_b16 a[192:193], v92 offset:0
    ds_read_b64_tr_b16 a[194:195], v92 offset:256
    ds_read_b64_tr_b16 a[196:197], v92 offset:8192
    ds_read_b64_tr_b16 a[198:199], v92 offset:8448
    ds_read_b64_tr_b16 a[200:201], v93 offset:0
    ds_read_b64_tr_b16 a[202:203], v93 offset:256
    ds_read_b64_tr_b16 a[204:205], v93 offset:8192
    ds_read_b64_tr_b16 a[206:207], v93 offset:8448
    ds_read_b64_tr_b16 a[208:209], v94 offset:0
    ds_read_b64_tr_b16 a[210:211], v94 offset:256
    ds_read_b64_tr_b16 a[212:213], v94 offset:8192
    ds_read_b64_tr_b16 a[214:215], v94 offset:8448
    ds_read_b64_tr_b16 a[216:217], v95 offset:0
    ds_read_b64_tr_b16 a[218:219], v95 offset:256
    ds_read_b64_tr_b16 a[220:221], v95 offset:8192
    ds_read_b64_tr_b16 a[222:223], v95 offset:8448
    s_waitcnt lgkmcnt(0)
    s_barrier
    s_add_u32 m0, s84, 0
    s_mov_b32 s19, 2621440
    buffer_load_dwordx4 v112, s[60:63], s19 offen lds
    s_add_u32 m0, s84, 1024
    s_mov_b32 s19, 2686976
    buffer_load_dwordx4 v112, s[60:63], s19 offen lds
    s_add_u32 m0, s84, 2048
    s_mov_b32 s19, 2752512
    buffer_load_dwordx4 v111, s[60:63], s19 offen lds
    s_add_u32 m0, s84, 3072
    s_mov_b32 s19, 2818048
    buffer_load_dwordx4 v111, s[60:63], s19 offen lds
    s_add_u32 m0, s84, 4096
    s_mov_b32 s19, 2883584
    buffer_load_dwordx4 v112, s[60:63], s19 offen lds
    s_add_u32 m0, s84, 5120
    s_mov_b32 s19, 2949120
    buffer_load_dwordx4 v112, s[60:63], s19 offen lds
    s_add_u32 m0, s84, 6144
    s_mov_b32 s19, 3014656
    buffer_load_dwordx4 v111, s[60:63], s19 offen lds
    s_add_u32 m0, s84, 7168
    s_mov_b32 s19, 3080192
    buffer_load_dwordx4 v111, s[60:63], s19 offen lds
    v_add_u32 v92, 32768, v100
    v_add_u32 v93, 32768, v101
    v_add_u32 v94, 32768, v102
    v_add_u32 v95, 32768, v103
    s_waitcnt vmcnt(33)
    s_barrier
    ds_read_b64_tr_b16 a[224:225], v92 offset:0
    ds_read_b64_tr_b16 a[226:227], v92 offset:256
    ds_read_b64_tr_b16 a[228:229], v92 offset:8192
    ds_read_b64_tr_b16 a[230:231], v92 offset:8448
    ds_read_b64_tr_b16 a[232:233], v93 offset:0
    ds_read_b64_tr_b16 a[234:235], v93 offset:256
    ds_read_b64_tr_b16 a[236:237], v93 offset:8192
    ds_read_b64_tr_b16 a[238:239], v93 offset:8448
    ds_read_b64_tr_b16 a[240:241], v94 offset:0
    ds_read_b64_tr_b16 a[242:243], v94 offset:256
    ds_read_b64_tr_b16 a[244:245], v94 offset:8192
    ds_read_b64_tr_b16 a[246:247], v94 offset:8448
    ds_read_b64_tr_b16 a[248:249], v95 offset:0
    ds_read_b64_tr_b16 a[250:251], v95 offset:256
    ds_read_b64_tr_b16 a[252:253], v95 offset:8192
    ds_read_b64_tr_b16 a[254:255], v95 offset:8448
    s_waitcnt lgkmcnt(0)
    s_barrier
    s_add_u32 m0, s84, 32768
    s_mov_b32 s19, 0
    buffer_load_dwordx4 v110, s[64:67], s19 offen lds
    s_add_u32 m0, s84, 33792
    s_mov_b32 s19, 8192
    buffer_load_dwordx4 v110, s[64:67], s19 offen lds
    s_add_u32 m0, s84, 34816
    s_mov_b32 s19, 16384
    buffer_load_dwordx4 v109, s[64:67], s19 offen lds
    s_add_u32 m0, s84, 35840
    s_mov_b32 s19, 24576
    buffer_load_dwordx4 v109, s[64:67], s19 offen lds
    s_add_u32 m0, s84, 36864
    s_mov_b32 s19, 32768
    buffer_load_dwordx4 v110, s[64:67], s19 offen lds
    s_add_u32 m0, s84, 37888
    s_mov_b32 s19, 40960
    buffer_load_dwordx4 v110, s[64:67], s19 offen lds
    s_add_u32 m0, s84, 38912
    s_mov_b32 s19, 49152
    buffer_load_dwordx4 v109, s[64:67], s19 offen lds
    s_add_u32 m0, s84, 39936
    s_mov_b32 s19, 57344
    buffer_load_dwordx4 v109, s[64:67], s19 offen lds
    v_add_u32 v92, 65536, v100
    v_add_u32 v93, 65536, v101
    v_add_u32 v94, 65536, v102
    v_add_u32 v95, 65536, v103
    s_waitcnt vmcnt(33)
    s_barrier
    ds_read_b64_tr_b16 v[128:129], v92 offset:0
    ds_read_b64_tr_b16 v[130:131], v92 offset:256
    ds_read_b64_tr_b16 v[132:133], v92 offset:8192
    ds_read_b64_tr_b16 v[134:135], v92 offset:8448
    ds_read_b64_tr_b16 v[136:137], v93 offset:0
    ds_read_b64_tr_b16 v[138:139], v93 offset:256
    ds_read_b64_tr_b16 v[140:141], v93 offset:8192
    ds_read_b64_tr_b16 v[142:143], v93 offset:8448
    ds_read_b64_tr_b16 v[144:145], v94 offset:0
    ds_read_b64_tr_b16 v[146:147], v94 offset:256
    ds_read_b64_tr_b16 v[148:149], v94 offset:8192
    ds_read_b64_tr_b16 v[150:151], v94 offset:8448
    ds_read_b64_tr_b16 v[152:153], v95 offset:0
    ds_read_b64_tr_b16 v[154:155], v95 offset:256
    ds_read_b64_tr_b16 v[156:157], v95 offset:8192
    ds_read_b64_tr_b16 v[158:159], v95 offset:8448
    s_waitcnt lgkmcnt(0)
    s_barrier
    s_add_u32 m0, s84, 65536
    s_mov_b32 s19, 128
    buffer_load_dwordx4 v110, s[64:67], s19 offen lds
    s_add_u32 m0, s84, 66560
    s_mov_b32 s19, 8320
    buffer_load_dwordx4 v110, s[64:67], s19 offen lds
    s_add_u32 m0, s84, 67584
    s_mov_b32 s19, 16512
    buffer_load_dwordx4 v109, s[64:67], s19 offen lds
    s_add_u32 m0, s84, 68608
    s_mov_b32 s19, 24704
    buffer_load_dwordx4 v109, s[64:67], s19 offen lds
    s_add_u32 m0, s84, 69632
    s_mov_b32 s19, 32896
    buffer_load_dwordx4 v110, s[64:67], s19 offen lds
    s_add_u32 m0, s84, 70656
    s_mov_b32 s19, 41088
    buffer_load_dwordx4 v110, s[64:67], s19 offen lds
    s_add_u32 m0, s84, 71680
    s_mov_b32 s19, 49280
    buffer_load_dwordx4 v109, s[64:67], s19 offen lds
    s_add_u32 m0, s84, 72704
    s_mov_b32 s19, 57472
    buffer_load_dwordx4 v109, s[64:67], s19 offen lds
    v_add_u32 v92, 98304, v100
    v_add_u32 v93, 98304, v101
    v_add_u32 v94, 98304, v102
    v_add_u32 v95, 98304, v103
    s_waitcnt vmcnt(33)
    s_barrier
    ds_read_b64_tr_b16 v[160:161], v92 offset:0
    ds_read_b64_tr_b16 v[162:163], v92 offset:256
    ds_read_b64_tr_b16 v[164:165], v92 offset:8192
    ds_read_b64_tr_b16 v[166:167], v92 offset:8448
    ds_read_b64_tr_b16 v[168:169], v93 offset:0
    ds_read_b64_tr_b16 v[170:171], v93 offset:256
    ds_read_b64_tr_b16 v[172:173], v93 offset:8192
    ds_read_b64_tr_b16 v[174:175], v93 offset:8448
    ds_read_b64_tr_b16 v[176:177], v94 offset:0
    ds_read_b64_tr_b16 v[178:179], v94 offset:256
    ds_read_b64_tr_b16 v[180:181], v94 offset:8192
    ds_read_b64_tr_b16 v[182:183], v94 offset:8448
    ds_read_b64_tr_b16 v[184:185], v95 offset:0
    ds_read_b64_tr_b16 v[186:187], v95 offset:256
    ds_read_b64_tr_b16 v[188:189], v95 offset:8192
    ds_read_b64_tr_b16 v[190:191], v95 offset:8448
    s_waitcnt lgkmcnt(0)
    s_barrier
    s_add_u32 m0, s84, 98304
    s_mov_b32 s19, 0
    buffer_load_dwordx4 v112, s[52:55], s19 offen lds
    s_add_u32 m0, s84, 99328
    s_mov_b32 s19, 65536
    buffer_load_dwordx4 v112, s[52:55], s19 offen lds
    s_add_u32 m0, s84, 100352
    s_mov_b32 s19, 131072
    buffer_load_dwordx4 v111, s[52:55], s19 offen lds
    s_add_u32 m0, s84, 101376
    s_mov_b32 s19, 196608
    buffer_load_dwordx4 v111, s[52:55], s19 offen lds
    s_add_u32 m0, s84, 102400
    s_mov_b32 s19, 262144
    buffer_load_dwordx4 v112, s[52:55], s19 offen lds
    s_add_u32 m0, s84, 103424
    s_mov_b32 s19, 327680
    buffer_load_dwordx4 v112, s[52:55], s19 offen lds
    s_add_u32 m0, s84, 104448
    s_mov_b32 s19, 393216
    buffer_load_dwordx4 v111, s[52:55], s19 offen lds
    s_add_u32 m0, s84, 105472
    s_mov_b32 s19, 458752
    buffer_load_dwordx4 v111, s[52:55], s19 offen lds
    v_add_u32 v92, 131072, v100
    v_add_u32 v93, 131072, v101
    v_add_u32 v94, 131072, v102
    v_add_u32 v95, 131072, v103
    s_waitcnt vmcnt(32)
    s_barrier
    ds_read_b64_tr_b16 v[192:193], v92 offset:0
    ds_read_b64_tr_b16 v[194:195], v92 offset:256
    ds_read_b64_tr_b16 v[196:197], v92 offset:8192
    ds_read_b64_tr_b16 v[198:199], v92 offset:8448
    ds_read_b64_tr_b16 v[200:201], v93 offset:0
    ds_read_b64_tr_b16 v[202:203], v93 offset:256
    ds_read_b64_tr_b16 v[204:205], v93 offset:8192
    ds_read_b64_tr_b16 v[206:207], v93 offset:8448
    ds_read_b64_tr_b16 v[208:209], v94 offset:0
    ds_read_b64_tr_b16 v[210:211], v94 offset:256
    ds_read_b64_tr_b16 v[212:213], v94 offset:8192
    ds_read_b64_tr_b16 v[214:215], v94 offset:8448
    ds_read_b64_tr_b16 v[216:217], v95 offset:0
    ds_read_b64_tr_b16 v[218:219], v95 offset:256
    ds_read_b64_tr_b16 v[220:221], v95 offset:8192
    ds_read_b64_tr_b16 v[222:223], v95 offset:8448
    s_waitcnt lgkmcnt(0)
    s_barrier
    s_add_u32 m0, s84, 131072
    s_mov_b32 s19, 524288
    buffer_load_dwordx4 v112, s[56:59], s19 offen lds
    s_add_u32 m0, s84, 132096
    s_mov_b32 s19, 589824
    buffer_load_dwordx4 v112, s[56:59], s19 offen lds
    s_add_u32 m0, s84, 133120
    s_mov_b32 s19, 655360
    buffer_load_dwordx4 v111, s[56:59], s19 offen lds
    s_add_u32 m0, s84, 134144
    s_mov_b32 s19, 720896
    buffer_load_dwordx4 v111, s[56:59], s19 offen lds
    s_add_u32 m0, s84, 135168
    s_mov_b32 s19, 786432
    buffer_load_dwordx4 v112, s[56:59], s19 offen lds
    s_add_u32 m0, s84, 136192
    s_mov_b32 s19, 851968
    buffer_load_dwordx4 v112, s[56:59], s19 offen lds
    s_add_u32 m0, s84, 137216
    s_mov_b32 s19, 917504
    buffer_load_dwordx4 v111, s[56:59], s19 offen lds
    s_add_u32 m0, s84, 138240
    s_mov_b32 s19, 983040
    buffer_load_dwordx4 v111, s[56:59], s19 offen lds
    v_add_u32 v92, 0, v100
    v_add_u32 v93, 0, v101
    v_add_u32 v94, 0, v102
    v_add_u32 v95, 0, v103
    s_waitcnt vmcnt(32)
    s_barrier
    ds_read_b64_tr_b16 v[224:225], v92 offset:0
    ds_read_b64_tr_b16 v[226:227], v92 offset:256
    ds_read_b64_tr_b16 v[228:229], v92 offset:8192
    ds_read_b64_tr_b16 v[230:231], v92 offset:8448
    ds_read_b64_tr_b16 v[232:233], v93 offset:0
    ds_read_b64_tr_b16 v[234:235], v93 offset:256
    ds_read_b64_tr_b16 v[236:237], v93 offset:8192
    ds_read_b64_tr_b16 v[238:239], v93 offset:8448
    ds_read_b64_tr_b16 v[240:241], v94 offset:0
    ds_read_b64_tr_b16 v[242:243], v94 offset:256
    ds_read_b64_tr_b16 v[244:245], v94 offset:8192
    ds_read_b64_tr_b16 v[246:247], v94 offset:8448
    ds_read_b64_tr_b16 v[248:249], v95 offset:0
    ds_read_b64_tr_b16 v[250:251], v95 offset:256
    ds_read_b64_tr_b16 v[252:253], v95 offset:8192
    ds_read_b64_tr_b16 v[254:255], v95 offset:8448
    s_waitcnt lgkmcnt(0)
    s_barrier
    v_add_u32 v92, 32768, v96
    v_add_u32 v93, 32768, v97
    v_add_u32 v94, 32768, v98
    v_add_u32 v95, 32768, v99
    s_waitcnt vmcnt(24)
    ds_read_b64_tr_b16 v[16:17], v92 offset:0
    ds_read_b64_tr_b16 v[18:19], v92 offset:256
    ds_read_b64_tr_b16 v[20:21], v92 offset:4096
    ds_read_b64_tr_b16 v[22:23], v92 offset:4352
    ds_read_b64_tr_b16 v[24:25], v93 offset:0
    ds_read_b64_tr_b16 v[26:27], v93 offset:256
    ds_read_b64_tr_b16 v[28:29], v93 offset:4096
    ds_read_b64_tr_b16 v[30:31], v93 offset:4352
    ds_read_b64_tr_b16 v[32:33], v94 offset:0
    ds_read_b64_tr_b16 v[34:35], v94 offset:256
    ds_read_b64_tr_b16 v[36:37], v94 offset:4096
    ds_read_b64_tr_b16 v[38:39], v94 offset:4352
    ds_read_b64_tr_b16 v[40:41], v95 offset:0
    ds_read_b64_tr_b16 v[42:43], v95 offset:256
    ds_read_b64_tr_b16 v[44:45], v95 offset:4096
    ds_read_b64_tr_b16 v[46:47], v95 offset:4352
    s_waitcnt lgkmcnt(0)
    ds_write_b128 v0, v[16:19] offset:0
    ds_write_b128 v0, v[20:23] offset:1024
    ds_write_b128 v0, v[24:27] offset:2048
    ds_write_b128 v0, v[28:31] offset:3072
    ds_write_b128 v0, v[32:35] offset:4096
    ds_write_b128 v0, v[36:39] offset:5120
    ds_write_b128 v0, v[40:43] offset:6144
    ds_write_b128 v0, v[44:47] offset:7168
    s_waitcnt lgkmcnt(0)
    v_add_u32 v92, 65536, v96
    v_add_u32 v93, 65536, v97
    v_add_u32 v94, 65536, v98
    v_add_u32 v95, 65536, v99
    s_waitcnt vmcnt(16)
    ds_read_b64_tr_b16 v[16:17], v92 offset:0
    ds_read_b64_tr_b16 v[18:19], v92 offset:256
    ds_read_b64_tr_b16 v[20:21], v92 offset:4096
    ds_read_b64_tr_b16 v[22:23], v92 offset:4352
    ds_read_b64_tr_b16 v[24:25], v93 offset:0
    ds_read_b64_tr_b16 v[26:27], v93 offset:256
    ds_read_b64_tr_b16 v[28:29], v93 offset:4096
    ds_read_b64_tr_b16 v[30:31], v93 offset:4352
    ds_read_b64_tr_b16 v[32:33], v94 offset:0
    ds_read_b64_tr_b16 v[34:35], v94 offset:256
    ds_read_b64_tr_b16 v[36:37], v94 offset:4096
    ds_read_b64_tr_b16 v[38:39], v94 offset:4352
    ds_read_b64_tr_b16 v[40:41], v95 offset:0
    ds_read_b64_tr_b16 v[42:43], v95 offset:256
    ds_read_b64_tr_b16 v[44:45], v95 offset:4096
    ds_read_b64_tr_b16 v[46:47], v95 offset:4352
    s_waitcnt lgkmcnt(0)
    ds_write_b128 v0, v[16:19] offset:32768
    ds_write_b128 v0, v[20:23] offset:33792
    ds_write_b128 v0, v[24:27] offset:34816
    ds_write_b128 v0, v[28:31] offset:35840
    ds_write_b128 v0, v[32:35] offset:36864
    ds_write_b128 v0, v[36:39] offset:37888
    ds_write_b128 v0, v[40:43] offset:38912
    ds_write_b128 v0, v[44:47] offset:39936
    s_waitcnt lgkmcnt(0)
    v_add_u32 v92, 98304, v100
    v_add_u32 v93, 98304, v101
    v_add_u32 v94, 98304, v102
    v_add_u32 v95, 98304, v103
    s_waitcnt vmcnt(8)
    v_mov_b32 v106, 0
    buffer_load_dwordx4 v[88:91], v106, s[8:11], 0 offen offset:128 sc1
    v_lshlrev_b32 v105, 3, v1
    s_mov_b32 s19, 1572864
    s_mov_b32 s20, 1581056
    buffer_load_dword v73, v105, s[4:7], s19 offen sc1
    buffer_load_dword v74, v105, s[4:7], s20 offen sc1
    s_barrier
    ds_read_b64_tr_b16 v[16:17], v92 offset:0
    ds_read_b64_tr_b16 v[18:19], v92 offset:256
    ds_read_b64_tr_b16 v[20:21], v92 offset:8192
    ds_read_b64_tr_b16 v[22:23], v92 offset:8448
    ds_read_b64_tr_b16 v[24:25], v93 offset:0
    ds_read_b64_tr_b16 v[26:27], v93 offset:256
    ds_read_b64_tr_b16 v[28:29], v93 offset:8192
    ds_read_b64_tr_b16 v[30:31], v93 offset:8448
    ds_read_b64_tr_b16 v[32:33], v94 offset:0
    ds_read_b64_tr_b16 v[34:35], v94 offset:256
    ds_read_b64_tr_b16 v[36:37], v94 offset:8192
    ds_read_b64_tr_b16 v[38:39], v94 offset:8448
    ds_read_b64_tr_b16 v[40:41], v95 offset:0
    ds_read_b64_tr_b16 v[42:43], v95 offset:256
    ds_read_b64_tr_b16 v[44:45], v95 offset:8192
    ds_read_b64_tr_b16 v[46:47], v95 offset:8448
    s_waitcnt lgkmcnt(0)
    s_barrier
    ds_write_b128 v10, v[16:19] offset:0
    ds_write_b128 v10, v[20:23] offset:1024
    ds_write_b128 v10, v[24:27] offset:2048
    ds_write_b128 v10, v[28:31] offset:3072
    ds_write_b128 v10, v[32:35] offset:4096
    ds_write_b128 v10, v[36:39] offset:5120
    ds_write_b128 v10, v[40:43] offset:6144
    ds_write_b128 v10, v[44:47] offset:7168
    s_waitcnt lgkmcnt(0)
    v_add_u32 v92, 131072, v100
    v_add_u32 v93, 131072, v101
    v_add_u32 v94, 131072, v102
    v_add_u32 v95, 131072, v103
    s_waitcnt vmcnt(3)
    s_mov_b32 s21, 0
L_ch_rdy:
    s_waitcnt vmcnt(0)
    v_cmp_gt_u32 vcc, 128, v89
    v_mov_b32 v105, 224
    v_cmp_gt_u32 s[12:13], v105, v90
    s_or_b64 vcc, vcc, s[12:13]
    v_mov_b32 v105, 128
    v_cmp_gt_u32 s[12:13], v105, v91
    s_or_b64 vcc, vcc, s[12:13]
    s_cbranch_vccz L_ch_rdy_x
    s_add_u32 s21, s21, 1
    s_cmp_gt_u32 s21, 200000
    s_cbranch_scc1 L_ch_fail
    s_sleep 2
    buffer_load_dwordx4 v[88:91], v106, s[8:11], 0 offen offset:128 sc1
    s_branch L_ch_rdy
L_ch_rdy_x:
    s_mov_b32 m0, s81
    s_nop 0
    buffer_load_dwordx4 v1, s[4:7], s30 offen sc1  lds
    buffer_load_dwordx4 v1, s[4:7], s30 offen offset:1024 sc1  lds
    s_add_u32 s30, s30, 262144
    s_mov_b32 m0, s82
    s_nop 0
    buffer_load_dwordx4 v1, s[4:7], s31 offen sc1  lds
    buffer_load_dwordx4 v1, s[4:7], s31 offen offset:1024 sc1  lds
    s_add_u32 s31, s31, 262144
    s_barrier
    ds_read_b64_tr_b16 v[16:17], v92 offset:0
    ds_read_b64_tr_b16 v[18:19], v92 offset:256
    ds_read_b64_tr_b16 v[20:21], v92 offset:8192
    ds_read_b64_tr_b16 v[22:23], v92 offset:8448
    ds_read_b64_tr_b16 v[24:25], v93 offset:0
    ds_read_b64_tr_b16 v[26:27], v93 offset:256
    ds_read_b64_tr_b16 v[28:29], v93 offset:8192
    ds_read_b64_tr_b16 v[30:31], v93 offset:8448
    ds_read_b64_tr_b16 v[32:33], v94 offset:0
    ds_read_b64_tr_b16 v[34:35], v94 offset:256
    ds_read_b64_tr_b16 v[36:37], v94 offset:8192
    ds_read_b64_tr_b16 v[38:39], v94 offset:8448
    ds_read_b64_tr_b16 v[40:41], v95 offset:0
    ds_read_b64_tr_b16 v[42:43], v95 offset:256
    ds_read_b64_tr_b16 v[44:45], v95 offset:8192
    ds_read_b64_tr_b16 v[46:47], v95 offset:8448
    s_waitcnt lgkmcnt(0)
    s_barrier
    ds_write_b128 v10, v[16:19] offset:32768
    ds_write_b128 v10, v[20:23] offset:33792
    ds_write_b128 v10, v[24:27] offset:34816
    ds_write_b128 v10, v[28:31] offset:35840
    ds_write_b128 v10, v[32:35] offset:36864
    ds_write_b128 v10, v[36:39] offset:37888
    ds_write_b128 v10, v[40:43] offset:38912
    ds_write_b128 v10, v[44:47] offset:39936
    s_waitcnt lgkmcnt(0)
    s_barrier
    v_mov_b32 v125, 0
    v_mov_b32 v126, 0
    s_mov_b32 s18, 0
    s_mov_b32 s25, 0
    s_mov_b32 s36, 7
    s_mov_b32 s27, 1572864
    s_mov_b32 s24, 1576960
    s_add_u32 s28, s43, 8192
    s_add_u32 s29, s43, 16384
    s_mov_b64 s[38:39], s[50:51]
    s_mov_b32 s22, 1048576
    s_mov_b32 s23, 1052672
    s_mov_b32 s35, 2621440
    s_mov_b32 s100, 0x30800000
    s_mov_b32 s98, 0x4e800000
    s_mov_b32 m0, s82
    ds_read_b128 v[64:67], v10 offset:0
    ds_read_b128 v[68:71], v10 offset:1024
    ds_read_b128 v[72:75], v10 offset:2048
    ds_read_b128 v[76:79], v10 offset:3072
    ds_read_b128 v[48:51], v10 offset:4096
    ds_read_b128 v[52:55], v10 offset:5120
    ds_read_b128 v[56:59], v10 offset:6144
    ds_read_b128 v[60:63], v10 offset:7168
    v_mov_b64 v[96:97], 0
    v_mov_b64 v[98:99], 0
    v_mov_b64 v[100:101], 0
    v_mov_b64 v[102:103], 0
    v_mov_b64 v[104:105], 0
    v_mov_b64 v[106:107], 0
    v_mov_b64 v[108:109], 0
    v_mov_b64 v[110:111], 0
    v_mov_b64 v[112:113], 0
    v_mov_b64 v[114:115], 0
    v_mov_b64 v[116:117], 0
    v_mov_b64 v[118:119], 0
    buffer_load_dwordx4 v[16:19], v1, s[4:7], s27 offen offset:0 sc1
    buffer_load_dwordx4 v[20:23], v1, s[4:7], s27 offen offset:1024 sc1
    buffer_load_dwordx4 v[24:27], v1, s[4:7], s27 offen offset:2048 sc1
    buffer_load_dwordx4 v[28:31], v1, s[4:7], s27 offen offset:3072 sc1
    buffer_load_dwordx4 v[32:35], v1, s[4:7], s24 offen offset:0 sc1
    buffer_load_dwordx4 v[36:39], v1, s[4:7], s24 offen offset:1024 sc1
    buffer_load_dwordx4 v[40:43], v1, s[4:7], s24 offen offset:2048 sc1
    buffer_load_dwordx4 v[44:47], v1, s[4:7], s24 offen offset:3072 sc1
    s_waitcnt vmcnt(0) lgkmcnt(0)
    s_cmp_eq_u32 s16, 1
    s_cbranch_scc1 L_ch_step1
    s_cmp_eq_u32 s16, 2
    s_cbranch_scc1 L_ch_step2
    s_cmp_eq_u32 s16, 3
    s_cbranch_scc1 L_ch_step3
    s_branch L_ch_step0
.p2align 6
L_ch_step0:
L_ch_g0:
    buffer_load_dwordx4 v[16:19], v1, s[4:7], s27 offen offset:0 sc1
    buffer_load_dwordx4 v[20:23], v1, s[4:7], s27 offen offset:1024 sc1
    s_add_u32 s21, s21, 1
    s_cmp_gt_u32 s21, 200000
    s_cbranch_scc1 L_ch_fail
    s_waitcnt vmcnt(2)
    v_cmp_u_f32 vcc, v16, v20
    s_cbranch_vccnz L_ch_g0
    ds_write_b128 v1, v[16:19] offset:0
    ds_write_b128 v1, v[20:23] offset:1024
    v_smfmac_f32_16x16x64_bf16 v[104:107], v[16:19], a[160:167], v2
    v_cmp_u_f32 s[12:13], v17, v21
    v_smfmac_f32_16x16x64_bf16 v[108:111], v[16:19], a[168:175], v2
    v_cmp_u_f32 s[14:15], v18, v22
    v_smfmac_f32_16x16x64_bf16 v[96:99], v[16:19], v[64:71], v2
    s_or_b64 s[12:13], s[12:13], s[14:15]
    buffer_load_dwordx4 v[32:35], v1, s[4:7], s24 offen offset:0 sc1
    buffer_load_dwordx4 v[36:39], v1, s[4:7], s24 offen offset:1024 sc1
    v_cmp_u_f32 vcc, v19, v23
    v_smfmac_f32_16x16x64_bf16 v[100:103], v[16:19], v[72:79], v2
    s_or_b64 s[12:13], s[12:13], vcc
    s_cbranch_scc1 L_ch_torn0
    v_smfmac_f32_16x16x64_bf16 v[96:99], v[20:23], a[64:71], v2
    s_waitcnt lgkmcnt(0)
    s_barrier
    ds_read_b128 v[24:27], v1 offset:2048
    ds_read_b128 v[28:31], v1 offset:3072
    v_smfmac_f32_16x16x64_bf16 v[100:103], v[20:23], a[72:79], v2
    ds_read_b128 v[64:67], v10 offset:36864
    v_smfmac_f32_16x16x64_bf16 v[104:107], v[20:23], a[192:199], v2
    ds_read_b128 v[68:71], v10 offset:37888
    v_smfmac_f32_16x16x64_bf16 v[108:111], v[20:23], a[200:207], v2
    ds_read_b128 v[72:75], v10 offset:38912
    s_waitcnt lgkmcnt(4)
    v_smfmac_f32_16x16x64_bf16 v[104:107], v[24:27], a[176:183], v2
    ds_read_b128 v[76:79], v10 offset:39936
    v_smfmac_f32_16x16x64_bf16 v[108:111], v[24:27], a[184:191], v2
    ds_read_b128 v[80:83], v1 offset:8192
    v_smfmac_f32_16x16x64_bf16 v[96:99], v[24:27], v[48:55], v2
    ds_read_b128 v[84:87], v1 offset:10240
    v_smfmac_f32_16x16x64_bf16 v[100:103], v[24:27], v[56:63], v2
    ds_read_b128 v[88:91], v1 offset:12288
    s_waitcnt lgkmcnt(7)
    v_smfmac_f32_16x16x64_bf16 v[96:99], v[28:31], a[80:87], v2
    ds_read_b128 v[48:51], v10 offset:32768
    v_smfmac_f32_16x16x64_bf16 v[100:103], v[28:31], a[88:95], v2
    ds_read_b128 v[52:55], v10 offset:33792
    v_smfmac_f32_16x16x64_bf16 v[104:107], v[28:31], a[208:215], v2
    ds_read_b128 v[56:59], v10 offset:34816
    v_smfmac_f32_16x16x64_bf16 v[108:111], v[28:31], a[216:223], v2
    ds_read_b128 v[60:63], v10 offset:35840
    v_smfmac_f32_16x16x64_bf16 v[112:115], v[16:19], v[128:135], v2
    s_waitcnt vmcnt(0)
    ds_read_b128 v[92:95], v1 offset:14336
    v_cmp_u_f32 vcc, v32, v36
    v_smfmac_f32_16x16x64_bf16 v[116:119], v[16:19], v[136:143], v2
    s_cbranch_vccnz L_ch_gf0
L_ch_gk0:
    ds_write_b128 v1, v[32:35] offset:4096
    v_smfmac_f32_16x16x64_bf16 v[112:115], v[20:23], v[160:167], v2
    buffer_store_dwordx4 v[120:123], v1, s[4:7], s35 offen sc1
    ds_write_b128 v1, v[36:39] offset:5120
    v_smfmac_f32_16x16x64_bf16 v[116:119], v[20:23], v[168:175], v2
    v_smfmac_f32_16x16x64_bf16 v[96:99], v[32:35], a[96:103], v2
    buffer_load_dword v13, v7, s[4:7], s29 offen sc1
    ds_read_b128 v[16:19], v5 offset:16384
    v_smfmac_f32_16x16x64_bf16 v[100:103], v[32:35], a[104:111], v2
    s_waitcnt lgkmcnt(1)
    s_barrier
    ds_read_b128 v[40:43], v1 offset:6144
    v_smfmac_f32_16x16x64_bf16 v[104:107], v[32:35], v[48:55], v2
    ds_read_b128 v[44:47], v1 offset:7168
    v_smfmac_f32_16x16x64_bf16 v[108:111], v[32:35], v[56:63], v2
    ds_read_b128 v[20:23], v5 offset:17408
    v_smfmac_f32_16x16x64_bf16 v[96:99], v[36:39], a[128:135], v2
    ds_read_b128 v[48:51], v1 offset:9216
    v_smfmac_f32_16x16x64_bf16 v[100:103], v[36:39], a[136:143], v2
    ds_read_b128 v[52:55], v1 offset:11264
    v_smfmac_f32_16x16x64_bf16 v[104:107], v[36:39], a[224:231], v2
    ds_read_b128 v[56:59], v1 offset:13312
    v_smfmac_f32_16x16x64_bf16 v[108:111], v[36:39], a[232:239], v2
    s_waitcnt lgkmcnt(3)
    buffer_load_dwordx4 v1, s[4:7], s31 offen sc1  lds
    ds_read_b128 v[60:63], v1 offset:15360
    v_smfmac_f32_16x16x64_bf16 v[96:99], v[40:43], a[112:119], v2
    v_smfmac_f32_16x16x64_bf16 v[96:99], v[44:47], a[144:151], v2
    s_nop 0
    v_smfmac_f32_16x16x64_bf16 v[100:103], v[40:43], a[120:127], v2
    s_nop 0
    v_smfmac_f32_16x16x64_bf16 v[100:103], v[44:47], a[152:159], v2
    buffer_load_dwordx4 v1, s[4:7], s31 offen offset:1024 sc1  lds
    s_mov_b32 m0, s81
    s_nop 0
    s_nop 0
    v_add_f32 v96, v96, v98
    v_smfmac_f32_16x16x64_bf16 v[104:107], v[40:43], v[64:71], v2
    v_add_f32 v97, v97, v99
    v_mul_f32 v96, s34, v96
    v_smfmac_f32_16x16x64_bf16 v[104:107], v[44:47], a[240:247], v2
    v_mul_f32 v97, s34, v97
    v_cvt_pk_bf16_f32 v96, v96, v97
    v_smfmac_f32_16x16x64_bf16 v[108:111], v[40:43], v[72:79], v2
    v_add_f32 v100, v100, v102
    v_add_f32 v101, v101, v103
    v_smfmac_f32_16x16x64_bf16 v[108:111], v[44:47], a[248:255], v2
    v_mul_f32 v100, s34, v100
    v_mul_f32 v101, s34, v101
    v_smfmac_f32_16x16x64_bf16 v[112:115], v[24:27], v[144:151], v2
    v_cvt_pk_bf16_f32 v100, v100, v101
    v_add_f32 v104, v104, v106
    v_smfmac_f32_16x16x64_bf16 v[116:119], v[24:27], v[152:159], v2
    ds_write2_b32 v6, v96, v100 offset0:1 offset1:129
    v_add_f32 v105, v105, v107
    v_cvt_pk_bf16_f32 v120, v104, v105
    v_add_f32 v108, v108, v110
    v_add_f32 v109, v109, v111
    v_cvt_pk_bf16_f32 v121, v108, v109
    ds_write2_b32 v6, v120, v121 offset0:0 offset1:128
    v_smfmac_f32_16x16x64_bf16 v[112:115], v[28:31], v[176:183], v2
    s_waitcnt vmcnt(4)
    v_smfmac_f32_16x16x64_bf16 v[116:119], v[28:31], v[184:191], v2
    v_smfmac_f32_16x16x64_bf16 v[112:115], v[32:35], v[192:199], v2
    v_smfmac_f32_16x16x64_bf16 v[116:119], v[32:35], v[200:207], v2
    s_waitcnt lgkmcnt(0)
    s_barrier
    ds_read_b64_tr_b16 v[64:65], v4 offset:26624
    ds_read_b64_tr_b16 v[66:67], v4 offset:27136
    v_smfmac_f32_16x16x64_bf16 v[112:115], v[36:39], v[224:231], v2
    ds_read_b64_tr_b16 v[68:69], v4 offset:27648
    ds_read_b64_tr_b16 v[70:71], v4 offset:28160
    v_smfmac_f32_16x16x64_bf16 v[116:119], v[36:39], v[232:239], v2
    ds_read_b64_tr_b16 v[72:73], v4 offset:28672
    ds_read_b64_tr_b16 v[74:75], v4 offset:29184
    v_smfmac_f32_16x16x64_bf16 v[112:115], v[40:43], v[208:215], v2
    ds_read_b64_tr_b16 v[76:77], v4 offset:29696
    ds_read_b64_tr_b16 v[78:79], v4 offset:30208
    v_smfmac_f32_16x16x64_bf16 v[116:119], v[40:43], v[216:223], v2
    v_smfmac_f32_16x16x64_bf16 v[112:115], v[44:47], v[240:247], v2
    v_mov_b64 v[36:37], s[44:45]
    v_smfmac_f32_16x16x64_bf16 v[116:119], v[44:47], v[248:255], v2
    s_waitcnt lgkmcnt(4)
    v_mov_b64 v[38:39], s[44:45]
    v_mfma_f32_16x16x32_bf16 v[96:99], v[80:83], v[64:67], 0
    buffer_load_dwordx4 v1, s[4:7], s30 offen sc1  lds
    s_mov_b32 s35, s33
    v_mfma_f32_16x16x32_bf16 v[96:99], v[84:87], v[68:71], v[96:99]
    s_waitcnt lgkmcnt(0)
    v_mfma_f32_16x16x32_bf16 v[96:99], v[88:91], v[72:75], v[96:99]
    v_add_f32 v112, v112, v114
    v_add_f32 v113, v113, v115
    v_mfma_f32_16x16x32_bf16 v[96:99], v[92:95], v[76:79], v[96:99]
    v_cvt_pk_bf16_f32 v122, v112, v113
    v_add_f32 v116, v116, v118
    v_mfma_f32_16x16x32_bf16 v[100:103], v[48:51], v[64:67], 0
    ds_read_b128 v[80:83], v0 offset:0
    buffer_load_dwordx4 v1, s[4:7], s30 offen offset:1024 sc1  lds
    v_add_f32 v117, v117, v119
    v_cvt_pk_bf16_f32 v123, v116, v117
    v_mfma_f32_16x16x32_bf16 v[100:103], v[52:55], v[68:71], v[100:103]
    ds_read_b128 v[84:87], v0 offset:1024
    v_mfma_f32_16x16x32_bf16 v[100:103], v[56:59], v[72:75], v[100:103]
    v_exp_f32 v24, v96
    v_mfma_f32_16x16x32_bf16 v[100:103], v[60:63], v[76:79], v[100:103]
    v_exp_f32 v25, v97
    v_mfma_f32_16x16x32_bf16 v[104:107], v[64:67], v[64:67], 0
    v_exp_f32 v26, v98
    v_mfma_f32_16x16x32_bf16 v[104:107], v[68:71], v[68:71], v[104:107]
    v_exp_f32 v27, v99
    v_mfma_f32_16x16x32_bf16 v[104:107], v[72:75], v[72:75], v[104:107]
    v_cvt_pk_bf16_f32 v108, v24, v25
    v_cvt_pk_bf16_f32 v109, v26, v27
    v_mfma_f32_16x16x32_bf16 v[104:107], v[76:79], v[76:79], v[104:107]
    v_exp_f32 v28, v100
    v_exp_f32 v29, v101
    v_exp_f32 v30, v102
    v_exp_f32 v31, v103
    v_cvt_pk_bf16_f32 v110, v28, v29
    v_cvt_pk_bf16_f32 v111, v30, v31
    s_cmp_eq_u32 s18, 63
    s_nop 0
    v_mfma_f32_16x16x32_bf16 v[112:115], v[36:39], v[108:111], 0
    v_exp_f32 v32, v104
    v_mfma_f32_16x16x32_bf16 v[40:43], v[16:19], v[108:111], 0
    v_exp_f32 v33, v105
    v_mfma_f32_16x16x32_bf16 v[44:47], v[20:23], v[108:111], 0
    v_cvt_pk_bf16_f32 v124, v32, v33
    v_cvt_pk_bf16_f32 v127, v32, v33
    ds_read_b128 v[88:91], v0 offset:2048
    s_cbranch_scc1 L_ch_last
    v_mfma_f32_16x16x16_bf16 v[112:115], v[36:37], v[124:125], v[112:115]
    ds_read_b128 v[92:95], v0 offset:3072
    s_add_u32 s33, s33, 131072
    v_mfma_f32_16x16x16_bf16 v[40:43], v[122:123], v[124:125], v[40:43]
    s_add_u32 s30, s30, 262144
    s_add_u32 s31, s31, 262144
    v_mfma_f32_16x16x16_bf16 v[44:47], v[122:123], v[126:127], v[44:47]
    s_nop 1
L_ch_pvdone0:
    v_rcp_f32 v35, v112
    v_cmp_ngt_f32 vcc, s98, v112
    v_cmp_nlt_f32 s[12:13], s100, v112
    v_pk_mul_f32 v[40:41], v[40:41], v[34:35] op_sel:[0,1] op_sel_hi:[1,1]
    v_pk_mul_f32 v[42:43], v[42:43], v[34:35] op_sel:[0,1] op_sel_hi:[1,1]
    s_nop 0
    v_pk_mul_f32 v[44:45], v[44:45], v[34:35] op_sel:[0,1] op_sel_hi:[1,1]
    v_pk_mul_f32 v[46:47], v[46:47], v[34:35] op_sel:[0,1] op_sel_hi:[1,1]
    v_cvt_pk_bf16_f32 v108, v40, v41
    v_cvt_pk_bf16_f32 v109, v42, v43
    v_cvt_pk_bf16_f32 v110, v44, v45
    v_cvt_pk_bf16_f32 v111, v46, v47
    ds_write_b128 v8, v[108:111]
    s_or_b64 vcc, vcc, s[12:13]
    s_and_b64 vcc, vcc, s[38:39]
    s_cbranch_scc1 L_ch_slow0
    v_mfma_f32_32x32x1_2b_f32 v[16:47], v125, v125, 0
    s_mov_b64 s[38:39], s[50:51]
    ds_read_b128 v[48:51], v0 offset:4096
    ds_read_b128 v[52:55], v0 offset:5120
    s_waitcnt lgkmcnt(2)
    s_barrier
    ds_read_b128 v[96:99], v9
    ds_read_b128 v[100:103], v9 offset:1024
    s_add_u32 s27, s27, 8192
    s_add_u32 s24, s24, 8192
    s_mov_b32 m0, s82
    s_nop 0
    s_add_u32 s18, s18, 1
    s_mov_b32 s21, 0
    s_nop 5
    s_waitcnt lgkmcnt(1)
    v_smfmac_f32_16x16x64_bf16 v[16:19], v[96:99], v[80:87], v2
    ds_read_b128 v[56:59], v0 offset:6144
    v_smfmac_f32_16x16x64_bf16 v[20:23], v[96:99], v[88:95], v2
    s_waitcnt lgkmcnt(1)
    ds_read_b128 v[60:63], v0 offset:7168
    v_smfmac_f32_16x16x64_bf16 v[16:19], v[100:103], a[0:7], v2
    ds_read_b128 v[64:67], v0 offset:32768
    v_smfmac_f32_16x16x64_bf16 v[20:23], v[100:103], a[8:15], v2
    ds_read_b128 v[68:71], v0 offset:33792
    v_smfmac_f32_16x16x64_bf16 v[24:27], v[96:99], v[48:55], v2
    ds_read_b128 v[72:75], v0 offset:34816
    v_smfmac_f32_16x16x64_bf16 v[24:27], v[100:103], a[16:23], v2
    ds_read_b128 v[76:79], v0 offset:35840
    s_waitcnt lgkmcnt(4)
    v_smfmac_f32_16x16x64_bf16 v[28:31], v[96:99], v[56:63], v2
    ds_read_b128 v[80:83], v0 offset:36864
    v_smfmac_f32_16x16x64_bf16 v[28:31], v[100:103], a[24:31], v2
    ds_read_b128 v[84:87], v0 offset:37888
    s_waitcnt lgkmcnt(4)
    v_pk_add_f32 v[16:17], v[16:17], v[18:19]
    v_cvt_pk_bf16_f32 v104, v16, v17
    v_bfi_b32 v104, 1, s25, v104
    v_pk_add_f32 v[20:21], v[20:21], v[22:23]
    v_cvt_pk_bf16_f32 v105, v20, v21
    v_pk_add_f32 v[24:25], v[24:25], v[26:27]
    v_cvt_pk_bf16_f32 v106, v24, v25
    v_bfi_b32 v106, 1, s25, v106
    v_pk_add_f32 v[28:29], v[28:29], v[30:31]
    v_cvt_pk_bf16_f32 v107, v28, v29
    v_smfmac_f32_16x16x64_bf16 v[32:35], v[96:99], v[64:71], v2
    buffer_store_dwordx2 v[104:105], v3, s[4:7], s22 offen offset:0
    ds_read_b128 v[88:91], v0 offset:38912
    v_smfmac_f32_16x16x64_bf16 v[32:35], v[100:103], a[32:39], v2
    buffer_store_dwordx2 v[106:107], v3, s[4:7], s22 offen offset:2048
    ds_read_b128 v[92:95], v0 offset:39936
    s_waitcnt lgkmcnt(4)
    v_smfmac_f32_16x16x64_bf16 v[36:39], v[96:99], v[72:79], v2
    v_smfmac_f32_16x16x64_bf16 v[36:39], v[100:103], a[40:47], v2
    s_waitcnt lgkmcnt(2)
    v_smfmac_f32_16x16x64_bf16 v[40:43], v[96:99], v[80:87], v2
    s_nop 0
    v_add_f32 v32, v32, v34
    v_smfmac_f32_16x16x64_bf16 v[40:43], v[100:103], a[48:55], v2
    s_waitcnt lgkmcnt(0)
    v_add_f32 v33, v33, v35
    v_cvt_pk_bf16_f32 v108, v32, v33
    v_smfmac_f32_16x16x64_bf16 v[44:47], v[96:99], v[88:95], v2
    v_bfi_b32 v108, 1, s25, v108
    v_add_f32 v36, v36, v38
    v_smfmac_f32_16x16x64_bf16 v[44:47], v[100:103], a[56:63], v2
    v_add_f32 v37, v37, v39
    v_cvt_pk_bf16_f32 v109, v36, v37
    buffer_store_dwordx2 v[108:109], v3, s[4:7], s23 offen offset:0
    v_pk_add_f32 v[40:41], v[40:41], v[42:43]
    v_cvt_pk_bf16_f32 v110, v40, v41
    v_bfi_b32 v110, 1, s25, v110
    s_nop 1
    v_pk_add_f32 v[44:45], v[44:45], v[46:47]
    v_cvt_pk_bf16_f32 v111, v44, v45
    buffer_store_dwordx2 v[110:111], v3, s[4:7], s23 offen offset:2048
    v_cndmask_b32 v116, 0, v11, s[72:73]
    v_cndmask_b32 v117, 0, v11, s[74:75]
    v_cndmask_b32 v118, 0, v11, s[76:77]
    v_cndmask_b32 v119, 0, v11, s[78:79]
    s_nop 3
    s_nop 3
    s_nop 3
    s_nop 3
    s_nop 3
    s_nop 3
    s_nop 3
    s_nop 3
    buffer_load_dwordx4 v[40:43], v1, s[4:7], s41 offen sc1
    buffer_load_dwordx4 v[44:47], v1, s[4:7], s41 offen offset:1024 sc1
    v_mov_b64 v[96:97], 0
    v_mov_b64 v[98:99], 0
    v_mov_b64 v[100:101], 0
    v_mov_b64 v[102:103], 0
    v_mov_b64 v[104:105], 0
    v_mov_b64 v[106:107], 0
    v_mov_b64 v[108:109], 0
    v_mov_b64 v[110:111], 0
    ds_read_b128 v[64:67], v10 offset:0
    ds_read_b128 v[68:71], v10 offset:1024
    ds_read_b128 v[72:75], v10 offset:2048
    ds_read_b128 v[76:79], v10 offset:3072
    s_waitcnt vmcnt(1)
    v_mfma_f32_16x16x32_bf16 v[112:115], v[116:119], v[40:43], 0
    v_bitop3_b32 v14, v40, v42, s25 bitop3:0x7e
    s_waitcnt vmcnt(0)
    v_mfma_f32_16x16x32_bf16 v[112:115], v[116:119], v[44:47], v[112:115]
    v_bitop3_b32 v15, v44, v46, s25 bitop3:0x7e
    v_bitop3_b32 v14, v14, v15, 1 bitop3:0xa8
    v_cmp_ne_u32 vcc, 0, v14
    s_cbranch_vccnz L_ch_r0
L_ch_rok0:
    s_nop 3
    v_add_f32_dpp v112, v112, v112 row_ror:4 row_mask:0xf bank_mask:0xf
    v_add_f32_dpp v113, v113, v113 row_ror:4 row_mask:0xf bank_mask:0xf
    s_nop 0
    v_add_f32_dpp v112, v112, v112 row_ror:8 row_mask:0xf bank_mask:0xf
    v_add_f32_dpp v113, v113, v113 row_ror:8 row_mask:0xf bank_mask:0xf
    v_cvt_pk_bf16_f32 v124, v112, v113
    buffer_store_dword v124, v7, s[4:7], s28 offen
    ds_read_b128 v[48:51], v10 offset:4096
    ds_read_b128 v[52:55], v10 offset:5120
    ds_read_b128 v[56:59], v10 offset:6144
    ds_read_b128 v[60:63], v10 offset:7168
    v_mov_b64 v[112:113], 0
    v_mov_b64 v[114:115], 0
    v_mov_b64 v[116:117], 0
    v_mov_b64 v[118:119], 0
    s_add_u32 s28, s28, 8192
    s_add_u32 s29, s29, 8192
    s_xor_b32 s25, s25, 1
    s_waitcnt lgkmcnt(0)
    s_mov_b32 s21, 0
    s_nop 3
    s_nop 3
    s_nop 3
    buffer_load_dwordx4 v[16:19], v1, s[4:7], s27 offen offset:0 sc1
    buffer_load_dwordx4 v[20:23], v1, s[4:7], s27 offen offset:1024 sc1
    s_nop 3
    s_nop 3
    s_nop 3
    s_nop 3
    s_cmp_lg_u32 s18, s36
    s_cbranch_scc1 L_ch_step0
    s_cmp_eq_u32 s18, 7
    s_cbranch_scc0 L_ch_wc0
    s_mov_b32 s36, 31
    v_mov_b32 v14, 0
    s_mov_b32 s21, 0
L_ch_wb0:
    buffer_load_dword v15, v14, s[8:11], 0 offen offset:144 sc1
    s_add_u32 s21, s21, 1
    s_cmp_gt_u32 s21, 200000
    s_cbranch_scc1 L_ch_wb0_x
    s_waitcnt vmcnt(0)
    v_cmp_gt_u32 vcc, 96, v15
    s_cbranch_vccz L_ch_wb0_x
    s_sleep 4
    s_branch L_ch_wb0
L_ch_wb0_x:
    s_waitcnt vmcnt(0)
    s_mov_b32 s21, 0
    s_branch L_ch_step0
L_ch_wc0:
    v_mov_b32 v14, 0
    s_mov_b32 s21, 0
L_ch_wd0:
    buffer_load_dword v15, v14, s[8:11], 0 offen offset:148 sc1
    s_add_u32 s21, s21, 1
    s_cmp_gt_u32 s21, 200000
    s_cbranch_scc1 L_ch_wd0_x
    s_waitcnt vmcnt(0)
    v_cmp_gt_u32 vcc, 128, v15
    s_cbranch_vccz L_ch_wd0_x
    s_sleep 4
    s_branch L_ch_wd0
L_ch_wd0_x:
    s_waitcnt vmcnt(0)
    s_mov_b32 s21, 0
    s_branch L_ch_step0
L_ch_r0:
    buffer_load_dwordx4 v[40:43], v1, s[4:7], s41 offen sc1
    buffer_load_dwordx4 v[44:47], v1, s[4:7], s41 offen offset:1024 sc1
    s_add_u32 s21, s21, 1
    s_cmp_gt_u32 s21, 200000
    s_cbranch_scc1 L_ch_fail
    s_waitcnt vmcnt(1)
    v_mfma_f32_16x16x32_bf16 v[112:115], v[116:119], v[40:43], 0
    v_bitop3_b32 v14, v40, v42, s25 bitop3:0x7e
    s_waitcnt vmcnt(0)
    v_mfma_f32_16x16x32_bf16 v[112:115], v[116:119], v[44:47], v[112:115]
    v_bitop3_b32 v15, v44, v46, s25 bitop3:0x7e
    v_bitop3_b32 v14, v14, v15, 1 bitop3:0xa8
    v_cmp_ne_u32 vcc, 0, v14
    s_cbranch_vccnz L_ch_r0
    s_nop 3
    s_branch L_ch_rok0
L_ch_torn0:
    s_nop 7
    v_mov_b64 v[96:97], 0
    v_mov_b64 v[98:99], 0
    v_mov_b64 v[100:101], 0
    v_mov_b64 v[102:103], 0
    v_mov_b64 v[104:105], 0
    v_mov_b64 v[106:107], 0
    v_mov_b64 v[108:109], 0
    v_mov_b64 v[110:111], 0
    v_mov_b64 v[112:113], 0
    v_mov_b64 v[114:115], 0
    v_mov_b64 v[116:117], 0
    v_mov_b64 v[118:119], 0
    s_branch L_ch_g0
L_ch_gf0:
    s_mov_b32 s21, 0
    buffer_load_dwordx4 v[32:35], v1, s[4:7], s24 offen offset:0 sc1
    buffer_load_dwordx4 v[36:39], v1, s[4:7], s24 offen offset:1024 sc1
    s_nop 15
L_ch_gp0:
    buffer_load_dwordx4 v[32:35], v1, s[4:7], s24 offen offset:0 sc1
    buffer_load_dwordx4 v[36:39], v1, s[4:7], s24 offen offset:1024 sc1
    s_add_u32 s21, s21, 1
    s_cmp_gt_u32 s21, 200000
    s_cbranch_scc1 L_ch_fail
    s_waitcnt vmcnt(2)
    v_cmp_u_f32 vcc, v32, v36
    s_cbranch_vccnz L_ch_gp0
    s_branch L_ch_gk0
L_ch_slow0:
    s_mov_b64 s[38:39], 0
    s_nop 7
    v_max3_f32 v34, v96, v97, v98
    v_max3_f32 v34, v34, v99, v100
    v_max3_f32 v34, v34, v101, v102
    v_max3_f32 v34, v34, v103, v104
    v_max_f32 v34, v34, v105
    v_mov_b32 v35, v34
    s_nop 1
    v_permlane32_swap_b32 v34, v35
    v_max_f32 v34, v34, v35
    v_mov_b32 v35, v34
    s_nop 1
    v_permlane16_swap_b32 v34, v35
    v_max_f32 v34, v34, v35
    v_sub_f32 v24, v96, v34
    v_sub_f32 v25, v97, v34
    v_sub_f32 v26, v98, v34
    v_sub_f32 v27, v99, v34
    v_sub_f32 v28, v100, v34
    v_sub_f32 v29, v101, v34
    v_sub_f32 v30, v102, v34
    v_sub_f32 v31, v103, v34
    v_sub_f32 v32, v104, v34
    v_sub_f32 v33, v105, v34
    v_exp_f32 v24, v24
    v_exp_f32 v25, v25
    v_exp_f32 v26, v26
    v_exp_f32 v27, v27
    v_exp_f32 v28, v28
    v_exp_f32 v29, v29
    v_exp_f32 v30, v30
    v_exp_f32 v31, v31
    v_exp_f32 v32, v32
    v_exp_f32 v33, v33
    v_cvt_pk_bf16_f32 v108, v24, v25
    v_cvt_pk_bf16_f32 v109, v26, v27
    v_cvt_pk_bf16_f32 v110, v28, v29
    v_cvt_pk_bf16_f32 v111, v30, v31
    v_cvt_pk_bf16_f32 v124, v32, v33
    v_cvt_pk_bf16_f32 v127, v32, v33
    v_mfma_f32_16x16x32_bf16 v[112:115], v[36:39], v[108:111], 0
    v_mfma_f32_16x16x32_bf16 v[40:43], v[16:19], v[108:111], 0
    v_mfma_f32_16x16x32_bf16 v[44:47], v[20:23], v[108:111], 0
    s_nop 3
    v_mfma_f32_16x16x16_bf16 v[112:115], v[36:37], v[124:125], v[112:115]
    v_mfma_f32_16x16x16_bf16 v[40:43], v[122:123], v[124:125], v[40:43]
    v_mfma_f32_16x16x16_bf16 v[44:47], v[122:123], v[126:127], v[44:47]
    s_nop 7
    s_branch L_ch_pvdone0
.p2align 6
L_ch_step1:
L_ch_g1:
    buffer_load_dwordx4 v[24:27], v1, s[4:7], s27 offen offset:2048 sc1
    buffer_load_dwordx4 v[28:31], v1, s[4:7], s27 offen offset:3072 sc1
    s_add_u32 s21, s21, 1
    s_cmp_gt_u32 s21, 200000
    s_cbranch_scc1 L_ch_fail
    s_waitcnt vmcnt(2)
    v_cmp_u_f32 vcc, v24, v28
    s_cbranch_vccnz L_ch_g1
    ds_write_b128 v1, v[24:27] offset:2048
    ds_write_b128 v1, v[28:31] offset:3072
    v_smfmac_f32_16x16x64_bf16 v[104:107], v[24:27], a[176:183], v2
    v_cmp_u_f32 s[12:13], v25, v29
    v_smfmac_f32_16x16x64_bf16 v[108:111], v[24:27], a[184:191], v2
    v_cmp_u_f32 s[14:15], v26, v30
    v_smfmac_f32_16x16x64_bf16 v[96:99], v[24:27], v[48:55], v2
    s_or_b64 s[12:13], s[12:13], s[14:15]
    buffer_load_dwordx4 v[40:43], v1, s[4:7], s24 offen offset:2048 sc1
    buffer_load_dwordx4 v[44:47], v1, s[4:7], s24 offen offset:3072 sc1
    v_cmp_u_f32 vcc, v27, v31
    v_smfmac_f32_16x16x64_bf16 v[100:103], v[24:27], v[56:63], v2
    s_or_b64 s[12:13], s[12:13], vcc
    s_cbranch_scc1 L_ch_torn1
    v_smfmac_f32_16x16x64_bf16 v[96:99], v[28:31], a[80:87], v2
    s_waitcnt lgkmcnt(0)
    s_barrier
    ds_read_b128 v[16:19], v1 offset:0
    ds_read_b128 v[20:23], v1 offset:1024
    v_smfmac_f32_16x16x64_bf16 v[100:103], v[28:31], a[88:95], v2
    ds_read_b128 v[48:51], v10 offset:36864
    v_smfmac_f32_16x16x64_bf16 v[104:107], v[28:31], a[208:215], v2
    ds_read_b128 v[52:55], v10 offset:37888
    v_smfmac_f32_16x16x64_bf16 v[108:111], v[28:31], a[216:223], v2
    ds_read_b128 v[56:59], v10 offset:38912
    s_waitcnt lgkmcnt(4)
    v_smfmac_f32_16x16x64_bf16 v[104:107], v[16:19], a[160:167], v2
    ds_read_b128 v[60:63], v10 offset:39936
    v_smfmac_f32_16x16x64_bf16 v[108:111], v[16:19], a[168:175], v2
    ds_read_b128 v[80:83], v1 offset:8192
    v_smfmac_f32_16x16x64_bf16 v[96:99], v[16:19], v[64:71], v2
    ds_read_b128 v[84:87], v1 offset:10240
    v_smfmac_f32_16x16x64_bf16 v[100:103], v[16:19], v[72:79], v2
    ds_read_b128 v[88:91], v1 offset:12288
    s_waitcnt lgkmcnt(7)
    v_smfmac_f32_16x16x64_bf16 v[96:99], v[20:23], a[64:71], v2
    ds_read_b128 v[64:67], v10 offset:32768
    v_smfmac_f32_16x16x64_bf16 v[100:103], v[20:23], a[72:79], v2
    ds_read_b128 v[68:71], v10 offset:33792
    v_smfmac_f32_16x16x64_bf16 v[104:107], v[20:23], a[192:199], v2
    ds_read_b128 v[72:75], v10 offset:34816
    v_smfmac_f32_16x16x64_bf16 v[108:111], v[20:23], a[200:207], v2
    ds_read_b128 v[76:79], v10 offset:35840
    v_smfmac_f32_16x16x64_bf16 v[112:115], v[16:19], v[128:135], v2
    s_waitcnt vmcnt(0)
    ds_read_b128 v[92:95], v1 offset:14336
    v_cmp_u_f32 vcc, v40, v44
    v_smfmac_f32_16x16x64_bf16 v[116:119], v[16:19], v[136:143], v2
    s_cbranch_vccnz L_ch_gf1
L_ch_gk1:
    ds_write_b128 v1, v[40:43] offset:6144
    v_smfmac_f32_16x16x64_bf16 v[112:115], v[20:23], v[160:167], v2
    ds_write_b128 v1, v[44:47] offset:7168
    v_smfmac_f32_16x16x64_bf16 v[116:119], v[20:23], v[168:175], v2
    buffer_store_dwordx4 v[120:123], v1, s[4:7], s35 offen sc1
    v_smfmac_f32_16x16x64_bf16 v[96:99], v[40:43], a[112:119], v2
    ds_read_b128 v[16:19], v5 offset:16384
    v_smfmac_f32_16x16x64_bf16 v[100:103], v[40:43], a[120:127], v2
    buffer_load_dword v13, v7, s[4:7], s29 offen sc1
    s_waitcnt lgkmcnt(1)
    s_barrier
    ds_read_b128 v[32:35], v1 offset:4096
    v_smfmac_f32_16x16x64_bf16 v[104:107], v[40:43], v[48:55], v2
    ds_read_b128 v[36:39], v1 offset:5120
    v_smfmac_f32_16x16x64_bf16 v[108:111], v[40:43], v[56:63], v2
    ds_read_b128 v[20:23], v5 offset:17408
    v_smfmac_f32_16x16x64_bf16 v[96:99], v[44:47], a[144:151], v2
    ds_read_b128 v[48:51], v1 offset:9216
    v_smfmac_f32_16x16x64_bf16 v[100:103], v[44:47], a[152:159], v2
    ds_read_b128 v[52:55], v1 offset:11264
    v_smfmac_f32_16x16x64_bf16 v[104:107], v[44:47], a[240:247], v2
    ds_read_b128 v[56:59], v1 offset:13312
    v_smfmac_f32_16x16x64_bf16 v[108:111], v[44:47], a[248:255], v2
    s_waitcnt lgkmcnt(3)
    buffer_load_dwordx4 v1, s[4:7], s31 offen sc1  lds
    ds_read_b128 v[60:63], v1 offset:15360
    v_smfmac_f32_16x16x64_bf16 v[96:99], v[32:35], a[96:103], v2
    v_smfmac_f32_16x16x64_bf16 v[96:99], v[36:39], a[128:135], v2
    s_nop 0
    v_smfmac_f32_16x16x64_bf16 v[100:103], v[32:35], a[104:111], v2
    s_nop 0
    v_smfmac_f32_16x16x64_bf16 v[100:103], v[36:39], a[136:143], v2
    buffer_load_dwordx4 v1, s[4:7], s31 offen offset:1024 sc1  lds
    s_mov_b32 m0, s81
    s_nop 0
    s_nop 0
    v_add_f32 v96, v96, v98
    v_smfmac_f32_16x16x64_bf16 v[104:107], v[32:35], v[64:71], v2
    v_add_f32 v97, v97, v99
    v_mul_f32 v96, s34, v96
    v_smfmac_f32_16x16x64_bf16 v[104:107], v[36:39], a[224:231], v2
    v_mul_f32 v97, s34, v97
    v_cvt_pk_bf16_f32 v96, v96, v97
    v_smfmac_f32_16x16x64_bf16 v[108:111], v[32:35], v[72:79], v2
    v_add_f32 v100, v100, v102
    v_add_f32 v101, v101, v103
    v_smfmac_f32_16x16x64_bf16 v[108:111], v[36:39], a[232:239], v2
    v_mul_f32 v100, s34, v100
    v_mul_f32 v101, s34, v101
    v_smfmac_f32_16x16x64_bf16 v[112:115], v[24:27], v[144:151], v2
    v_cvt_pk_bf16_f32 v100, v100, v101
    v_add_f32 v104, v104, v106
    v_smfmac_f32_16x16x64_bf16 v[116:119], v[24:27], v[152:159], v2
    ds_write2_b32 v6, v96, v100 offset0:1 offset1:129
    v_add_f32 v105, v105, v107
    v_cvt_pk_bf16_f32 v120, v104, v105
    v_add_f32 v108, v108, v110
    v_add_f32 v109, v109, v111
    v_cvt_pk_bf16_f32 v121, v108, v109
    ds_write2_b32 v6, v120, v121 offset0:0 offset1:128
    v_smfmac_f32_16x16x64_bf16 v[112:115], v[28:31], v[176:183], v2
    s_waitcnt vmcnt(4)
    v_smfmac_f32_16x16x64_bf16 v[116:119], v[28:31], v[184:191], v2
    v_smfmac_f32_16x16x64_bf16 v[112:115], v[32:35], v[192:199], v2
    v_smfmac_f32_16x16x64_bf16 v[116:119], v[32:35], v[200:207], v2
    s_waitcnt lgkmcnt(0)
    s_barrier
    ds_read_b64_tr_b16 v[64:65], v4 offset:26624
    ds_read_b64_tr_b16 v[66:67], v4 offset:27136
    v_smfmac_f32_16x16x64_bf16 v[112:115], v[36:39], v[224:231], v2
    ds_read_b64_tr_b16 v[68:69], v4 offset:27648
    ds_read_b64_tr_b16 v[70:71], v4 offset:28160
    v_smfmac_f32_16x16x64_bf16 v[116:119], v[36:39], v[232:239], v2
    ds_read_b64_tr_b16 v[72:73], v4 offset:28672
    ds_read_b64_tr_b16 v[74:75], v4 offset:29184
    v_smfmac_f32_16x16x64_bf16 v[112:115], v[40:43], v[208:215], v2
    ds_read_b64_tr_b16 v[76:77], v4 offset:29696
    ds_read_b64_tr_b16 v[78:79], v4 offset:30208
    v_smfmac_f32_16x16x64_bf16 v[116:119], v[40:43], v[216:223], v2
    v_smfmac_f32_16x16x64_bf16 v[112:115], v[44:47], v[240:247], v2
    v_mov_b64 v[36:37], s[44:45]
    v_smfmac_f32_16x16x64_bf16 v[116:119], v[44:47], v[248:255], v2
    s_waitcnt lgkmcnt(4)
    v_mov_b64 v[38:39], s[44:45]
    v_mfma_f32_16x16x32_bf16 v[96:99], v[80:83], v[64:67], 0
    s_nop 0
    s_mov_b32 s35, s33
    v_mfma_f32_16x16x32_bf16 v[96:99], v[84:87], v[68:71], v[96:99]
    buffer_load_dwordx4 v1, s[4:7], s30 offen sc1  lds
    s_waitcnt lgkmcnt(0)
    v_mfma_f32_16x16x32_bf16 v[96:99], v[88:91], v[72:75], v[96:99]
    v_add_f32 v112, v112, v114
    v_add_f32 v113, v113, v115
    v_mfma_f32_16x16x32_bf16 v[96:99], v[92:95], v[76:79], v[96:99]
    v_cvt_pk_bf16_f32 v122, v112, v113
    v_add_f32 v116, v116, v118
    v_mfma_f32_16x16x32_bf16 v[100:103], v[48:51], v[64:67], 0
    ds_read_b128 v[80:83], v0 offset:0
    v_add_f32 v117, v117, v119
    v_cvt_pk_bf16_f32 v123, v116, v117
    v_mfma_f32_16x16x32_bf16 v[100:103], v[52:55], v[68:71], v[100:103]
    ds_read_b128 v[84:87], v0 offset:1024
    buffer_load_dwordx4 v1, s[4:7], s30 offen offset:1024 sc1  lds
    v_mfma_f32_16x16x32_bf16 v[100:103], v[56:59], v[72:75], v[100:103]
    v_exp_f32 v24, v96
    v_mfma_f32_16x16x32_bf16 v[100:103], v[60:63], v[76:79], v[100:103]
    v_exp_f32 v25, v97
    v_mfma_f32_16x16x32_bf16 v[104:107], v[64:67], v[64:67], 0
    v_exp_f32 v26, v98
    v_mfma_f32_16x16x32_bf16 v[104:107], v[68:71], v[68:71], v[104:107]
    v_exp_f32 v27, v99
    v_mfma_f32_16x16x32_bf16 v[104:107], v[72:75], v[72:75], v[104:107]
    v_cvt_pk_bf16_f32 v108, v24, v25
    v_cvt_pk_bf16_f32 v109, v26, v27
    v_mfma_f32_16x16x32_bf16 v[104:107], v[76:79], v[76:79], v[104:107]
    v_exp_f32 v28, v100
    v_exp_f32 v29, v101
    v_exp_f32 v30, v102
    v_exp_f32 v31, v103
    v_cvt_pk_bf16_f32 v110, v28, v29
    v_cvt_pk_bf16_f32 v111, v30, v31
    s_cmp_eq_u32 s18, 63
    s_nop 0
    v_mfma_f32_16x16x32_bf16 v[112:115], v[36:39], v[108:111], 0
    v_exp_f32 v32, v104
    v_mfma_f32_16x16x32_bf16 v[40:43], v[16:19], v[108:111], 0
    v_exp_f32 v33, v105
    v_mfma_f32_16x16x32_bf16 v[44:47], v[20:23], v[108:111], 0
    v_cvt_pk_bf16_f32 v124, v32, v33
    v_cvt_pk_bf16_f32 v127, v32, v33
    ds_read_b128 v[88:91], v0 offset:2048
    s_cbranch_scc1 L_ch_last
    v_mfma_f32_16x16x16_bf16 v[112:115], v[36:37], v[124:125], v[112:115]
    ds_read_b128 v[92:95], v0 offset:3072
    s_add_u32 s33, s33, 131072
    v_mfma_f32_16x16x16_bf16 v[40:43], v[122:123], v[124:125], v[40:43]
    s_add_u32 s30, s30, 262144
    s_add_u32 s31, s31, 262144
    v_mfma_f32_16x16x16_bf16 v[44:47], v[122:123], v[126:127], v[44:47]
    s_nop 1
L_ch_pvdone1:
    v_rcp_f32 v35, v112
    v_cmp_ngt_f32 vcc, s98, v112
    v_cmp_nlt_f32 s[12:13], s100, v112
    v_pk_mul_f32 v[40:41], v[40:41], v[34:35] op_sel:[0,1] op_sel_hi:[1,1]
    v_pk_mul_f32 v[42:43], v[42:43], v[34:35] op_sel:[0,1] op_sel_hi:[1,1]
    s_nop 0
    v_pk_mul_f32 v[44:45], v[44:45], v[34:35] op_sel:[0,1] op_sel_hi:[1,1]
    v_pk_mul_f32 v[46:47], v[46:47], v[34:35] op_sel:[0,1] op_sel_hi:[1,1]
    v_cvt_pk_bf16_f32 v108, v40, v41
    v_cvt_pk_bf16_f32 v109, v42, v43
    v_cvt_pk_bf16_f32 v110, v44, v45
    v_cvt_pk_bf16_f32 v111, v46, v47
    ds_write_b128 v8, v[108:111]
    s_or_b64 vcc, vcc, s[12:13]
    s_and_b64 vcc, vcc, s[38:39]
    s_cbranch_scc1 L_ch_slow1
    v_mfma_f32_32x32x1_2b_f32 v[16:47], v125, v125, 0
    s_mov_b64 s[38:39], s[50:51]
    ds_read_b128 v[48:51], v0 offset:4096
    ds_read_b128 v[52:55], v0 offset:5120
    s_waitcnt lgkmcnt(2)
    s_barrier
    ds_read_b128 v[96:99], v9
    ds_read_b128 v[100:103], v9 offset:1024
    s_add_u32 s27, s27, 8192
    s_add_u32 s24, s24, 8192
    s_mov_b32 m0, s82
    s_nop 0
    s_add_u32 s18, s18, 1
    s_mov_b32 s21, 0
    s_nop 5
    s_waitcnt lgkmcnt(1)
    v_smfmac_f32_16x16x64_bf16 v[16:19], v[96:99], v[80:87], v2
    ds_read_b128 v[56:59], v0 offset:6144
    v_smfmac_f32_16x16x64_bf16 v[20:23], v[96:99], v[88:95], v2
    s_waitcnt lgkmcnt(1)
    ds_read_b128 v[60:63], v0 offset:7168
    v_smfmac_f32_16x16x64_bf16 v[16:19], v[100:103], a[0:7], v2
    ds_read_b128 v[64:67], v0 offset:32768
    v_smfmac_f32_16x16x64_bf16 v[20:23], v[100:103], a[8:15], v2
    ds_read_b128 v[68:71], v0 offset:33792
    v_smfmac_f32_16x16x64_bf16 v[24:27], v[96:99], v[48:55], v2
    ds_read_b128 v[72:75], v0 offset:34816
    v_smfmac_f32_16x16x64_bf16 v[24:27], v[100:103], a[16:23], v2
    ds_read_b128 v[76:79], v0 offset:35840
    s_waitcnt lgkmcnt(4)
    v_smfmac_f32_16x16x64_bf16 v[28:31], v[96:99], v[56:63], v2
    ds_read_b128 v[80:83], v0 offset:36864
    v_smfmac_f32_16x16x64_bf16 v[28:31], v[100:103], a[24:31], v2
    ds_read_b128 v[84:87], v0 offset:37888
    s_waitcnt lgkmcnt(4)
    v_pk_add_f32 v[16:17], v[16:17], v[18:19]
    v_cvt_pk_bf16_f32 v104, v16, v17
    v_bfi_b32 v104, 1, s25, v104
    v_pk_add_f32 v[20:21], v[20:21], v[22:23]
    v_cvt_pk_bf16_f32 v105, v20, v21
    v_pk_add_f32 v[24:25], v[24:25], v[26:27]
    v_cvt_pk_bf16_f32 v106, v24, v25
    v_bfi_b32 v106, 1, s25, v106
    v_pk_add_f32 v[28:29], v[28:29], v[30:31]
    v_cvt_pk_bf16_f32 v107, v28, v29
    v_smfmac_f32_16x16x64_bf16 v[32:35], v[96:99], v[64:71], v2
    buffer_store_dwordx2 v[104:105], v3, s[4:7], s22 offen offset:0
    ds_read_b128 v[88:91], v0 offset:38912
    v_smfmac_f32_16x16x64_bf16 v[32:35], v[100:103], a[32:39], v2
    buffer_store_dwordx2 v[106:107], v3, s[4:7], s22 offen offset:2048
    ds_read_b128 v[92:95], v0 offset:39936
    s_waitcnt lgkmcnt(4)
    v_smfmac_f32_16x16x64_bf16 v[36:39], v[96:99], v[72:79], v2
    v_smfmac_f32_16x16x64_bf16 v[36:39], v[100:103], a[40:47], v2
    s_waitcnt lgkmcnt(2)
    v_smfmac_f32_16x16x64_bf16 v[40:43], v[96:99], v[80:87], v2
    s_nop 0
    v_add_f32 v32, v32, v34
    v_smfmac_f32_16x16x64_bf16 v[40:43], v[100:103], a[48:55], v2
    s_waitcnt lgkmcnt(0)
    v_add_f32 v33, v33, v35
    v_cvt_pk_bf16_f32 v108, v32, v33
    v_smfmac_f32_16x16x64_bf16 v[44:47], v[96:99], v[88:95], v2
    v_bfi_b32 v108, 1, s25, v108
    v_add_f32 v36, v36, v38
    v_smfmac_f32_16x16x64_bf16 v[44:47], v[100:103], a[56:63], v2
    v_add_f32 v37, v37, v39
    v_cvt_pk_bf16_f32 v109, v36, v37
    buffer_store_dwordx2 v[108:109], v3, s[4:7], s23 offen offset:0
    v_pk_add_f32 v[40:41], v[40:41], v[42:43]
    v_cvt_pk_bf16_f32 v110, v40, v41
    v_bfi_b32 v110, 1, s25, v110
    s_nop 1
    v_pk_add_f32 v[44:45], v[44:45], v[46:47]
    v_cvt_pk_bf16_f32 v111, v44, v45
    buffer_store_dwordx2 v[110:111], v3, s[4:7], s23 offen offset:2048
    v_cndmask_b32 v116, 0, v11, s[72:73]
    v_cndmask_b32 v117, 0, v11, s[74:75]
    v_cndmask_b32 v118, 0, v11, s[76:77]
    v_cndmask_b32 v119, 0, v11, s[78:79]
    s_nop 3
    s_nop 3
    s_nop 3
    s_nop 3
    s_nop 3
    s_nop 3
    s_nop 3
    s_nop 3
    s_nop 3
    s_nop 3
    buffer_load_dwordx4 v[40:43], v1, s[4:7], s41 offen sc1
    buffer_load_dwordx4 v[44:47], v1, s[4:7], s41 offen offset:1024 sc1
    v_mov_b64 v[96:97], 0
    v_mov_b64 v[98:99], 0
    v_mov_b64 v[100:101], 0
    v_mov_b64 v[102:103], 0
    v_mov_b64 v[104:105], 0
    v_mov_b64 v[106:107], 0
    v_mov_b64 v[108:109], 0
    v_mov_b64 v[110:111], 0
    ds_read_b128 v[64:67], v10 offset:0
    ds_read_b128 v[68:71], v10 offset:1024
    ds_read_b128 v[72:75], v10 offset:2048
    ds_read_b128 v[76:79], v10 offset:3072
    s_waitcnt vmcnt(1)
    v_mfma_f32_16x16x32_bf16 v[112:115], v[116:119], v[40:43], 0
    v_bitop3_b32 v14, v40, v42, s25 bitop3:0x7e
    s_waitcnt vmcnt(0)
    v_mfma_f32_16x16x32_bf16 v[112:115], v[116:119], v[44:47], v[112:115]
    v_bitop3_b32 v15, v44, v46, s25 bitop3:0x7e
    v_bitop3_b32 v14, v14, v15, 1 bitop3:0xa8
    v_cmp_ne_u32 vcc, 0, v14
    s_cbranch_vccnz L_ch_r1
L_ch_rok1:
    s_nop 3
    v_add_f32_dpp v112, v112, v112 row_ror:4 row_mask:0xf bank_mask:0xf
    v_add_f32_dpp v113, v113, v113 row_ror:4 row_mask:0xf bank_mask:0xf
    s_nop 0
    v_add_f32_dpp v112, v112, v112 row_ror:8 row_mask:0xf bank_mask:0xf
    v_add_f32_dpp v113, v113, v113 row_ror:8 row_mask:0xf bank_mask:0xf
    v_cvt_pk_bf16_f32 v124, v112, v113
    buffer_store_dword v124, v7, s[4:7], s28 offen
    ds_read_b128 v[48:51], v10 offset:4096
    ds_read_b128 v[52:55], v10 offset:5120
    ds_read_b128 v[56:59], v10 offset:6144
    ds_read_b128 v[60:63], v10 offset:7168
    v_mov_b64 v[112:113], 0
    v_mov_b64 v[114:115], 0
    v_mov_b64 v[116:117], 0
    v_mov_b64 v[118:119], 0
    s_add_u32 s28, s28, 8192
    s_add_u32 s29, s29, 8192
    s_xor_b32 s25, s25, 1
    s_waitcnt lgkmcnt(0)
    s_mov_b32 s21, 0
    s_nop 3
    s_nop 3
    s_nop 3
    buffer_load_dwordx4 v[24:27], v1, s[4:7], s27 offen offset:2048 sc1
    buffer_load_dwordx4 v[28:31], v1, s[4:7], s27 offen offset:3072 sc1
    s_nop 3
    s_nop 3
    s_nop 3
    s_nop 3
    s_cmp_lg_u32 s18, s36
    s_cbranch_scc1 L_ch_step1
    s_cmp_eq_u32 s18, 7
    s_cbranch_scc0 L_ch_wc1
    s_mov_b32 s36, 31
    v_mov_b32 v14, 0
    s_mov_b32 s21, 0
L_ch_wb1:
    buffer_load_dword v15, v14, s[8:11], 0 offen offset:144 sc1
    s_add_u32 s21, s21, 1
    s_cmp_gt_u32 s21, 200000
    s_cbranch_scc1 L_ch_wb1_x
    s_waitcnt vmcnt(0)
    v_cmp_gt_u32 vcc, 96, v15
    s_cbranch_vccz L_ch_wb1_x
    s_sleep 4
    s_branch L_ch_wb1
L_ch_wb1_x:
    s_waitcnt vmcnt(0)
    s_mov_b32 s21, 0
    s_branch L_ch_step1
L_ch_wc1:
    v_mov_b32 v14, 0
    s_mov_b32 s21, 0
L_ch_wd1:
    buffer_load_dword v15, v14, s[8:11], 0 offen offset:148 sc1
    s_add_u32 s21, s21, 1
    s_cmp_gt_u32 s21, 200000
    s_cbranch_scc1 L_ch_wd1_x
    s_waitcnt vmcnt(0)
    v_cmp_gt_u32 vcc, 128, v15
    s_cbranch_vccz L_ch_wd1_x
    s_sleep 4
    s_branch L_ch_wd1
L_ch_wd1_x:
    s_waitcnt vmcnt(0)
    s_mov_b32 s21, 0
    s_branch L_ch_step1
L_ch_r1:
    buffer_load_dwordx4 v[40:43], v1, s[4:7], s41 offen sc1
    buffer_load_dwordx4 v[44:47], v1, s[4:7], s41 offen offset:1024 sc1
    s_add_u32 s21, s21, 1
    s_cmp_gt_u32 s21, 200000
    s_cbranch_scc1 L_ch_fail
    s_waitcnt vmcnt(1)
    v_mfma_f32_16x16x32_bf16 v[112:115], v[116:119], v[40:43], 0
    v_bitop3_b32 v14, v40, v42, s25 bitop3:0x7e
    s_waitcnt vmcnt(0)
    v_mfma_f32_16x16x32_bf16 v[112:115], v[116:119], v[44:47], v[112:115]
    v_bitop3_b32 v15, v44, v46, s25 bitop3:0x7e
    v_bitop3_b32 v14, v14, v15, 1 bitop3:0xa8
    v_cmp_ne_u32 vcc, 0, v14
    s_cbranch_vccnz L_ch_r1
    s_nop 3
    s_branch L_ch_rok1
L_ch_torn1:
    s_nop 7
    v_mov_b64 v[96:97], 0
    v_mov_b64 v[98:99], 0
    v_mov_b64 v[100:101], 0
    v_mov_b64 v[102:103], 0
    v_mov_b64 v[104:105], 0
    v_mov_b64 v[106:107], 0
    v_mov_b64 v[108:109], 0
    v_mov_b64 v[110:111], 0
    v_mov_b64 v[112:113], 0
    v_mov_b64 v[114:115], 0
    v_mov_b64 v[116:117], 0
    v_mov_b64 v[118:119], 0
    s_branch L_ch_g1
L_ch_gf1:
    s_mov_b32 s21, 0
    buffer_load_dwordx4 v[40:43], v1, s[4:7], s24 offen offset:2048 sc1
    buffer_load_dwordx4 v[44:47], v1, s[4:7], s24 offen offset:3072 sc1
    s_nop 15
L_ch_gp1:
    buffer_load_dwordx4 v[40:43], v1, s[4:7], s24 offen offset:2048 sc1
    buffer_load_dwordx4 v[44:47], v1, s[4:7], s24 offen offset:3072 sc1
    s_add_u32 s21, s21, 1
    s_cmp_gt_u32 s21, 200000
    s_cbranch_scc1 L_ch_fail
    s_waitcnt vmcnt(2)
    v_cmp_u_f32 vcc, v40, v44
    s_cbranch_vccnz L_ch_gp1
    s_branch L_ch_gk1
L_ch_slow1:
    s_mov_b64 s[38:39], 0
    s_nop 7
    v_max3_f32 v34, v96, v97, v98
    v_max3_f32 v34, v34, v99, v100
    v_max3_f32 v34, v34, v101, v102
    v_max3_f32 v34, v34, v103, v104
    v_max_f32 v34, v34, v105
    v_mov_b32 v35, v34
    s_nop 1
    v_permlane32_swap_b32 v34, v35
    v_max_f32 v34, v34, v35
    v_mov_b32 v35, v34
    s_nop 1
    v_permlane16_swap_b32 v34, v35
    v_max_f32 v34, v34, v35
    v_sub_f32 v24, v96, v34
    v_sub_f32 v25, v97, v34
    v_sub_f32 v26, v98, v34
    v_sub_f32 v27, v99, v34
    v_sub_f32 v28, v100, v34
    v_sub_f32 v29, v101, v34
    v_sub_f32 v30, v102, v34
    v_sub_f32 v31, v103, v34
    v_sub_f32 v32, v104, v34
    v_sub_f32 v33, v105, v34
    v_exp_f32 v24, v24
    v_exp_f32 v25, v25
    v_exp_f32 v26, v26
    v_exp_f32 v27, v27
    v_exp_f32 v28, v28
    v_exp_f32 v29, v29
    v_exp_f32 v30, v30
    v_exp_f32 v31, v31
    v_exp_f32 v32, v32
    v_exp_f32 v33, v33
    v_cvt_pk_bf16_f32 v108, v24, v25
    v_cvt_pk_bf16_f32 v109, v26, v27
    v_cvt_pk_bf16_f32 v110, v28, v29
    v_cvt_pk_bf16_f32 v111, v30, v31
    v_cvt_pk_bf16_f32 v124, v32, v33
    v_cvt_pk_bf16_f32 v127, v32, v33
    v_mfma_f32_16x16x32_bf16 v[112:115], v[36:39], v[108:111], 0
    v_mfma_f32_16x16x32_bf16 v[40:43], v[16:19], v[108:111], 0
    v_mfma_f32_16x16x32_bf16 v[44:47], v[20:23], v[108:111], 0
    s_nop 3
    v_mfma_f32_16x16x16_bf16 v[112:115], v[36:37], v[124:125], v[112:115]
    v_mfma_f32_16x16x16_bf16 v[40:43], v[122:123], v[124:125], v[40:43]
    v_mfma_f32_16x16x16_bf16 v[44:47], v[122:123], v[126:127], v[44:47]
    s_nop 7
    s_branch L_ch_pvdone1
.p2align 6
L_ch_step2:
    s_barrier
    ds_read_b128 v[16:19], v1 offset:0
    ds_read_b128 v[20:23], v1 offset:1024
    ds_read_b128 v[24:27], v1 offset:2048
    ds_read_b128 v[28:31], v1 offset:3072
    buffer_store_dwordx4 v[120:123], v1, s[4:7], s35 offen sc1
    buffer_load_dword v13, v7, s[4:7], s29 offen sc1
    s_waitcnt lgkmcnt(3)
    v_smfmac_f32_16x16x64_bf16 v[104:107], v[16:19], a[160:167], v2
    v_smfmac_f32_16x16x64_bf16 v[108:111], v[16:19], a[168:175], v2
    v_smfmac_f32_16x16x64_bf16 v[96:99], v[16:19], v[64:71], v2
    v_smfmac_f32_16x16x64_bf16 v[100:103], v[16:19], v[72:79], v2
    s_waitcnt lgkmcnt(2)
    v_smfmac_f32_16x16x64_bf16 v[96:99], v[20:23], a[64:71], v2
    ds_read_b128 v[64:67], v10 offset:36864
    v_smfmac_f32_16x16x64_bf16 v[100:103], v[20:23], a[72:79], v2
    ds_read_b128 v[68:71], v10 offset:37888
    v_smfmac_f32_16x16x64_bf16 v[104:107], v[20:23], a[192:199], v2
    ds_read_b128 v[72:75], v10 offset:38912
    v_smfmac_f32_16x16x64_bf16 v[108:111], v[20:23], a[200:207], v2
    ds_read_b128 v[76:79], v10 offset:39936
    s_waitcnt lgkmcnt(5)
    v_smfmac_f32_16x16x64_bf16 v[104:107], v[24:27], a[176:183], v2
    ds_read_b128 v[80:83], v1 offset:8192
    v_smfmac_f32_16x16x64_bf16 v[108:111], v[24:27], a[184:191], v2
    ds_read_b128 v[84:87], v1 offset:10240
    v_smfmac_f32_16x16x64_bf16 v[96:99], v[24:27], v[48:55], v2
    ds_read_b128 v[88:91], v1 offset:12288
    v_smfmac_f32_16x16x64_bf16 v[100:103], v[24:27], v[56:63], v2
    ds_read_b128 v[92:95], v1 offset:14336
    s_waitcnt lgkmcnt(8)
    v_smfmac_f32_16x16x64_bf16 v[96:99], v[28:31], a[80:87], v2
    ds_read_b128 v[48:51], v10 offset:32768
    v_smfmac_f32_16x16x64_bf16 v[100:103], v[28:31], a[88:95], v2
    ds_read_b128 v[52:55], v10 offset:33792
    v_smfmac_f32_16x16x64_bf16 v[104:107], v[28:31], a[208:215], v2
    ds_read_b128 v[56:59], v10 offset:34816
    s_waitcnt vmcnt(2)
    v_smfmac_f32_16x16x64_bf16 v[108:111], v[28:31], a[216:223], v2
    s_barrier
    ds_read_b128 v[32:35], v1 offset:4096
    v_smfmac_f32_16x16x64_bf16 v[112:115], v[16:19], v[128:135], v2
    ds_read_b128 v[36:39], v1 offset:5120
    v_smfmac_f32_16x16x64_bf16 v[116:119], v[16:19], v[136:143], v2
    ds_read_b128 v[40:43], v1 offset:6144
    v_smfmac_f32_16x16x64_bf16 v[112:115], v[20:23], v[160:167], v2
    ds_read_b128 v[44:47], v1 offset:7168
    v_smfmac_f32_16x16x64_bf16 v[116:119], v[20:23], v[168:175], v2
    ds_read_b128 v[60:63], v10 offset:35840
    s_waitcnt lgkmcnt(4)
    v_smfmac_f32_16x16x64_bf16 v[96:99], v[32:35], a[96:103], v2
    ds_read_b128 v[16:19], v5 offset:16384
    v_smfmac_f32_16x16x64_bf16 v[100:103], v[32:35], a[104:111], v2
    ds_read_b128 v[20:23], v5 offset:17408
    v_smfmac_f32_16x16x64_bf16 v[104:107], v[32:35], v[48:55], v2
    s_waitcnt lgkmcnt(2)
    v_smfmac_f32_16x16x64_bf16 v[108:111], v[32:35], v[56:63], v2
    v_smfmac_f32_16x16x64_bf16 v[96:99], v[36:39], a[128:135], v2
    ds_read_b128 v[48:51], v1 offset:9216
    v_smfmac_f32_16x16x64_bf16 v[100:103], v[36:39], a[136:143], v2
    s_waitcnt lgkmcnt(1)
    buffer_load_dwordx4 v1, s[4:7], s31 offen sc1  lds
    ds_read_b128 v[52:55], v1 offset:11264
    v_smfmac_f32_16x16x64_bf16 v[104:107], v[36:39], a[224:231], v2
    ds_read_b128 v[56:59], v1 offset:13312
    v_smfmac_f32_16x16x64_bf16 v[108:111], v[36:39], a[232:239], v2
    ds_read_b128 v[60:63], v1 offset:15360
    v_smfmac_f32_16x16x64_bf16 v[96:99], v[40:43], a[112:119], v2
    v_smfmac_f32_16x16x64_bf16 v[96:99], v[44:47], a[144:151], v2
    buffer_load_dwordx4 v1, s[4:7], s31 offen offset:1024 sc1  lds
    s_mov_b32 m0, s81
    s_nop 0
    v_smfmac_f32_16x16x64_bf16 v[100:103], v[40:43], a[120:127], v2
    s_nop 0
    v_smfmac_f32_16x16x64_bf16 v[100:103], v[44:47], a[152:159], v2
    s_nop 0
    s_nop 0
    v_add_f32 v96, v96, v98
    v_smfmac_f32_16x16x64_bf16 v[104:107], v[40:43], v[64:71], v2
    v_add_f32 v97, v97, v99
    v_mul_f32 v96, s34, v96
    v_smfmac_f32_16x16x64_bf16 v[104:107], v[44:47], a[240:247], v2
    v_mul_f32 v97, s34, v97
    v_cvt_pk_bf16_f32 v96, v96, v97
    v_smfmac_f32_16x16x64_bf16 v[108:111], v[40:43], v[72:79], v2
    v_add_f32 v100, v100, v102
    v_add_f32 v101, v101, v103
    v_smfmac_f32_16x16x64_bf16 v[108:111], v[44:47], a[248:255], v2
    v_mul_f32 v100, s34, v100
    v_mul_f32 v101, s34, v101
    v_smfmac_f32_16x16x64_bf16 v[112:115], v[24:27], v[144:151], v2
    v_cvt_pk_bf16_f32 v100, v100, v101
    v_add_f32 v104, v104, v106
    v_smfmac_f32_16x16x64_bf16 v[116:119], v[24:27], v[152:159], v2
    ds_write2_b32 v6, v96, v100 offset0:1 offset1:129
    v_add_f32 v105, v105, v107
    v_cvt_pk_bf16_f32 v120, v104, v105
    v_add_f32 v108, v108, v110
    v_add_f32 v109, v109, v111
    v_cvt_pk_bf16_f32 v121, v108, v109
    ds_write2_b32 v6, v120, v121 offset0:0 offset1:128
    v_smfmac_f32_16x16x64_bf16 v[112:115], v[28:31], v[176:183], v2
    v_smfmac_f32_16x16x64_bf16 v[116:119], v[28:31], v[184:191], v2
    v_smfmac_f32_16x16x64_bf16 v[112:115], v[32:35], v[192:199], v2
    v_smfmac_f32_16x16x64_bf16 v[116:119], v[32:35], v[200:207], v2
    s_waitcnt lgkmcnt(0)
    s_barrier
    ds_read_b64_tr_b16 v[64:65], v4 offset:26624
    ds_read_b64_tr_b16 v[66:67], v4 offset:27136
    v_smfmac_f32_16x16x64_bf16 v[112:115], v[36:39], v[224:231], v2
    ds_read_b64_tr_b16 v[68:69], v4 offset:27648
    ds_read_b64_tr_b16 v[70:71], v4 offset:28160
    v_smfmac_f32_16x16x64_bf16 v[116:119], v[36:39], v[232:239], v2
    ds_read_b64_tr_b16 v[72:73], v4 offset:28672
    ds_read_b64_tr_b16 v[74:75], v4 offset:29184
    v_smfmac_f32_16x16x64_bf16 v[112:115], v[40:43], v[208:215], v2
    ds_read_b64_tr_b16 v[76:77], v4 offset:29696
    ds_read_b64_tr_b16 v[78:79], v4 offset:30208
    v_smfmac_f32_16x16x64_bf16 v[116:119], v[40:43], v[216:223], v2
    v_smfmac_f32_16x16x64_bf16 v[112:115], v[44:47], v[240:247], v2
    v_mov_b64 v[36:37], s[44:45]
    v_smfmac_f32_16x16x64_bf16 v[116:119], v[44:47], v[248:255], v2
    s_waitcnt lgkmcnt(4)
    v_mov_b64 v[38:39], s[44:45]
    v_mfma_f32_16x16x32_bf16 v[96:99], v[80:83], v[64:67], 0
    s_nop 0
    s_mov_b32 s35, s33
    v_mfma_f32_16x16x32_bf16 v[96:99], v[84:87], v[68:71], v[96:99]
    buffer_load_dwordx4 v1, s[4:7], s30 offen sc1  lds
    s_waitcnt lgkmcnt(0)
    v_mfma_f32_16x16x32_bf16 v[96:99], v[88:91], v[72:75], v[96:99]
    v_add_f32 v112, v112, v114
    v_add_f32 v113, v113, v115
    v_mfma_f32_16x16x32_bf16 v[96:99], v[92:95], v[76:79], v[96:99]
    v_cvt_pk_bf16_f32 v122, v112, v113
    v_add_f32 v116, v116, v118
    v_mfma_f32_16x16x32_bf16 v[100:103], v[48:51], v[64:67], 0
    ds_read_b128 v[80:83], v0 offset:0
    v_add_f32 v117, v117, v119
    v_cvt_pk_bf16_f32 v123, v116, v117
    v_mfma_f32_16x16x32_bf16 v[100:103], v[52:55], v[68:71], v[100:103]
    ds_read_b128 v[84:87], v0 offset:1024
    buffer_load_dwordx4 v1, s[4:7], s30 offen offset:1024 sc1  lds
    v_mfma_f32_16x16x32_bf16 v[100:103], v[56:59], v[72:75], v[100:103]
    v_exp_f32 v24, v96
    v_mfma_f32_16x16x32_bf16 v[100:103], v[60:63], v[76:79], v[100:103]
    v_exp_f32 v25, v97
    v_mfma_f32_16x16x32_bf16 v[104:107], v[64:67], v[64:67], 0
    v_exp_f32 v26, v98
    v_mfma_f32_16x16x32_bf16 v[104:107], v[68:71], v[68:71], v[104:107]
    v_exp_f32 v27, v99
    v_mfma_f32_16x16x32_bf16 v[104:107], v[72:75], v[72:75], v[104:107]
    v_cvt_pk_bf16_f32 v108, v24, v25
    v_cvt_pk_bf16_f32 v109, v26, v27
    v_mfma_f32_16x16x32_bf16 v[104:107], v[76:79], v[76:79], v[104:107]
    v_exp_f32 v28, v100
    v_exp_f32 v29, v101
    v_exp_f32 v30, v102
    v_exp_f32 v31, v103
    v_cvt_pk_bf16_f32 v110, v28, v29
    v_cvt_pk_bf16_f32 v111, v30, v31
    s_cmp_eq_u32 s18, 63
    s_nop 0
    v_mfma_f32_16x16x32_bf16 v[112:115], v[36:39], v[108:111], 0
    v_exp_f32 v32, v104
    v_mfma_f32_16x16x32_bf16 v[40:43], v[16:19], v[108:111], 0
    v_exp_f32 v33, v105
    v_mfma_f32_16x16x32_bf16 v[44:47], v[20:23], v[108:111], 0
    v_cvt_pk_bf16_f32 v124, v32, v33
    v_cvt_pk_bf16_f32 v127, v32, v33
    ds_read_b128 v[88:91], v0 offset:2048
    s_cbranch_scc1 L_ch_last
    v_mfma_f32_16x16x16_bf16 v[112:115], v[36:37], v[124:125], v[112:115]
    ds_read_b128 v[92:95], v0 offset:3072
    s_add_u32 s33, s33, 131072
    v_mfma_f32_16x16x16_bf16 v[40:43], v[122:123], v[124:125], v[40:43]
    s_add_u32 s30, s30, 262144
    s_add_u32 s31, s31, 262144
    v_mfma_f32_16x16x16_bf16 v[44:47], v[122:123], v[126:127], v[44:47]
    s_nop 1
L_ch_pvdone2:
    v_rcp_f32 v35, v112
    v_cmp_ngt_f32 vcc, s98, v112
    v_cmp_nlt_f32 s[12:13], s100, v112
    v_pk_mul_f32 v[40:41], v[40:41], v[34:35] op_sel:[0,1] op_sel_hi:[1,1]
    v_pk_mul_f32 v[42:43], v[42:43], v[34:35] op_sel:[0,1] op_sel_hi:[1,1]
    s_nop 0
    v_pk_mul_f32 v[44:45], v[44:45], v[34:35] op_sel:[0,1] op_sel_hi:[1,1]
    v_pk_mul_f32 v[46:47], v[46:47], v[34:35] op_sel:[0,1] op_sel_hi:[1,1]
    v_cvt_pk_bf16_f32 v108, v40, v41
    v_cvt_pk_bf16_f32 v109, v42, v43
    v_cvt_pk_bf16_f32 v110, v44, v45
    v_cvt_pk_bf16_f32 v111, v46, v47
    ds_write_b128 v8, v[108:111]
    s_or_b64 vcc, vcc, s[12:13]
    s_and_b64 vcc, vcc, s[38:39]
    s_cbranch_scc1 L_ch_slow2
    v_mfma_f32_32x32x1_2b_f32 v[16:47], v125, v125, 0
    s_mov_b64 s[38:39], s[50:51]
    ds_read_b128 v[48:51], v0 offset:4096
    ds_read_b128 v[52:55], v0 offset:5120
    s_waitcnt lgkmcnt(2)
    s_barrier
    ds_read_b128 v[96:99], v9
    ds_read_b128 v[100:103], v9 offset:1024
    s_add_u32 s27, s27, 8192
    s_add_u32 s24, s24, 8192
    s_mov_b32 m0, s82
    s_nop 0
    s_add_u32 s18, s18, 1
    s_mov_b32 s21, 0
    s_nop 5
    s_waitcnt lgkmcnt(1)
    v_smfmac_f32_16x16x64_bf16 v[16:19], v[96:99], v[80:87], v2
    ds_read_b128 v[56:59], v0 offset:6144
    v_smfmac_f32_16x16x64_bf16 v[20:23], v[96:99], v[88:95], v2
    s_waitcnt lgkmcnt(1)
    ds_read_b128 v[60:63], v0 offset:7168
    v_smfmac_f32_16x16x64_bf16 v[16:19], v[100:103], a[0:7], v2
    ds_read_b128 v[64:67], v0 offset:32768
    v_smfmac_f32_16x16x64_bf16 v[20:23], v[100:103], a[8:15], v2
    ds_read_b128 v[68:71], v0 offset:33792
    v_smfmac_f32_16x16x64_bf16 v[24:27], v[96:99], v[48:55], v2
    ds_read_b128 v[72:75], v0 offset:34816
    v_smfmac_f32_16x16x64_bf16 v[24:27], v[100:103], a[16:23], v2
    ds_read_b128 v[76:79], v0 offset:35840
    s_waitcnt lgkmcnt(4)
    v_smfmac_f32_16x16x64_bf16 v[28:31], v[96:99], v[56:63], v2
    ds_read_b128 v[80:83], v0 offset:36864
    v_smfmac_f32_16x16x64_bf16 v[28:31], v[100:103], a[24:31], v2
    ds_read_b128 v[84:87], v0 offset:37888
    s_waitcnt lgkmcnt(4)
    v_pk_add_f32 v[16:17], v[16:17], v[18:19]
    v_cvt_pk_bf16_f32 v104, v16, v17
    v_bfi_b32 v104, 1, s25, v104
    v_pk_add_f32 v[20:21], v[20:21], v[22:23]
    v_cvt_pk_bf16_f32 v105, v20, v21
    v_pk_add_f32 v[24:25], v[24:25], v[26:27]
    v_cvt_pk_bf16_f32 v106, v24, v25
    v_bfi_b32 v106, 1, s25, v106
    v_pk_add_f32 v[28:29], v[28:29], v[30:31]
    v_cvt_pk_bf16_f32 v107, v28, v29
    v_smfmac_f32_16x16x64_bf16 v[32:35], v[96:99], v[64:71], v2
    buffer_store_dwordx2 v[104:105], v3, s[4:7], s22 offen offset:0
    ds_read_b128 v[88:91], v0 offset:38912
    v_smfmac_f32_16x16x64_bf16 v[32:35], v[100:103], a[32:39], v2
    buffer_store_dwordx2 v[106:107], v3, s[4:7], s22 offen offset:2048
    ds_read_b128 v[92:95], v0 offset:39936
    s_waitcnt lgkmcnt(4)
    v_smfmac_f32_16x16x64_bf16 v[36:39], v[96:99], v[72:79], v2
    v_smfmac_f32_16x16x64_bf16 v[36:39], v[100:103], a[40:47], v2
    s_waitcnt lgkmcnt(2)
    v_smfmac_f32_16x16x64_bf16 v[40:43], v[96:99], v[80:87], v2
    s_nop 0
    v_add_f32 v32, v32, v34
    v_smfmac_f32_16x16x64_bf16 v[40:43], v[100:103], a[48:55], v2
    s_waitcnt lgkmcnt(0)
    v_add_f32 v33, v33, v35
    v_cvt_pk_bf16_f32 v108, v32, v33
    v_smfmac_f32_16x16x64_bf16 v[44:47], v[96:99], v[88:95], v2
    v_bfi_b32 v108, 1, s25, v108
    v_add_f32 v36, v36, v38
    v_smfmac_f32_16x16x64_bf16 v[44:47], v[100:103], a[56:63], v2
    v_add_f32 v37, v37, v39
    v_cvt_pk_bf16_f32 v109, v36, v37
    buffer_store_dwordx2 v[108:109], v3, s[4:7], s23 offen offset:0
    v_pk_add_f32 v[40:41], v[40:41], v[42:43]
    v_cvt_pk_bf16_f32 v110, v40, v41
    v_bfi_b32 v110, 1, s25, v110
    s_nop 1
    v_pk_add_f32 v[44:45], v[44:45], v[46:47]
    v_cvt_pk_bf16_f32 v111, v44, v45
    buffer_store_dwordx2 v[110:111], v3, s[4:7], s23 offen offset:2048
    v_cndmask_b32 v116, 0, v11, s[72:73]
    v_cndmask_b32 v117, 0, v11, s[74:75]
    v_cndmask_b32 v118, 0, v11, s[76:77]
    v_cndmask_b32 v119, 0, v11, s[78:79]
    v_mov_b64 v[96:97], 0
    v_mov_b64 v[98:99], 0
    v_mov_b64 v[100:101], 0
    v_mov_b64 v[102:103], 0
    v_mov_b64 v[104:105], 0
    v_mov_b64 v[106:107], 0
    v_mov_b64 v[108:109], 0
    v_mov_b64 v[110:111], 0
    ds_read_b128 v[64:67], v10 offset:0
    ds_read_b128 v[68:71], v10 offset:1024
    ds_read_b128 v[72:75], v10 offset:2048
    ds_read_b128 v[76:79], v10 offset:3072
    s_nop 3
    s_nop 3
    s_nop 3
    s_nop 3
    s_nop 3
    s_nop 3
    s_nop 3
    s_nop 3
    s_nop 3
    s_nop 3
    s_nop 3
    s_nop 3
    s_nop 3
    s_nop 3
    s_nop 3
    s_nop 3
    buffer_load_dwordx4 v[40:43], v1, s[4:7], s41 offen sc1
    buffer_load_dwordx4 v[44:47], v1, s[4:7], s41 offen offset:1024 sc1
    ds_read_b128 v[48:51], v10 offset:4096
    ds_read_b128 v[52:55], v10 offset:5120
    ds_read_b128 v[56:59], v10 offset:6144
    ds_read_b128 v[60:63], v10 offset:7168
    s_waitcnt vmcnt(1)
    v_mfma_f32_16x16x32_bf16 v[112:115], v[116:119], v[40:43], 0
    v_bitop3_b32 v14, v40, v42, s25 bitop3:0x7e
    s_waitcnt vmcnt(0)
    v_mfma_f32_16x16x32_bf16 v[112:115], v[116:119], v[44:47], v[112:115]
    v_bitop3_b32 v15, v44, v46, s25 bitop3:0x7e
    v_bitop3_b32 v14, v14, v15, 1 bitop3:0xa8
    v_cmp_ne_u32 vcc, 0, v14
    s_cbranch_vccnz L_ch_r2
L_ch_rok2:
    s_nop 3
    v_add_f32_dpp v112, v112, v112 row_ror:4 row_mask:0xf bank_mask:0xf
    v_add_f32_dpp v113, v113, v113 row_ror:4 row_mask:0xf bank_mask:0xf
    s_nop 0
    v_add_f32_dpp v112, v112, v112 row_ror:8 row_mask:0xf bank_mask:0xf
    v_add_f32_dpp v113, v113, v113 row_ror:8 row_mask:0xf bank_mask:0xf
    v_cvt_pk_bf16_f32 v124, v112, v113
    buffer_store_dword v124, v7, s[4:7], s28 offen
    v_mov_b64 v[112:113], 0
    v_mov_b64 v[114:115], 0
    v_mov_b64 v[116:117], 0
    v_mov_b64 v[118:119], 0
    s_add_u32 s28, s28, 8192
    s_add_u32 s29, s29, 8192
    s_xor_b32 s25, s25, 1
    s_waitcnt lgkmcnt(0)
    s_mov_b32 s21, 0
    s_cmp_lg_u32 s18, s36
    s_cbranch_scc1 L_ch_step2
    s_cmp_eq_u32 s18, 7
    s_cbranch_scc0 L_ch_wc2
    s_mov_b32 s36, 31
    v_mov_b32 v14, 0
    s_mov_b32 s21, 0
L_ch_wb2:
    buffer_load_dword v15, v14, s[8:11], 0 offen offset:144 sc1
    s_add_u32 s21, s21, 1
    s_cmp_gt_u32 s21, 200000
    s_cbranch_scc1 L_ch_wb2_x
    s_waitcnt vmcnt(0)
    v_cmp_gt_u32 vcc, 96, v15
    s_cbranch_vccz L_ch_wb2_x
    s_sleep 4
    s_branch L_ch_wb2
L_ch_wb2_x:
    s_waitcnt vmcnt(0)
    s_mov_b32 s21, 0
    s_branch L_ch_step2
L_ch_wc2:
    v_mov_b32 v14, 0
    s_mov_b32 s21, 0
L_ch_wd2:
    buffer_load_dword v15, v14, s[8:11], 0 offen offset:148 sc1
    s_add_u32 s21, s21, 1
    s_cmp_gt_u32 s21, 200000
    s_cbranch_scc1 L_ch_wd2_x
    s_waitcnt vmcnt(0)
    v_cmp_gt_u32 vcc, 128, v15
    s_cbranch_vccz L_ch_wd2_x
    s_sleep 4
    s_branch L_ch_wd2
L_ch_wd2_x:
    s_waitcnt vmcnt(0)
    s_mov_b32 s21, 0
    s_branch L_ch_step2
L_ch_r2:
    buffer_load_dwordx4 v[40:43], v1, s[4:7], s41 offen sc1
    buffer_load_dwordx4 v[44:47], v1, s[4:7], s41 offen offset:1024 sc1
    s_add_u32 s21, s21, 1
    s_cmp_gt_u32 s21, 200000
    s_cbranch_scc1 L_ch_fail
    s_waitcnt vmcnt(1)
    v_mfma_f32_16x16x32_bf16 v[112:115], v[116:119], v[40:43], 0
    v_bitop3_b32 v14, v40, v42, s25 bitop3:0x7e
    s_waitcnt vmcnt(0)
    v_mfma_f32_16x16x32_bf16 v[112:115], v[116:119], v[44:47], v[112:115]
    v_bitop3_b32 v15, v44, v46, s25 bitop3:0x7e
    v_bitop3_b32 v14, v14, v15, 1 bitop3:0xa8
    v_cmp_ne_u32 vcc, 0, v14
    s_cbranch_vccnz L_ch_r2
    s_nop 3
    s_branch L_ch_rok2
L_ch_slow2:
    s_mov_b64 s[38:39], 0
    s_nop 7
    v_max3_f32 v34, v96, v97, v98
    v_max3_f32 v34, v34, v99, v100
    v_max3_f32 v34, v34, v101, v102
    v_max3_f32 v34, v34, v103, v104
    v_max_f32 v34, v34, v105
    v_mov_b32 v35, v34
    s_nop 1
    v_permlane32_swap_b32 v34, v35
    v_max_f32 v34, v34, v35
    v_mov_b32 v35, v34
    s_nop 1
    v_permlane16_swap_b32 v34, v35
    v_max_f32 v34, v34, v35
    v_sub_f32 v24, v96, v34
    v_sub_f32 v25, v97, v34
    v_sub_f32 v26, v98, v34
    v_sub_f32 v27, v99, v34
    v_sub_f32 v28, v100, v34
    v_sub_f32 v29, v101, v34
    v_sub_f32 v30, v102, v34
    v_sub_f32 v31, v103, v34
    v_sub_f32 v32, v104, v34
    v_sub_f32 v33, v105, v34
    v_exp_f32 v24, v24
    v_exp_f32 v25, v25
    v_exp_f32 v26, v26
    v_exp_f32 v27, v27
    v_exp_f32 v28, v28
    v_exp_f32 v29, v29
    v_exp_f32 v30, v30
    v_exp_f32 v31, v31
    v_exp_f32 v32, v32
    v_exp_f32 v33, v33
    v_cvt_pk_bf16_f32 v108, v24, v25
    v_cvt_pk_bf16_f32 v109, v26, v27
    v_cvt_pk_bf16_f32 v110, v28, v29
    v_cvt_pk_bf16_f32 v111, v30, v31
    v_cvt_pk_bf16_f32 v124, v32, v33
    v_cvt_pk_bf16_f32 v127, v32, v33
    v_mfma_f32_16x16x32_bf16 v[112:115], v[36:39], v[108:111], 0
    v_mfma_f32_16x16x32_bf16 v[40:43], v[16:19], v[108:111], 0
    v_mfma_f32_16x16x32_bf16 v[44:47], v[20:23], v[108:111], 0
    s_nop 3
    v_mfma_f32_16x16x16_bf16 v[112:115], v[36:37], v[124:125], v[112:115]
    v_mfma_f32_16x16x16_bf16 v[40:43], v[122:123], v[124:125], v[40:43]
    v_mfma_f32_16x16x16_bf16 v[44:47], v[122:123], v[126:127], v[44:47]
    s_nop 7
    s_branch L_ch_pvdone2
.p2align 6
L_ch_step3:
    s_barrier
    ds_read_b128 v[16:19], v1 offset:0
    ds_read_b128 v[20:23], v1 offset:1024
    ds_read_b128 v[24:27], v1 offset:2048
    ds_read_b128 v[28:31], v1 offset:3072
    buffer_store_dwordx4 v[120:123], v1, s[4:7], s35 offen sc1
    buffer_load_dword v13, v7, s[4:7], s29 offen sc1
    s_waitcnt lgkmcnt(3)
    v_smfmac_f32_16x16x64_bf16 v[104:107], v[16:19], a[160:167], v2
    v_smfmac_f32_16x16x64_bf16 v[108:111], v[16:19], a[168:175], v2
    v_smfmac_f32_16x16x64_bf16 v[96:99], v[16:19], v[64:71], v2
    v_smfmac_f32_16x16x64_bf16 v[100:103], v[16:19], v[72:79], v2
    s_waitcnt lgkmcnt(2)
    v_smfmac_f32_16x16x64_bf16 v[96:99], v[20:23], a[64:71], v2
    ds_read_b128 v[64:67], v10 offset:36864
    v_smfmac_f32_16x16x64_bf16 v[100:103], v[20:23], a[72:79], v2
    ds_read_b128 v[68:71], v10 offset:37888
    v_smfmac_f32_16x16x64_bf16 v[104:107], v[20:23], a[192:199], v2
    ds_read_b128 v[72:75], v10 offset:38912
    v_smfmac_f32_16x16x64_bf16 v[108:111], v[20:23], a[200:207], v2
    ds_read_b128 v[76:79], v10 offset:39936
    s_waitcnt lgkmcnt(5)
    v_smfmac_f32_16x16x64_bf16 v[104:107], v[24:27], a[176:183], v2
    ds_read_b128 v[80:83], v1 offset:8192
    v_smfmac_f32_16x16x64_bf16 v[108:111], v[24:27], a[184:191], v2
    ds_read_b128 v[84:87], v1 offset:10240
    v_smfmac_f32_16x16x64_bf16 v[96:99], v[24:27], v[48:55], v2
    ds_read_b128 v[88:91], v1 offset:12288
    v_smfmac_f32_16x16x64_bf16 v[100:103], v[24:27], v[56:63], v2
    ds_read_b128 v[92:95], v1 offset:14336
    s_waitcnt lgkmcnt(8)
    v_smfmac_f32_16x16x64_bf16 v[96:99], v[28:31], a[80:87], v2
    ds_read_b128 v[48:51], v10 offset:32768
    v_smfmac_f32_16x16x64_bf16 v[100:103], v[28:31], a[88:95], v2
    ds_read_b128 v[52:55], v10 offset:33792
    v_smfmac_f32_16x16x64_bf16 v[104:107], v[28:31], a[208:215], v2
    ds_read_b128 v[56:59], v10 offset:34816
    s_waitcnt vmcnt(2)
    v_smfmac_f32_16x16x64_bf16 v[108:111], v[28:31], a[216:223], v2
    s_barrier
    ds_read_b128 v[32:35], v1 offset:4096
    v_smfmac_f32_16x16x64_bf16 v[112:115], v[16:19], v[128:135], v2
    ds_read_b128 v[36:39], v1 offset:5120
    v_smfmac_f32_16x16x64_bf16 v[116:119], v[16:19], v[136:143], v2
    ds_read_b128 v[40:43], v1 offset:6144
    v_smfmac_f32_16x16x64_bf16 v[112:115], v[20:23], v[160:167], v2
    ds_read_b128 v[44:47], v1 offset:7168
    v_smfmac_f32_16x16x64_bf16 v[116:119], v[20:23], v[168:175], v2
    ds_read_b128 v[60:63], v10 offset:35840
    s_waitcnt lgkmcnt(4)
    v_smfmac_f32_16x16x64_bf16 v[96:99], v[32:35], a[96:103], v2
    ds_read_b128 v[16:19], v5 offset:16384
    v_smfmac_f32_16x16x64_bf16 v[100:103], v[32:35], a[104:111], v2
    ds_read_b128 v[20:23], v5 offset:17408
    v_smfmac_f32_16x16x64_bf16 v[104:107], v[32:35], v[48:55], v2
    s_waitcnt lgkmcnt(2)
    v_smfmac_f32_16x16x64_bf16 v[108:111], v[32:35], v[56:63], v2
    v_smfmac_f32_16x16x64_bf16 v[96:99], v[36:39], a[128:135], v2
    ds_read_b128 v[48:51], v1 offset:9216
    v_smfmac_f32_16x16x64_bf16 v[100:103], v[36:39], a[136:143], v2
    s_waitcnt lgkmcnt(1)
    buffer_load_dwordx4 v1, s[4:7], s31 offen sc1  lds
    ds_read_b128 v[52:55], v1 offset:11264
    v_smfmac_f32_16x16x64_bf16 v[104:107], v[36:39], a[224:231], v2
    ds_read_b128 v[56:59], v1 offset:13312
    v_smfmac_f32_16x16x64_bf16 v[108:111], v[36:39], a[232:239], v2
    ds_read_b128 v[60:63], v1 offset:15360
    v_smfmac_f32_16x16x64_bf16 v[96:99], v[40:43], a[112:119], v2
    v_smfmac_f32_16x16x64_bf16 v[96:99], v[44:47], a[144:151], v2
    buffer_load_dwordx4 v1, s[4:7], s31 offen offset:1024 sc1  lds
    s_mov_b32 m0, s81
    s_nop 0
    v_smfmac_f32_16x16x64_bf16 v[100:103], v[40:43], a[120:127], v2
    s_nop 0
    v_smfmac_f32_16x16x64_bf16 v[100:103], v[44:47], a[152:159], v2
    s_nop 0
    s_nop 0
    v_add_f32 v96, v96, v98
    v_smfmac_f32_16x16x64_bf16 v[104:107], v[40:43], v[64:71], v2
    v_add_f32 v97, v97, v99
    v_mul_f32 v96, s34, v96
    v_smfmac_f32_16x16x64_bf16 v[104:107], v[44:47], a[240:247], v2
    v_mul_f32 v97, s34, v97
    v_cvt_pk_bf16_f32 v96, v96, v97
    v_smfmac_f32_16x16x64_bf16 v[108:111], v[40:43], v[72:79], v2
    v_add_f32 v100, v100, v102
    v_add_f32 v101, v101, v103
    v_smfmac_f32_16x16x64_bf16 v[108:111], v[44:47], a[248:255], v2
    v_mul_f32 v100, s34, v100
    v_mul_f32 v101, s34, v101
    v_smfmac_f32_16x16x64_bf16 v[112:115], v[24:27], v[144:151], v2
    v_cvt_pk_bf16_f32 v100, v100, v101
    v_add_f32 v104, v104, v106
    v_smfmac_f32_16x16x64_bf16 v[116:119], v[24:27], v[152:159], v2
    ds_write2_b32 v6, v96, v100 offset0:1 offset1:129
    v_add_f32 v105, v105, v107
    v_cvt_pk_bf16_f32 v120, v104, v105
    v_add_f32 v108, v108, v110
    v_add_f32 v109, v109, v111
    v_cvt_pk_bf16_f32 v121, v108, v109
    ds_write2_b32 v6, v120, v121 offset0:0 offset1:128
    v_smfmac_f32_16x16x64_bf16 v[112:115], v[28:31], v[176:183], v2
    v_smfmac_f32_16x16x64_bf16 v[116:119], v[28:31], v[184:191], v2
    v_smfmac_f32_16x16x64_bf16 v[112:115], v[32:35], v[192:199], v2
    v_smfmac_f32_16x16x64_bf16 v[116:119], v[32:35], v[200:207], v2
    s_waitcnt lgkmcnt(0)
    s_barrier
    ds_read_b64_tr_b16 v[64:65], v4 offset:26624
    ds_read_b64_tr_b16 v[66:67], v4 offset:27136
    v_smfmac_f32_16x16x64_bf16 v[112:115], v[36:39], v[224:231], v2
    ds_read_b64_tr_b16 v[68:69], v4 offset:27648
    ds_read_b64_tr_b16 v[70:71], v4 offset:28160
    v_smfmac_f32_16x16x64_bf16 v[116:119], v[36:39], v[232:239], v2
    ds_read_b64_tr_b16 v[72:73], v4 offset:28672
    ds_read_b64_tr_b16 v[74:75], v4 offset:29184
    v_smfmac_f32_16x16x64_bf16 v[112:115], v[40:43], v[208:215], v2
    ds_read_b64_tr_b16 v[76:77], v4 offset:29696
    ds_read_b64_tr_b16 v[78:79], v4 offset:30208
    v_smfmac_f32_16x16x64_bf16 v[116:119], v[40:43], v[216:223], v2
    v_smfmac_f32_16x16x64_bf16 v[112:115], v[44:47], v[240:247], v2
    v_mov_b64 v[36:37], s[44:45]
    v_smfmac_f32_16x16x64_bf16 v[116:119], v[44:47], v[248:255], v2
    s_waitcnt lgkmcnt(4)
    v_mov_b64 v[38:39], s[44:45]
    v_mfma_f32_16x16x32_bf16 v[96:99], v[80:83], v[64:67], 0
    buffer_load_dwordx4 v1, s[4:7], s30 offen sc1  lds
    s_mov_b32 s35, s33
    v_mfma_f32_16x16x32_bf16 v[96:99], v[84:87], v[68:71], v[96:99]
    s_waitcnt lgkmcnt(0)
    v_mfma_f32_16x16x32_bf16 v[96:99], v[88:91], v[72:75], v[96:99]
    v_add_f32 v112, v112, v114
    v_add_f32 v113, v113, v115
    v_mfma_f32_16x16x32_bf16 v[96:99], v[92:95], v[76:79], v[96:99]
    v_cvt_pk_bf16_f32 v122, v112, v113
    v_add_f32 v116, v116, v118
    v_mfma_f32_16x16x32_bf16 v[100:103], v[48:51], v[64:67], 0
    ds_read_b128 v[80:83], v0 offset:0
    buffer_load_dwordx4 v1, s[4:7], s30 offen offset:1024 sc1  lds
    v_add_f32 v117, v117, v119
    v_cvt_pk_bf16_f32 v123, v116, v117
    v_mfma_f32_16x16x32_bf16 v[100:103], v[52:55], v[68:71], v[100:103]
    ds_read_b128 v[84:87], v0 offset:1024
    v_mfma_f32_16x16x32_bf16 v[100:103], v[56:59], v[72:75], v[100:103]
    v_exp_f32 v24, v96
    v_mfma_f32_16x16x32_bf16 v[100:103], v[60:63], v[76:79], v[100:103]
    v_exp_f32 v25, v97
    v_mfma_f32_16x16x32_bf16 v[104:107], v[64:67], v[64:67], 0
    v_exp_f32 v26, v98
    v_mfma_f32_16x16x32_bf16 v[104:107], v[68:71], v[68:71], v[104:107]
    v_exp_f32 v27, v99
    v_mfma_f32_16x16x32_bf16 v[104:107], v[72:75], v[72:75], v[104:107]
    v_cvt_pk_bf16_f32 v108, v24, v25
    v_cvt_pk_bf16_f32 v109, v26, v27
    v_mfma_f32_16x16x32_bf16 v[104:107], v[76:79], v[76:79], v[104:107]
    v_exp_f32 v28, v100
    v_exp_f32 v29, v101
    v_exp_f32 v30, v102
    v_exp_f32 v31, v103
    v_cvt_pk_bf16_f32 v110, v28, v29
    v_cvt_pk_bf16_f32 v111, v30, v31
    s_cmp_eq_u32 s18, 63
    s_nop 0
    v_mfma_f32_16x16x32_bf16 v[112:115], v[36:39], v[108:111], 0
    v_exp_f32 v32, v104
    v_mfma_f32_16x16x32_bf16 v[40:43], v[16:19], v[108:111], 0
    v_exp_f32 v33, v105
    v_mfma_f32_16x16x32_bf16 v[44:47], v[20:23], v[108:111], 0
    v_cvt_pk_bf16_f32 v124, v32, v33
    v_cvt_pk_bf16_f32 v127, v32, v33
    ds_read_b128 v[88:91], v0 offset:2048
    s_cbranch_scc1 L_ch_last
    v_mfma_f32_16x16x16_bf16 v[112:115], v[36:37], v[124:125], v[112:115]
    ds_read_b128 v[92:95], v0 offset:3072
    s_add_u32 s33, s33, 131072
    v_mfma_f32_16x16x16_bf16 v[40:43], v[122:123], v[124:125], v[40:43]
    s_add_u32 s30, s30, 262144
    s_add_u32 s31, s31, 262144
    v_mfma_f32_16x16x16_bf16 v[44:47], v[122:123], v[126:127], v[44:47]
    s_nop 1
L_ch_pvdone3:
    v_rcp_f32 v35, v112
    v_cmp_ngt_f32 vcc, s98, v112
    v_cmp_nlt_f32 s[12:13], s100, v112
    v_pk_mul_f32 v[40:41], v[40:41], v[34:35] op_sel:[0,1] op_sel_hi:[1,1]
    v_pk_mul_f32 v[42:43], v[42:43], v[34:35] op_sel:[0,1] op_sel_hi:[1,1]
    s_nop 0
    v_pk_mul_f32 v[44:45], v[44:45], v[34:35] op_sel:[0,1] op_sel_hi:[1,1]
    v_pk_mul_f32 v[46:47], v[46:47], v[34:35] op_sel:[0,1] op_sel_hi:[1,1]
    v_cvt_pk_bf16_f32 v108, v40, v41
    v_cvt_pk_bf16_f32 v109, v42, v43
    v_cvt_pk_bf16_f32 v110, v44, v45
    v_cvt_pk_bf16_f32 v111, v46, v47
    ds_write_b128 v8, v[108:111]
    s_or_b64 vcc, vcc, s[12:13]
    s_and_b64 vcc, vcc, s[38:39]
    s_cbranch_scc1 L_ch_slow3
    v_mfma_f32_32x32x1_2b_f32 v[16:47], v125, v125, 0
    s_mov_b64 s[38:39], s[50:51]
    ds_read_b128 v[48:51], v0 offset:4096
    ds_read_b128 v[52:55], v0 offset:5120
    s_waitcnt lgkmcnt(2)
    s_barrier
    ds_read_b128 v[96:99], v9
    ds_read_b128 v[100:103], v9 offset:1024
    s_add_u32 s27, s27, 8192
    s_add_u32 s24, s24, 8192
    s_mov_b32 m0, s82
    s_nop 0
    s_add_u32 s18, s18, 1
    s_mov_b32 s21, 0
    s_nop 5
    s_waitcnt lgkmcnt(1)
    v_smfmac_f32_16x16x64_bf16 v[16:19], v[96:99], v[80:87], v2
    ds_read_b128 v[56:59], v0 offset:6144
    v_smfmac_f32_16x16x64_bf16 v[20:23], v[96:99], v[88:95], v2
    s_waitcnt lgkmcnt(1)
    ds_read_b128 v[60:63], v0 offset:7168
    v_smfmac_f32_16x16x64_bf16 v[16:19], v[100:103], a[0:7], v2
    ds_read_b128 v[64:67], v0 offset:32768
    v_smfmac_f32_16x16x64_bf16 v[20:23], v[100:103], a[8:15], v2
    ds_read_b128 v[68:71], v0 offset:33792
    v_smfmac_f32_16x16x64_bf16 v[24:27], v[96:99], v[48:55], v2
    ds_read_b128 v[72:75], v0 offset:34816
    v_smfmac_f32_16x16x64_bf16 v[24:27], v[100:103], a[16:23], v2
    ds_read_b128 v[76:79], v0 offset:35840
    s_waitcnt lgkmcnt(4)
    v_smfmac_f32_16x16x64_bf16 v[28:31], v[96:99], v[56:63], v2
    ds_read_b128 v[80:83], v0 offset:36864
    v_smfmac_f32_16x16x64_bf16 v[28:31], v[100:103], a[24:31], v2
    ds_read_b128 v[84:87], v0 offset:37888
    s_waitcnt lgkmcnt(4)
    v_pk_add_f32 v[16:17], v[16:17], v[18:19]
    v_cvt_pk_bf16_f32 v104, v16, v17
    v_bfi_b32 v104, 1, s25, v104
    v_pk_add_f32 v[20:21], v[20:21], v[22:23]
    v_cvt_pk_bf16_f32 v105, v20, v21
    v_pk_add_f32 v[24:25], v[24:25], v[26:27]
    v_cvt_pk_bf16_f32 v106, v24, v25
    v_bfi_b32 v106, 1, s25, v106
    v_pk_add_f32 v[28:29], v[28:29], v[30:31]
    v_cvt_pk_bf16_f32 v107, v28, v29
    v_smfmac_f32_16x16x64_bf16 v[32:35], v[96:99], v[64:71], v2
    buffer_store_dwordx2 v[104:105], v3, s[4:7], s22 offen offset:0
    ds_read_b128 v[88:91], v0 offset:38912
    v_smfmac_f32_16x16x64_bf16 v[32:35], v[100:103], a[32:39], v2
    buffer_store_dwordx2 v[106:107], v3, s[4:7], s22 offen offset:2048
    ds_read_b128 v[92:95], v0 offset:39936
    s_waitcnt lgkmcnt(4)
    v_smfmac_f32_16x16x64_bf16 v[36:39], v[96:99], v[72:79], v2
    v_smfmac_f32_16x16x64_bf16 v[36:39], v[100:103], a[40:47], v2
    s_waitcnt lgkmcnt(2)
    v_smfmac_f32_16x16x64_bf16 v[40:43], v[96:99], v[80:87], v2
    s_nop 0
    v_add_f32 v32, v32, v34
    v_smfmac_f32_16x16x64_bf16 v[40:43], v[100:103], a[48:55], v2
    s_waitcnt lgkmcnt(0)
    v_add_f32 v33, v33, v35
    v_cvt_pk_bf16_f32 v108, v32, v33
    v_smfmac_f32_16x16x64_bf16 v[44:47], v[96:99], v[88:95], v2
    v_bfi_b32 v108, 1, s25, v108
    v_add_f32 v36, v36, v38
    v_smfmac_f32_16x16x64_bf16 v[44:47], v[100:103], a[56:63], v2
    v_add_f32 v37, v37, v39
    v_cvt_pk_bf16_f32 v109, v36, v37
    buffer_store_dwordx2 v[108:109], v3, s[4:7], s23 offen offset:0
    v_pk_add_f32 v[40:41], v[40:41], v[42:43]
    v_cvt_pk_bf16_f32 v110, v40, v41
    v_bfi_b32 v110, 1, s25, v110
    s_nop 1
    v_pk_add_f32 v[44:45], v[44:45], v[46:47]
    v_cvt_pk_bf16_f32 v111, v44, v45
    buffer_store_dwordx2 v[110:111], v3, s[4:7], s23 offen offset:2048
    v_cndmask_b32 v116, 0, v11, s[72:73]
    v_cndmask_b32 v117, 0, v11, s[74:75]
    v_cndmask_b32 v118, 0, v11, s[76:77]
    v_cndmask_b32 v119, 0, v11, s[78:79]
    v_mov_b64 v[96:97], 0
    v_mov_b64 v[98:99], 0
    v_mov_b64 v[100:101], 0
    v_mov_b64 v[102:103], 0
    v_mov_b64 v[104:105], 0
    v_mov_b64 v[106:107], 0
    v_mov_b64 v[108:109], 0
    v_mov_b64 v[110:111], 0
    ds_read_b128 v[64:67], v10 offset:0
    ds_read_b128 v[68:71], v10 offset:1024
    ds_read_b128 v[72:75], v10 offset:2048
    ds_read_b128 v[76:79], v10 offset:3072
    ds_read_b128 v[48:51], v10 offset:4096
    ds_read_b128 v[52:55], v10 offset:5120
    ds_read_b128 v[56:59], v10 offset:6144
    ds_read_b128 v[60:63], v10 offset:7168
    s_nop 3
    s_nop 3
    s_nop 3
    s_nop 3
    s_nop 3
    s_nop 3
    s_nop 3
    s_nop 3
    s_nop 3
    s_nop 3
    s_nop 3
    s_nop 3
    s_nop 3
    s_nop 3
    s_nop 3
    s_nop 3
    s_nop 3
    s_nop 3
    s_nop 3
    s_nop 3
    buffer_load_dwordx4 v[40:43], v1, s[4:7], s41 offen sc1
    buffer_load_dwordx4 v[44:47], v1, s[4:7], s41 offen offset:1024 sc1
    s_waitcnt vmcnt(1)
    v_mfma_f32_16x16x32_bf16 v[112:115], v[116:119], v[40:43], 0
    v_bitop3_b32 v14, v40, v42, s25 bitop3:0x7e
    s_waitcnt vmcnt(0)
    v_mfma_f32_16x16x32_bf16 v[112:115], v[116:119], v[44:47], v[112:115]
    v_bitop3_b32 v15, v44, v46, s25 bitop3:0x7e
    v_bitop3_b32 v14, v14, v15, 1 bitop3:0xa8
    v_cmp_ne_u32 vcc, 0, v14
    s_cbranch_vccnz L_ch_r3
L_ch_rok3:
    s_nop 3
    v_add_f32_dpp v112, v112, v112 row_ror:4 row_mask:0xf bank_mask:0xf
    v_add_f32_dpp v113, v113, v113 row_ror:4 row_mask:0xf bank_mask:0xf
    s_nop 0
    v_add_f32_dpp v112, v112, v112 row_ror:8 row_mask:0xf bank_mask:0xf
    v_add_f32_dpp v113, v113, v113 row_ror:8 row_mask:0xf bank_mask:0xf
    v_cvt_pk_bf16_f32 v124, v112, v113
    buffer_store_dword v124, v7, s[4:7], s28 offen
    v_mov_b64 v[112:113], 0
    v_mov_b64 v[114:115], 0
    v_mov_b64 v[116:117], 0
    v_mov_b64 v[118:119], 0
    s_add_u32 s28, s28, 8192
    s_add_u32 s29, s29, 8192
    s_xor_b32 s25, s25, 1
    s_waitcnt lgkmcnt(0)
    s_mov_b32 s21, 0
    s_cmp_lg_u32 s18, s36
    s_cbranch_scc1 L_ch_step3
    s_cmp_eq_u32 s18, 7
    s_cbranch_scc0 L_ch_wc3
    s_mov_b32 s36, 31
    v_mov_b32 v14, 0
    s_mov_b32 s21, 0
L_ch_wb3:
    buffer_load_dword v15, v14, s[8:11], 0 offen offset:144 sc1
    s_add_u32 s21, s21, 1
    s_cmp_gt_u32 s21, 200000
    s_cbranch_scc1 L_ch_wb3_x
    s_waitcnt vmcnt(0)
    v_cmp_gt_u32 vcc, 96, v15
    s_cbranch_vccz L_ch_wb3_x
    s_sleep 4
    s_branch L_ch_wb3
L_ch_wb3_x:
    s_waitcnt vmcnt(0)
    s_mov_b32 s21, 0
    s_branch L_ch_step3
L_ch_wc3:
    v_mov_b32 v14, 0
    s_mov_b32 s21, 0
L_ch_wd3:
    buffer_load_dword v15, v14, s[8:11], 0 offen offset:148 sc1
    s_add_u32 s21, s21, 1
    s_cmp_gt_u32 s21, 200000
    s_cbranch_scc1 L_ch_wd3_x
    s_waitcnt vmcnt(0)
    v_cmp_gt_u32 vcc, 128, v15
    s_cbranch_vccz L_ch_wd3_x
    s_sleep 4
    s_branch L_ch_wd3
L_ch_wd3_x:
    s_waitcnt vmcnt(0)
    s_mov_b32 s21, 0
    s_branch L_ch_step3
L_ch_r3:
    buffer_load_dwordx4 v[40:43], v1, s[4:7], s41 offen sc1
    buffer_load_dwordx4 v[44:47], v1, s[4:7], s41 offen offset:1024 sc1
    s_add_u32 s21, s21, 1
    s_cmp_gt_u32 s21, 200000
    s_cbranch_scc1 L_ch_fail
    s_waitcnt vmcnt(1)
    v_mfma_f32_16x16x32_bf16 v[112:115], v[116:119], v[40:43], 0
    v_bitop3_b32 v14, v40, v42, s25 bitop3:0x7e
    s_waitcnt vmcnt(0)
    v_mfma_f32_16x16x32_bf16 v[112:115], v[116:119], v[44:47], v[112:115]
    v_bitop3_b32 v15, v44, v46, s25 bitop3:0x7e
    v_bitop3_b32 v14, v14, v15, 1 bitop3:0xa8
    v_cmp_ne_u32 vcc, 0, v14
    s_cbranch_vccnz L_ch_r3
    s_nop 3
    s_branch L_ch_rok3
L_ch_slow3:
    s_mov_b64 s[38:39], 0
    s_nop 7
    v_max3_f32 v34, v96, v97, v98
    v_max3_f32 v34, v34, v99, v100
    v_max3_f32 v34, v34, v101, v102
    v_max3_f32 v34, v34, v103, v104
    v_max_f32 v34, v34, v105
    v_mov_b32 v35, v34
    s_nop 1
    v_permlane32_swap_b32 v34, v35
    v_max_f32 v34, v34, v35
    v_mov_b32 v35, v34
    s_nop 1
    v_permlane16_swap_b32 v34, v35
    v_max_f32 v34, v34, v35
    v_sub_f32 v24, v96, v34
    v_sub_f32 v25, v97, v34
    v_sub_f32 v26, v98, v34
    v_sub_f32 v27, v99, v34
    v_sub_f32 v28, v100, v34
    v_sub_f32 v29, v101, v34
    v_sub_f32 v30, v102, v34
    v_sub_f32 v31, v103, v34
    v_sub_f32 v32, v104, v34
    v_sub_f32 v33, v105, v34
    v_exp_f32 v24, v24
    v_exp_f32 v25, v25
    v_exp_f32 v26, v26
    v_exp_f32 v27, v27
    v_exp_f32 v28, v28
    v_exp_f32 v29, v29
    v_exp_f32 v30, v30
    v_exp_f32 v31, v31
    v_exp_f32 v32, v32
    v_exp_f32 v33, v33
    v_cvt_pk_bf16_f32 v108, v24, v25
    v_cvt_pk_bf16_f32 v109, v26, v27
    v_cvt_pk_bf16_f32 v110, v28, v29
    v_cvt_pk_bf16_f32 v111, v30, v31
    v_cvt_pk_bf16_f32 v124, v32, v33
    v_cvt_pk_bf16_f32 v127, v32, v33
    v_mfma_f32_16x16x32_bf16 v[112:115], v[36:39], v[108:111], 0
    v_mfma_f32_16x16x32_bf16 v[40:43], v[16:19], v[108:111], 0
    v_mfma_f32_16x16x32_bf16 v[44:47], v[20:23], v[108:111], 0
    s_nop 3
    v_mfma_f32_16x16x16_bf16 v[112:115], v[36:37], v[124:125], v[112:115]
    v_mfma_f32_16x16x16_bf16 v[40:43], v[122:123], v[124:125], v[40:43]
    v_mfma_f32_16x16x16_bf16 v[44:47], v[122:123], v[126:127], v[44:47]
    s_nop 7
    s_branch L_ch_pvdone3
L_ch_last:
    buffer_store_dwordx4 v[120:123], v1, s[4:7], s35 offen sc1
    s_branch L_ch_done
L_ch_fail:
    s_mov_b32 s85, 1
L_ch_done:
    s_waitcnt vmcnt(0) lgkmcnt(0)
    s_endpgm
L_worker:
    s_load_dwordx2 s[20:21], s[0:1], 0
    s_load_dwordx2 s[32:33], s[0:1], 16
    s_load_dwordx2 s[34:35], s[0:1], 24
    s_load_dwordx2 s[36:37], s[0:1], 32
    s_load_dwordx2 s[38:39], s[0:1], 64
    s_load_dwordx2 s[28:29], s[0:1], 72
    s_mov_b32 s22, 0x200000
    s_mov_b32 s23, 0x20000
    s_mov_b32 s30, 3584
    s_mov_b32 s31, 0x20000
    s_load_dwordx2 s[56:57], s[0:1], 40
    s_load_dwordx2 s[60:61], s[0:1], 80
    s_load_dwordx2 s[64:65], s[0:1], 88
    s_load_dwordx2 s[68:69], s[0:1], 96
    s_load_dwordx2 s[72:73], s[0:1], 104
    s_mov_b32 s58, 0x400000
    s_mov_b32 s59, 0x20000
    s_mov_b32 s62, 1835008
    s_mov_b32 s63, 0x20000
    s_mov_b32 s66, 1024
    s_mov_b32 s67, 0x20000
    s_mov_b32 s70, 1024
    s_mov_b32 s71, 0x20000
    s_mov_b32 s74, 0x200000
    s_mov_b32 s75, 0x20000
    s_sub_u32 s47, s3, 1
    s_lshl_b32 s40, s47, 5
    s_add_u32 s40, s40, s18
    s_mov_b32 s53, 256
    s_and_b32 s78, s18, 15
    s_lshr_b32 s79, s18, 4
    s_lshl_b32 s47, s47, 1
    s_add_u32 s79, s79, s47
    s_mov_b32 s77, 14
    s_mov_b32 s55, s40
    v_and_b32 v2, 63, v0
    v_lshlrev_b32 v2, 4, v2
    v_mov_b32 v4, -1
    v_mov_b32 v5, -1
    v_mov_b32 v6, -1
    v_mov_b32 v7, -1
    s_lshl_b32 s47, s79, 17
    s_lshl_b32 s48, s78, 13
    s_add_u32 s47, s47, s48
    s_lshl_b32 s48, s16, 11
    s_add_u32 s47, s47, s48
    s_add_u32 s47, s47, 4194304
    s_lshl_b32 s48, s79, 7
    s_lshl_b32 s46, s78, 2
    s_add_u32 s48, s48, s46
    s_add_u32 s48, s48, 2883584
    v_mov_b32 v8, 0
    buffer_store_dword v8, v8, s[4:7], s48 offen
    s_mov_b32 s48, s79
L_w_rst:
    buffer_store_dwordx4 v[4:7], v2, s[4:7], s47 offen sc1
    buffer_store_dwordx4 v[4:7], v2, s[4:7], s47 offen offset:1024 sc1
    s_add_u32 s47, s47, 1835008
    s_add_u32 s48, s48, 14
    s_cmp_lt_u32 s48, 64
    s_cbranch_scc1 L_w_rst
    s_waitcnt lgkmcnt(0)
    s_barrier
    v_and_b32 v1, 63, v0
    v_lshrrev_b32 v14, 3, v1
    v_and_b32 v15, 7, v1
    v_lshrrev_b32 v16, 1, v14
    v_xor_b32 v15, v15, v16
    v_lshlrev_b32 v2, 10, v14
    v_lshl_add_u32 v2, v15, 4, v2
    v_and_b32 v14, 31, v1
    v_lshrrev_b32 v15, 5, v1
    v_bfe_u32 v16, v1, 1, 3
    s_lshr_b32 s47, s16, 1
    s_lshl_b32 s47, s47, 14
    v_add_u32 v5, 0, v15
    v_xor_b32 v5, v5, v16
    v_lshlrev_b32 v5, 4, v5
    v_lshl_add_u32 v5, v14, 7, v5
    v_add_u32 v5, s47, v5
    v_add_u32 v6, 2, v15
    v_xor_b32 v6, v6, v16
    v_lshlrev_b32 v6, 4, v6
    v_lshl_add_u32 v6, v14, 7, v6
    v_add_u32 v6, s47, v6
    v_add_u32 v7, 4, v15
    v_xor_b32 v7, v7, v16
    v_lshlrev_b32 v7, 4, v7
    v_lshl_add_u32 v7, v14, 7, v7
    v_add_u32 v7, s47, v7
    v_add_u32 v8, 6, v15
    v_xor_b32 v8, v8, v16
    v_lshlrev_b32 v8, 4, v8
    v_lshl_add_u32 v8, v14, 7, v8
    v_add_u32 v8, s47, v8
    v_bfe_u32 v14, v1, 2, 2
    v_lshl_add_u32 v16, v15, 3, v14
    v_lshlrev_b32 v16, 9, v16
    v_bfe_u32 v13, v1, 4, 1
    v_lshl_add_u32 v16, v13, 5, v16
    v_and_b32 v13, 3, v1
    v_lshl_add_u32 v16, v13, 3, v16
    s_and_b32 s47, s16, 1
    s_lshl_b32 s47, s47, 8
    s_add_u32 s47, s47, 32768
    v_add_u32 v16, s47, v16
    v_xor_b32 v9, 0, v14
    v_lshl_add_u32 v9, v9, 6, v16
    v_xor_b32 v10, 1, v14
    v_lshl_add_u32 v10, v10, 6, v16
    v_xor_b32 v11, 2, v14
    v_lshl_add_u32 v11, v11, 6, v16
    v_xor_b32 v12, 3, v14
    v_lshl_add_u32 v12, v12, 6, v16
    s_lshl_b32 s51, s16, 13
    s_add_u32 s52, s51, 32768
    s_cmp_ge_u32 s40, 128
    s_cbranch_scc1 L_w_big
    s_lshr_b32 s42, s40, 2
    s_and_b32 s41, s40, 3
    s_mov_b32 s26, 0x400000
    s_mov_b32 s27, 0x20000
    s_cmp_ge_u32 s42, 16
    s_cselect_b32 s24, s36, s34
    s_cselect_b32 s25, s37, s35
    s_mov_b32 s45, 2048
    s_cselect_b32 s45, 4096, s45
    s_cselect_b32 s43, 1, 0
    s_and_b32 s42, s42, 15
    s_lshl_b32 s47, s41, 1
    s_lshr_b32 s48, s16, 1
    s_add_u32 s47, s47, s48
    s_lshl_b32 s47, s47, 5
    s_add_u32 s45, s45, s47
    s_lshl_b32 s47, s42, 1
    s_add_u32 s45, s45, s47
    s_and_b32 s47, s16, 1
    s_add_u32 s45, s45, s47
    s_lshl_b32 s45, s45, 13
    s_lshl_b32 s49, s41, 16
    s_lshl_b32 s47, s16, 14
    s_add_u32 s49, s49, s47
    s_lshl_b32 s50, s16, 17
    s_lshl_b32 s47, s42, 9
    s_add_u32 s50, s50, s47
    v_lshrrev_b32 v14, 5, v1
    v_and_b32 v15, 31, v1
    v_lshlrev_b32 v16, 2, v14
    v_xor_b32 v15, v15, v16
    v_lshlrev_b32 v15, 4, v15
    v_lshl_add_u32 v3, v14, 13, v15
    v_xor_b32 v4, 128, v3
    v_xor_b32 v16, 64, v2
    s_lshl_b32 s46, s16, 11
    s_lshl_b32 s54, s16, 13
    s_add_u32 s54, s54, 8192
    s_add_u32 m0, s46, 0
    s_add_u32 s47, s49, 0
    buffer_load_dwordx4 v2, s[20:23], s47 offen lds
    s_add_u32 m0, s46, 1024
    s_add_u32 s47, s49, 8192
    buffer_load_dwordx4 v16, s[20:23], s47 offen lds
    s_add_u32 m0, s54, 0
    s_add_u32 s47, s50, 0
    buffer_load_dwordx4 v3, s[24:27], s47 offen lds
    s_add_u32 m0, s54, 1024
    s_add_u32 s47, s50, 16384
    buffer_load_dwordx4 v4, s[24:27], s47 offen lds
    s_add_u32 m0, s54, 2048
    s_add_u32 s47, s50, 32768
    buffer_load_dwordx4 v3, s[24:27], s47 offen lds
    s_add_u32 m0, s54, 3072
    s_add_u32 s47, s50, 49152
    buffer_load_dwordx4 v4, s[24:27], s47 offen lds
    s_add_u32 m0, s54, 4096
    s_add_u32 s47, s50, 65536
    buffer_load_dwordx4 v3, s[24:27], s47 offen lds
    s_add_u32 m0, s54, 5120
    s_add_u32 s47, s50, 81920
    buffer_load_dwordx4 v4, s[24:27], s47 offen lds
    s_add_u32 m0, s54, 6144
    s_add_u32 s47, s50, 98304
    buffer_load_dwordx4 v3, s[24:27], s47 offen lds
    s_add_u32 m0, s54, 7168
    s_add_u32 s47, s50, 114688
    buffer_load_dwordx4 v4, s[24:27], s47 offen lds
    s_add_u32 m0, s46, 40960
    s_add_u32 s47, s49, 128
    buffer_load_dwordx4 v2, s[20:23], s47 offen lds
    s_add_u32 m0, s46, 41984
    s_add_u32 s47, s49, 8320
    buffer_load_dwordx4 v16, s[20:23], s47 offen lds
    s_add_u32 m0, s54, 40960
    s_add_u32 s47, s50, 524288
    buffer_load_dwordx4 v3, s[24:27], s47 offen lds
    s_add_u32 m0, s54, 41984
    s_add_u32 s47, s50, 540672
    buffer_load_dwordx4 v4, s[24:27], s47 offen lds
    s_add_u32 m0, s54, 43008
    s_add_u32 s47, s50, 557056
    buffer_load_dwordx4 v3, s[24:27], s47 offen lds
    s_add_u32 m0, s54, 44032
    s_add_u32 s47, s50, 573440
    buffer_load_dwordx4 v4, s[24:27], s47 offen lds
    s_add_u32 m0, s54, 45056
    s_add_u32 s47, s50, 589824
    buffer_load_dwordx4 v3, s[24:27], s47 offen lds
    s_add_u32 m0, s54, 46080
    s_add_u32 s47, s50, 606208
    buffer_load_dwordx4 v4, s[24:27], s47 offen lds
    s_add_u32 m0, s54, 47104
    s_add_u32 s47, s50, 622592
    buffer_load_dwordx4 v3, s[24:27], s47 offen lds
    s_add_u32 m0, s54, 48128
    s_add_u32 s47, s50, 638976
    buffer_load_dwordx4 v4, s[24:27], s47 offen lds
    s_add_u32 m0, s46, 81920
    s_add_u32 s47, s49, 256
    buffer_load_dwordx4 v2, s[20:23], s47 offen lds
    s_add_u32 m0, s46, 82944
    s_add_u32 s47, s49, 8448
    buffer_load_dwordx4 v16, s[20:23], s47 offen lds
    s_add_u32 m0, s54, 81920
    s_add_u32 s47, s50, 1048576
    buffer_load_dwordx4 v3, s[24:27], s47 offen lds
    s_add_u32 m0, s54, 82944
    s_add_u32 s47, s50, 1064960
    buffer_load_dwordx4 v4, s[24:27], s47 offen lds
    s_add_u32 m0, s54, 83968
    s_add_u32 s47, s50, 1081344
    buffer_load_dwordx4 v3, s[24:27], s47 offen lds
    s_add_u32 m0, s54, 84992
    s_add_u32 s47, s50, 1097728
    buffer_load_dwordx4 v4, s[24:27], s47 offen lds
    s_add_u32 m0, s54, 86016
    s_add_u32 s47, s50, 1114112
    buffer_load_dwordx4 v3, s[24:27], s47 offen lds
    s_add_u32 m0, s54, 87040
    s_add_u32 s47, s50, 1130496
    buffer_load_dwordx4 v4, s[24:27], s47 offen lds
    s_add_u32 m0, s54, 88064
    s_add_u32 s47, s50, 1146880
    buffer_load_dwordx4 v3, s[24:27], s47 offen lds
    s_add_u32 m0, s54, 89088
    s_add_u32 s47, s50, 1163264
    buffer_load_dwordx4 v4, s[24:27], s47 offen lds
    s_add_u32 m0, s46, 122880
    s_add_u32 s47, s49, 384
    buffer_load_dwordx4 v2, s[20:23], s47 offen lds
    s_add_u32 m0, s46, 123904
    s_add_u32 s47, s49, 8576
    buffer_load_dwordx4 v16, s[20:23], s47 offen lds
    s_add_u32 m0, s54, 122880
    s_add_u32 s47, s50, 1572864
    buffer_load_dwordx4 v3, s[24:27], s47 offen lds
    s_add_u32 m0, s54, 123904
    s_add_u32 s47, s50, 1589248
    buffer_load_dwordx4 v4, s[24:27], s47 offen lds
    s_add_u32 m0, s54, 124928
    s_add_u32 s47, s50, 1605632
    buffer_load_dwordx4 v3, s[24:27], s47 offen lds
    s_add_u32 m0, s54, 125952
    s_add_u32 s47, s50, 1622016
    buffer_load_dwordx4 v4, s[24:27], s47 offen lds
    s_add_u32 m0, s54, 126976
    s_add_u32 s47, s50, 1638400
    buffer_load_dwordx4 v3, s[24:27], s47 offen lds
    s_add_u32 m0, s54, 128000
    s_add_u32 s47, s50, 1654784
    buffer_load_dwordx4 v4, s[24:27], s47 offen lds
    s_add_u32 m0, s54, 129024
    s_add_u32 s47, s50, 1671168
    buffer_load_dwordx4 v3, s[24:27], s47 offen lds
    s_add_u32 m0, s54, 130048
    s_add_u32 s47, s50, 1687552
    buffer_load_dwordx4 v4, s[24:27], s47 offen lds
    s_lshr_b32 s47, s16, 1
    s_mul_i32 s47, s47, 12288
    v_subrev_u32 v17, s47, v5
    v_subrev_u32 v21, 24576, v9
    v_subrev_u32 v18, s47, v6
    v_subrev_u32 v22, 24576, v10
    v_subrev_u32 v19, s47, v7
    v_subrev_u32 v23, 24576, v11
    v_subrev_u32 v20, s47, v8
    v_subrev_u32 v24, 24576, v12
    s_cmp_eq_u32 s43, 1
    s_cbranch_scc1 L_mi_v
    v_add_u32 v25, 0, v17
    v_add_u32 v112, 0, v21
    v_add_u32 v26, 0, v18
    v_add_u32 v113, 0, v22
    v_add_u32 v27, 0, v19
    v_add_u32 v114, 0, v23
    v_add_u32 v28, 0, v20
    v_add_u32 v115, 0, v24
    s_waitcnt vmcnt(30)
    s_barrier
    ds_read_b128 v[32:35], v25
    ds_read_b64_tr_b16 v[36:37], v112 offset:0
    ds_read_b64_tr_b16 v[38:39], v112 offset:2048
    ds_read_b64_tr_b16 v[40:41], v113 offset:0
    ds_read_b64_tr_b16 v[42:43], v113 offset:2048
    ds_read_b64_tr_b16 v[44:45], v114 offset:0
    ds_read_b64_tr_b16 v[46:47], v114 offset:2048
    ds_read_b64_tr_b16 v[48:49], v115 offset:0
    ds_read_b64_tr_b16 v[50:51], v115 offset:2048
    ds_read_b128 v[52:55], v26
    ds_read_b64_tr_b16 v[56:57], v112 offset:8192
    ds_read_b64_tr_b16 v[58:59], v112 offset:10240
    ds_read_b64_tr_b16 v[60:61], v113 offset:8192
    ds_read_b64_tr_b16 v[62:63], v113 offset:10240
    ds_read_b64_tr_b16 v[64:65], v114 offset:8192
    ds_read_b64_tr_b16 v[66:67], v114 offset:10240
    ds_read_b64_tr_b16 v[68:69], v115 offset:8192
    ds_read_b64_tr_b16 v[70:71], v115 offset:10240
    s_waitcnt lgkmcnt(9)
    v_mfma_f32_32x32x16_bf16 v[128:143], v[36:39], v[32:35], 0
    v_mfma_f32_32x32x16_bf16 v[144:159], v[40:43], v[32:35], 0
    v_mfma_f32_32x32x16_bf16 v[160:175], v[44:47], v[32:35], 0
    v_mfma_f32_32x32x16_bf16 v[176:191], v[48:51], v[32:35], 0
    ds_read_b128 v[72:75], v27
    ds_read_b64_tr_b16 v[76:77], v112 offset:16384
    ds_read_b64_tr_b16 v[78:79], v112 offset:18432
    ds_read_b64_tr_b16 v[80:81], v113 offset:16384
    ds_read_b64_tr_b16 v[82:83], v113 offset:18432
    ds_read_b64_tr_b16 v[84:85], v114 offset:16384
    ds_read_b64_tr_b16 v[86:87], v114 offset:18432
    ds_read_b64_tr_b16 v[88:89], v115 offset:16384
    ds_read_b64_tr_b16 v[90:91], v115 offset:18432
    s_waitcnt lgkmcnt(9)
    v_mfma_f32_32x32x16_bf16 v[128:143], v[56:59], v[52:55], v[128:143]
    v_mfma_f32_32x32x16_bf16 v[144:159], v[60:63], v[52:55], v[144:159]
    v_mfma_f32_32x32x16_bf16 v[160:175], v[64:67], v[52:55], v[160:175]
    v_mfma_f32_32x32x16_bf16 v[176:191], v[68:71], v[52:55], v[176:191]
    ds_read_b128 v[92:95], v28
    ds_read_b64_tr_b16 v[96:97], v112 offset:24576
    ds_read_b64_tr_b16 v[98:99], v112 offset:26624
    ds_read_b64_tr_b16 v[100:101], v113 offset:24576
    ds_read_b64_tr_b16 v[102:103], v113 offset:26624
    ds_read_b64_tr_b16 v[104:105], v114 offset:24576
    ds_read_b64_tr_b16 v[106:107], v114 offset:26624
    ds_read_b64_tr_b16 v[108:109], v115 offset:24576
    ds_read_b64_tr_b16 v[110:111], v115 offset:26624
    s_waitcnt lgkmcnt(9)
    v_mfma_f32_32x32x16_bf16 v[128:143], v[76:79], v[72:75], v[128:143]
    v_mfma_f32_32x32x16_bf16 v[144:159], v[80:83], v[72:75], v[144:159]
    v_mfma_f32_32x32x16_bf16 v[160:175], v[84:87], v[72:75], v[160:175]
    v_mfma_f32_32x32x16_bf16 v[176:191], v[88:91], v[72:75], v[176:191]
    s_waitcnt lgkmcnt(0)
    v_mfma_f32_32x32x16_bf16 v[128:143], v[96:99], v[92:95], v[128:143]
    v_mfma_f32_32x32x16_bf16 v[144:159], v[100:103], v[92:95], v[144:159]
    v_mfma_f32_32x32x16_bf16 v[160:175], v[104:107], v[92:95], v[160:175]
    v_mfma_f32_32x32x16_bf16 v[176:191], v[108:111], v[92:95], v[176:191]
    v_add_u32 v25, 40960, v17
    v_add_u32 v112, 40960, v21
    v_add_u32 v26, 40960, v18
    v_add_u32 v113, 40960, v22
    v_add_u32 v27, 40960, v19
    v_add_u32 v114, 40960, v23
    v_add_u32 v28, 40960, v20
    v_add_u32 v115, 40960, v24
    s_waitcnt vmcnt(20)
    s_barrier
    s_add_u32 m0, s46, 0
    s_add_u32 s47, s49, 512
    buffer_load_dwordx4 v2, s[20:23], s47 offen lds
    s_add_u32 m0, s46, 1024
    s_add_u32 s47, s49, 8704
    buffer_load_dwordx4 v16, s[20:23], s47 offen lds
    s_add_u32 m0, s54, 0
    s_add_u32 s47, s50, 2097152
    buffer_load_dwordx4 v3, s[24:27], s47 offen lds
    s_add_u32 m0, s54, 1024
    s_add_u32 s47, s50, 2113536
    buffer_load_dwordx4 v4, s[24:27], s47 offen lds
    s_add_u32 m0, s54, 2048
    s_add_u32 s47, s50, 2129920
    buffer_load_dwordx4 v3, s[24:27], s47 offen lds
    s_add_u32 m0, s54, 3072
    s_add_u32 s47, s50, 2146304
    buffer_load_dwordx4 v4, s[24:27], s47 offen lds
    s_add_u32 m0, s54, 4096
    s_add_u32 s47, s50, 2162688
    buffer_load_dwordx4 v3, s[24:27], s47 offen lds
    s_add_u32 m0, s54, 5120
    s_add_u32 s47, s50, 2179072
    buffer_load_dwordx4 v4, s[24:27], s47 offen lds
    s_add_u32 m0, s54, 6144
    s_add_u32 s47, s50, 2195456
    buffer_load_dwordx4 v3, s[24:27], s47 offen lds
    s_add_u32 m0, s54, 7168
    s_add_u32 s47, s50, 2211840
    buffer_load_dwordx4 v4, s[24:27], s47 offen lds
    ds_read_b128 v[32:35], v25
    ds_read_b64_tr_b16 v[36:37], v112 offset:0
    ds_read_b64_tr_b16 v[38:39], v112 offset:2048
    ds_read_b64_tr_b16 v[40:41], v113 offset:0
    ds_read_b64_tr_b16 v[42:43], v113 offset:2048
    ds_read_b64_tr_b16 v[44:45], v114 offset:0
    ds_read_b64_tr_b16 v[46:47], v114 offset:2048
    ds_read_b64_tr_b16 v[48:49], v115 offset:0
    ds_read_b64_tr_b16 v[50:51], v115 offset:2048
    ds_read_b128 v[52:55], v26
    ds_read_b64_tr_b16 v[56:57], v112 offset:8192
    ds_read_b64_tr_b16 v[58:59], v112 offset:10240
    ds_read_b64_tr_b16 v[60:61], v113 offset:8192
    ds_read_b64_tr_b16 v[62:63], v113 offset:10240
    ds_read_b64_tr_b16 v[64:65], v114 offset:8192
    ds_read_b64_tr_b16 v[66:67], v114 offset:10240
    ds_read_b64_tr_b16 v[68:69], v115 offset:8192
    ds_read_b64_tr_b16 v[70:71], v115 offset:10240
    s_waitcnt lgkmcnt(9)
    v_mfma_f32_32x32x16_bf16 v[128:143], v[36:39], v[32:35], v[128:143]
    v_mfma_f32_32x32x16_bf16 v[144:159], v[40:43], v[32:35], v[144:159]
    v_mfma_f32_32x32x16_bf16 v[160:175], v[44:47], v[32:35], v[160:175]
    v_mfma_f32_32x32x16_bf16 v[176:191], v[48:51], v[32:35], v[176:191]
    ds_read_b128 v[72:75], v27
    ds_read_b64_tr_b16 v[76:77], v112 offset:16384
    ds_read_b64_tr_b16 v[78:79], v112 offset:18432
    ds_read_b64_tr_b16 v[80:81], v113 offset:16384
    ds_read_b64_tr_b16 v[82:83], v113 offset:18432
    ds_read_b64_tr_b16 v[84:85], v114 offset:16384
    ds_read_b64_tr_b16 v[86:87], v114 offset:18432
    ds_read_b64_tr_b16 v[88:89], v115 offset:16384
    ds_read_b64_tr_b16 v[90:91], v115 offset:18432
    s_waitcnt lgkmcnt(9)
    v_mfma_f32_32x32x16_bf16 v[128:143], v[56:59], v[52:55], v[128:143]
    v_mfma_f32_32x32x16_bf16 v[144:159], v[60:63], v[52:55], v[144:159]
    v_mfma_f32_32x32x16_bf16 v[160:175], v[64:67], v[52:55], v[160:175]
    v_mfma_f32_32x32x16_bf16 v[176:191], v[68:71], v[52:55], v[176:191]
    ds_read_b128 v[92:95], v28
    ds_read_b64_tr_b16 v[96:97], v112 offset:24576
    ds_read_b64_tr_b16 v[98:99], v112 offset:26624
    ds_read_b64_tr_b16 v[100:101], v113 offset:24576
    ds_read_b64_tr_b16 v[102:103], v113 offset:26624
    ds_read_b64_tr_b16 v[104:105], v114 offset:24576
    ds_read_b64_tr_b16 v[106:107], v114 offset:26624
    ds_read_b64_tr_b16 v[108:109], v115 offset:24576
    ds_read_b64_tr_b16 v[110:111], v115 offset:26624
    s_waitcnt lgkmcnt(9)
    v_mfma_f32_32x32x16_bf16 v[128:143], v[76:79], v[72:75], v[128:143]
    v_mfma_f32_32x32x16_bf16 v[144:159], v[80:83], v[72:75], v[144:159]
    v_mfma_f32_32x32x16_bf16 v[160:175], v[84:87], v[72:75], v[160:175]
    v_mfma_f32_32x32x16_bf16 v[176:191], v[88:91], v[72:75], v[176:191]
    s_waitcnt lgkmcnt(0)
    v_mfma_f32_32x32x16_bf16 v[128:143], v[96:99], v[92:95], v[128:143]
    v_mfma_f32_32x32x16_bf16 v[144:159], v[100:103], v[92:95], v[144:159]
    v_mfma_f32_32x32x16_bf16 v[160:175], v[104:107], v[92:95], v[160:175]
    v_mfma_f32_32x32x16_bf16 v[176:191], v[108:111], v[92:95], v[176:191]
    v_add_u32 v25, 81920, v17
    v_add_u32 v112, 81920, v21
    v_add_u32 v26, 81920, v18
    v_add_u32 v113, 81920, v22
    v_add_u32 v27, 81920, v19
    v_add_u32 v114, 81920, v23
    v_add_u32 v28, 81920, v20
    v_add_u32 v115, 81920, v24
    s_waitcnt vmcnt(20)
    s_barrier
    s_add_u32 m0, s46, 40960
    s_add_u32 s47, s49, 640
    buffer_load_dwordx4 v2, s[20:23], s47 offen lds
    s_add_u32 m0, s46, 41984
    s_add_u32 s47, s49, 8832
    buffer_load_dwordx4 v16, s[20:23], s47 offen lds
    s_add_u32 m0, s54, 40960
    s_add_u32 s47, s50, 2621440
    buffer_load_dwordx4 v3, s[24:27], s47 offen lds
    s_add_u32 m0, s54, 41984
    s_add_u32 s47, s50, 2637824
    buffer_load_dwordx4 v4, s[24:27], s47 offen lds
    s_add_u32 m0, s54, 43008
    s_add_u32 s47, s50, 2654208
    buffer_load_dwordx4 v3, s[24:27], s47 offen lds
    s_add_u32 m0, s54, 44032
    s_add_u32 s47, s50, 2670592
    buffer_load_dwordx4 v4, s[24:27], s47 offen lds
    s_add_u32 m0, s54, 45056
    s_add_u32 s47, s50, 2686976
    buffer_load_dwordx4 v3, s[24:27], s47 offen lds
    s_add_u32 m0, s54, 46080
    s_add_u32 s47, s50, 2703360
    buffer_load_dwordx4 v4, s[24:27], s47 offen lds
    s_add_u32 m0, s54, 47104
    s_add_u32 s47, s50, 2719744
    buffer_load_dwordx4 v3, s[24:27], s47 offen lds
    s_add_u32 m0, s54, 48128
    s_add_u32 s47, s50, 2736128
    buffer_load_dwordx4 v4, s[24:27], s47 offen lds
    ds_read_b128 v[32:35], v25
    ds_read_b64_tr_b16 v[36:37], v112 offset:0
    ds_read_b64_tr_b16 v[38:39], v112 offset:2048
    ds_read_b64_tr_b16 v[40:41], v113 offset:0
    ds_read_b64_tr_b16 v[42:43], v113 offset:2048
    ds_read_b64_tr_b16 v[44:45], v114 offset:0
    ds_read_b64_tr_b16 v[46:47], v114 offset:2048
    ds_read_b64_tr_b16 v[48:49], v115 offset:0
    ds_read_b64_tr_b16 v[50:51], v115 offset:2048
    ds_read_b128 v[52:55], v26
    ds_read_b64_tr_b16 v[56:57], v112 offset:8192
    ds_read_b64_tr_b16 v[58:59], v112 offset:10240
    ds_read_b64_tr_b16 v[60:61], v113 offset:8192
    ds_read_b64_tr_b16 v[62:63], v113 offset:10240
    ds_read_b64_tr_b16 v[64:65], v114 offset:8192
    ds_read_b64_tr_b16 v[66:67], v114 offset:10240
    ds_read_b64_tr_b16 v[68:69], v115 offset:8192
    ds_read_b64_tr_b16 v[70:71], v115 offset:10240
    s_waitcnt lgkmcnt(9)
    v_mfma_f32_32x32x16_bf16 v[128:143], v[36:39], v[32:35], v[128:143]
    v_mfma_f32_32x32x16_bf16 v[144:159], v[40:43], v[32:35], v[144:159]
    v_mfma_f32_32x32x16_bf16 v[160:175], v[44:47], v[32:35], v[160:175]
    v_mfma_f32_32x32x16_bf16 v[176:191], v[48:51], v[32:35], v[176:191]
    ds_read_b128 v[72:75], v27
    ds_read_b64_tr_b16 v[76:77], v112 offset:16384
    ds_read_b64_tr_b16 v[78:79], v112 offset:18432
    ds_read_b64_tr_b16 v[80:81], v113 offset:16384
    ds_read_b64_tr_b16 v[82:83], v113 offset:18432
    ds_read_b64_tr_b16 v[84:85], v114 offset:16384
    ds_read_b64_tr_b16 v[86:87], v114 offset:18432
    ds_read_b64_tr_b16 v[88:89], v115 offset:16384
    ds_read_b64_tr_b16 v[90:91], v115 offset:18432
    s_waitcnt lgkmcnt(9)
    v_mfma_f32_32x32x16_bf16 v[128:143], v[56:59], v[52:55], v[128:143]
    v_mfma_f32_32x32x16_bf16 v[144:159], v[60:63], v[52:55], v[144:159]
    v_mfma_f32_32x32x16_bf16 v[160:175], v[64:67], v[52:55], v[160:175]
    v_mfma_f32_32x32x16_bf16 v[176:191], v[68:71], v[52:55], v[176:191]
    ds_read_b128 v[92:95], v28
    ds_read_b64_tr_b16 v[96:97], v112 offset:24576
    ds_read_b64_tr_b16 v[98:99], v112 offset:26624
    ds_read_b64_tr_b16 v[100:101], v113 offset:24576
    ds_read_b64_tr_b16 v[102:103], v113 offset:26624
    ds_read_b64_tr_b16 v[104:105], v114 offset:24576
    ds_read_b64_tr_b16 v[106:107], v114 offset:26624
    ds_read_b64_tr_b16 v[108:109], v115 offset:24576
    ds_read_b64_tr_b16 v[110:111], v115 offset:26624
    s_waitcnt lgkmcnt(9)
    v_mfma_f32_32x32x16_bf16 v[128:143], v[76:79], v[72:75], v[128:143]
    v_mfma_f32_32x32x16_bf16 v[144:159], v[80:83], v[72:75], v[144:159]
    v_mfma_f32_32x32x16_bf16 v[160:175], v[84:87], v[72:75], v[160:175]
    v_mfma_f32_32x32x16_bf16 v[176:191], v[88:91], v[72:75], v[176:191]
    s_waitcnt lgkmcnt(0)
    v_mfma_f32_32x32x16_bf16 v[128:143], v[96:99], v[92:95], v[128:143]
    v_mfma_f32_32x32x16_bf16 v[144:159], v[100:103], v[92:95], v[144:159]
    v_mfma_f32_32x32x16_bf16 v[160:175], v[104:107], v[92:95], v[160:175]
    v_mfma_f32_32x32x16_bf16 v[176:191], v[108:111], v[92:95], v[176:191]
    v_add_u32 v25, 122880, v17
    v_add_u32 v112, 122880, v21
    v_add_u32 v26, 122880, v18
    v_add_u32 v113, 122880, v22
    v_add_u32 v27, 122880, v19
    v_add_u32 v114, 122880, v23
    v_add_u32 v28, 122880, v20
    v_add_u32 v115, 122880, v24
    s_waitcnt vmcnt(20)
    s_barrier
    s_add_u32 m0, s46, 81920
    s_add_u32 s47, s49, 768
    buffer_load_dwordx4 v2, s[20:23], s47 offen lds
    s_add_u32 m0, s46, 82944
    s_add_u32 s47, s49, 8960
    buffer_load_dwordx4 v16, s[20:23], s47 offen lds
    s_add_u32 m0, s54, 81920
    s_add_u32 s47, s50, 3145728
    buffer_load_dwordx4 v3, s[24:27], s47 offen lds
    s_add_u32 m0, s54, 82944
    s_add_u32 s47, s50, 3162112
    buffer_load_dwordx4 v4, s[24:27], s47 offen lds
    s_add_u32 m0, s54, 83968
    s_add_u32 s47, s50, 3178496
    buffer_load_dwordx4 v3, s[24:27], s47 offen lds
    s_add_u32 m0, s54, 84992
    s_add_u32 s47, s50, 3194880
    buffer_load_dwordx4 v4, s[24:27], s47 offen lds
    s_add_u32 m0, s54, 86016
    s_add_u32 s47, s50, 3211264
    buffer_load_dwordx4 v3, s[24:27], s47 offen lds
    s_add_u32 m0, s54, 87040
    s_add_u32 s47, s50, 3227648
    buffer_load_dwordx4 v4, s[24:27], s47 offen lds
    s_add_u32 m0, s54, 88064
    s_add_u32 s47, s50, 3244032
    buffer_load_dwordx4 v3, s[24:27], s47 offen lds
    s_add_u32 m0, s54, 89088
    s_add_u32 s47, s50, 3260416
    buffer_load_dwordx4 v4, s[24:27], s47 offen lds
    ds_read_b128 v[32:35], v25
    ds_read_b64_tr_b16 v[36:37], v112 offset:0
    ds_read_b64_tr_b16 v[38:39], v112 offset:2048
    ds_read_b64_tr_b16 v[40:41], v113 offset:0
    ds_read_b64_tr_b16 v[42:43], v113 offset:2048
    ds_read_b64_tr_b16 v[44:45], v114 offset:0
    ds_read_b64_tr_b16 v[46:47], v114 offset:2048
    ds_read_b64_tr_b16 v[48:49], v115 offset:0
    ds_read_b64_tr_b16 v[50:51], v115 offset:2048
    ds_read_b128 v[52:55], v26
    ds_read_b64_tr_b16 v[56:57], v112 offset:8192
    ds_read_b64_tr_b16 v[58:59], v112 offset:10240
    ds_read_b64_tr_b16 v[60:61], v113 offset:8192
    ds_read_b64_tr_b16 v[62:63], v113 offset:10240
    ds_read_b64_tr_b16 v[64:65], v114 offset:8192
    ds_read_b64_tr_b16 v[66:67], v114 offset:10240
    ds_read_b64_tr_b16 v[68:69], v115 offset:8192
    ds_read_b64_tr_b16 v[70:71], v115 offset:10240
    s_waitcnt lgkmcnt(9)
    v_mfma_f32_32x32x16_bf16 v[128:143], v[36:39], v[32:35], v[128:143]
    v_mfma_f32_32x32x16_bf16 v[144:159], v[40:43], v[32:35], v[144:159]
    v_mfma_f32_32x32x16_bf16 v[160:175], v[44:47], v[32:35], v[160:175]
    v_mfma_f32_32x32x16_bf16 v[176:191], v[48:51], v[32:35], v[176:191]
    ds_read_b128 v[72:75], v27
    ds_read_b64_tr_b16 v[76:77], v112 offset:16384
    ds_read_b64_tr_b16 v[78:79], v112 offset:18432
    ds_read_b64_tr_b16 v[80:81], v113 offset:16384
    ds_read_b64_tr_b16 v[82:83], v113 offset:18432
    ds_read_b64_tr_b16 v[84:85], v114 offset:16384
    ds_read_b64_tr_b16 v[86:87], v114 offset:18432
    ds_read_b64_tr_b16 v[88:89], v115 offset:16384
    ds_read_b64_tr_b16 v[90:91], v115 offset:18432
    s_waitcnt lgkmcnt(9)
    v_mfma_f32_32x32x16_bf16 v[128:143], v[56:59], v[52:55], v[128:143]
    v_mfma_f32_32x32x16_bf16 v[144:159], v[60:63], v[52:55], v[144:159]
    v_mfma_f32_32x32x16_bf16 v[160:175], v[64:67], v[52:55], v[160:175]
    v_mfma_f32_32x32x16_bf16 v[176:191], v[68:71], v[52:55], v[176:191]
    ds_read_b128 v[92:95], v28
    ds_read_b64_tr_b16 v[96:97], v112 offset:24576
    ds_read_b64_tr_b16 v[98:99], v112 offset:26624
    ds_read_b64_tr_b16 v[100:101], v113 offset:24576
    ds_read_b64_tr_b16 v[102:103], v113 offset:26624
    ds_read_b64_tr_b16 v[104:105], v114 offset:24576
    ds_read_b64_tr_b16 v[106:107], v114 offset:26624
    ds_read_b64_tr_b16 v[108:109], v115 offset:24576
    ds_read_b64_tr_b16 v[110:111], v115 offset:26624
    s_waitcnt lgkmcnt(9)
    v_mfma_f32_32x32x16_bf16 v[128:143], v[76:79], v[72:75], v[128:143]
    v_mfma_f32_32x32x16_bf16 v[144:159], v[80:83], v[72:75], v[144:159]
    v_mfma_f32_32x32x16_bf16 v[160:175], v[84:87], v[72:75], v[160:175]
    v_mfma_f32_32x32x16_bf16 v[176:191], v[88:91], v[72:75], v[176:191]
    s_waitcnt lgkmcnt(0)
    v_mfma_f32_32x32x16_bf16 v[128:143], v[96:99], v[92:95], v[128:143]
    v_mfma_f32_32x32x16_bf16 v[144:159], v[100:103], v[92:95], v[144:159]
    v_mfma_f32_32x32x16_bf16 v[160:175], v[104:107], v[92:95], v[160:175]
    v_mfma_f32_32x32x16_bf16 v[176:191], v[108:111], v[92:95], v[176:191]
    v_add_u32 v25, 0, v17
    v_add_u32 v112, 0, v21
    v_add_u32 v26, 0, v18
    v_add_u32 v113, 0, v22
    v_add_u32 v27, 0, v19
    v_add_u32 v114, 0, v23
    v_add_u32 v28, 0, v20
    v_add_u32 v115, 0, v24
    s_waitcnt vmcnt(20)
    s_barrier
    s_add_u32 m0, s46, 122880
    s_add_u32 s47, s49, 896
    buffer_load_dwordx4 v2, s[20:23], s47 offen lds
    s_add_u32 m0, s46, 123904
    s_add_u32 s47, s49, 9088
    buffer_load_dwordx4 v16, s[20:23], s47 offen lds
    s_add_u32 m0, s54, 122880
    s_add_u32 s47, s50, 3670016
    buffer_load_dwordx4 v3, s[24:27], s47 offen lds
    s_add_u32 m0, s54, 123904
    s_add_u32 s47, s50, 3686400
    buffer_load_dwordx4 v4, s[24:27], s47 offen lds
    s_add_u32 m0, s54, 124928
    s_add_u32 s47, s50, 3702784
    buffer_load_dwordx4 v3, s[24:27], s47 offen lds
    s_add_u32 m0, s54, 125952
    s_add_u32 s47, s50, 3719168
    buffer_load_dwordx4 v4, s[24:27], s47 offen lds
    s_add_u32 m0, s54, 126976
    s_add_u32 s47, s50, 3735552
    buffer_load_dwordx4 v3, s[24:27], s47 offen lds
    s_add_u32 m0, s54, 128000
    s_add_u32 s47, s50, 3751936
    buffer_load_dwordx4 v4, s[24:27], s47 offen lds
    s_add_u32 m0, s54, 129024
    s_add_u32 s47, s50, 3768320
    buffer_load_dwordx4 v3, s[24:27], s47 offen lds
    s_add_u32 m0, s54, 130048
    s_add_u32 s47, s50, 3784704
    buffer_load_dwordx4 v4, s[24:27], s47 offen lds
    ds_read_b128 v[32:35], v25
    ds_read_b64_tr_b16 v[36:37], v112 offset:0
    ds_read_b64_tr_b16 v[38:39], v112 offset:2048
    ds_read_b64_tr_b16 v[40:41], v113 offset:0
    ds_read_b64_tr_b16 v[42:43], v113 offset:2048
    ds_read_b64_tr_b16 v[44:45], v114 offset:0
    ds_read_b64_tr_b16 v[46:47], v114 offset:2048
    ds_read_b64_tr_b16 v[48:49], v115 offset:0
    ds_read_b64_tr_b16 v[50:51], v115 offset:2048
    ds_read_b128 v[52:55], v26
    ds_read_b64_tr_b16 v[56:57], v112 offset:8192
    ds_read_b64_tr_b16 v[58:59], v112 offset:10240
    ds_read_b64_tr_b16 v[60:61], v113 offset:8192
    ds_read_b64_tr_b16 v[62:63], v113 offset:10240
    ds_read_b64_tr_b16 v[64:65], v114 offset:8192
    ds_read_b64_tr_b16 v[66:67], v114 offset:10240
    ds_read_b64_tr_b16 v[68:69], v115 offset:8192
    ds_read_b64_tr_b16 v[70:71], v115 offset:10240
    s_waitcnt lgkmcnt(9)
    v_mfma_f32_32x32x16_bf16 v[128:143], v[36:39], v[32:35], v[128:143]
    v_mfma_f32_32x32x16_bf16 v[144:159], v[40:43], v[32:35], v[144:159]
    v_mfma_f32_32x32x16_bf16 v[160:175], v[44:47], v[32:35], v[160:175]
    v_mfma_f32_32x32x16_bf16 v[176:191], v[48:51], v[32:35], v[176:191]
    ds_read_b128 v[72:75], v27
    ds_read_b64_tr_b16 v[76:77], v112 offset:16384
    ds_read_b64_tr_b16 v[78:79], v112 offset:18432
    ds_read_b64_tr_b16 v[80:81], v113 offset:16384
    ds_read_b64_tr_b16 v[82:83], v113 offset:18432
    ds_read_b64_tr_b16 v[84:85], v114 offset:16384
    ds_read_b64_tr_b16 v[86:87], v114 offset:18432
    ds_read_b64_tr_b16 v[88:89], v115 offset:16384
    ds_read_b64_tr_b16 v[90:91], v115 offset:18432
    s_waitcnt lgkmcnt(9)
    v_mfma_f32_32x32x16_bf16 v[128:143], v[56:59], v[52:55], v[128:143]
    v_mfma_f32_32x32x16_bf16 v[144:159], v[60:63], v[52:55], v[144:159]
    v_mfma_f32_32x32x16_bf16 v[160:175], v[64:67], v[52:55], v[160:175]
    v_mfma_f32_32x32x16_bf16 v[176:191], v[68:71], v[52:55], v[176:191]
    ds_read_b128 v[92:95], v28
    ds_read_b64_tr_b16 v[96:97], v112 offset:24576
    ds_read_b64_tr_b16 v[98:99], v112 offset:26624
    ds_read_b64_tr_b16 v[100:101], v113 offset:24576
    ds_read_b64_tr_b16 v[102:103], v113 offset:26624
    ds_read_b64_tr_b16 v[104:105], v114 offset:24576
    ds_read_b64_tr_b16 v[106:107], v114 offset:26624
    ds_read_b64_tr_b16 v[108:109], v115 offset:24576
    ds_read_b64_tr_b16 v[110:111], v115 offset:26624
    s_waitcnt lgkmcnt(9)
    v_mfma_f32_32x32x16_bf16 v[128:143], v[76:79], v[72:75], v[128:143]
    v_mfma_f32_32x32x16_bf16 v[144:159], v[80:83], v[72:75], v[144:159]
    v_mfma_f32_32x32x16_bf16 v[160:175], v[84:87], v[72:75], v[160:175]
    v_mfma_f32_32x32x16_bf16 v[176:191], v[88:91], v[72:75], v[176:191]
    s_waitcnt lgkmcnt(0)
    v_mfma_f32_32x32x16_bf16 v[128:143], v[96:99], v[92:95], v[128:143]
    v_mfma_f32_32x32x16_bf16 v[144:159], v[100:103], v[92:95], v[144:159]
    v_mfma_f32_32x32x16_bf16 v[160:175], v[104:107], v[92:95], v[160:175]
    v_mfma_f32_32x32x16_bf16 v[176:191], v[108:111], v[92:95], v[176:191]
    v_add_u32 v25, 40960, v17
    v_add_u32 v112, 40960, v21
    v_add_u32 v26, 40960, v18
    v_add_u32 v113, 40960, v22
    v_add_u32 v27, 40960, v19
    v_add_u32 v114, 40960, v23
    v_add_u32 v28, 40960, v20
    v_add_u32 v115, 40960, v24
    s_waitcnt vmcnt(20)
    s_barrier
    ds_read_b128 v[32:35], v25
    ds_read_b64_tr_b16 v[36:37], v112 offset:0
    ds_read_b64_tr_b16 v[38:39], v112 offset:2048
    ds_read_b64_tr_b16 v[40:41], v113 offset:0
    ds_read_b64_tr_b16 v[42:43], v113 offset:2048
    ds_read_b64_tr_b16 v[44:45], v114 offset:0
    ds_read_b64_tr_b16 v[46:47], v114 offset:2048
    ds_read_b64_tr_b16 v[48:49], v115 offset:0
    ds_read_b64_tr_b16 v[50:51], v115 offset:2048
    ds_read_b128 v[52:55], v26
    ds_read_b64_tr_b16 v[56:57], v112 offset:8192
    ds_read_b64_tr_b16 v[58:59], v112 offset:10240
    ds_read_b64_tr_b16 v[60:61], v113 offset:8192
    ds_read_b64_tr_b16 v[62:63], v113 offset:10240
    ds_read_b64_tr_b16 v[64:65], v114 offset:8192
    ds_read_b64_tr_b16 v[66:67], v114 offset:10240
    ds_read_b64_tr_b16 v[68:69], v115 offset:8192
    ds_read_b64_tr_b16 v[70:71], v115 offset:10240
    s_waitcnt lgkmcnt(9)
    v_mfma_f32_32x32x16_bf16 v[128:143], v[36:39], v[32:35], v[128:143]
    v_mfma_f32_32x32x16_bf16 v[144:159], v[40:43], v[32:35], v[144:159]
    v_mfma_f32_32x32x16_bf16 v[160:175], v[44:47], v[32:35], v[160:175]
    v_mfma_f32_32x32x16_bf16 v[176:191], v[48:51], v[32:35], v[176:191]
    ds_read_b128 v[72:75], v27
    ds_read_b64_tr_b16 v[76:77], v112 offset:16384
    ds_read_b64_tr_b16 v[78:79], v112 offset:18432
    ds_read_b64_tr_b16 v[80:81], v113 offset:16384
    ds_read_b64_tr_b16 v[82:83], v113 offset:18432
    ds_read_b64_tr_b16 v[84:85], v114 offset:16384
    ds_read_b64_tr_b16 v[86:87], v114 offset:18432
    ds_read_b64_tr_b16 v[88:89], v115 offset:16384
    ds_read_b64_tr_b16 v[90:91], v115 offset:18432
    s_waitcnt lgkmcnt(9)
    v_mfma_f32_32x32x16_bf16 v[128:143], v[56:59], v[52:55], v[128:143]
    v_mfma_f32_32x32x16_bf16 v[144:159], v[60:63], v[52:55], v[144:159]
    v_mfma_f32_32x32x16_bf16 v[160:175], v[64:67], v[52:55], v[160:175]
    v_mfma_f32_32x32x16_bf16 v[176:191], v[68:71], v[52:55], v[176:191]
    ds_read_b128 v[92:95], v28
    ds_read_b64_tr_b16 v[96:97], v112 offset:24576
    ds_read_b64_tr_b16 v[98:99], v112 offset:26624
    ds_read_b64_tr_b16 v[100:101], v113 offset:24576
    ds_read_b64_tr_b16 v[102:103], v113 offset:26624
    ds_read_b64_tr_b16 v[104:105], v114 offset:24576
    ds_read_b64_tr_b16 v[106:107], v114 offset:26624
    ds_read_b64_tr_b16 v[108:109], v115 offset:24576
    ds_read_b64_tr_b16 v[110:111], v115 offset:26624
    s_waitcnt lgkmcnt(9)
    v_mfma_f32_32x32x16_bf16 v[128:143], v[76:79], v[72:75], v[128:143]
    v_mfma_f32_32x32x16_bf16 v[144:159], v[80:83], v[72:75], v[144:159]
    v_mfma_f32_32x32x16_bf16 v[160:175], v[84:87], v[72:75], v[160:175]
    v_mfma_f32_32x32x16_bf16 v[176:191], v[88:91], v[72:75], v[176:191]
    s_waitcnt lgkmcnt(0)
    v_mfma_f32_32x32x16_bf16 v[128:143], v[96:99], v[92:95], v[128:143]
    v_mfma_f32_32x32x16_bf16 v[144:159], v[100:103], v[92:95], v[144:159]
    v_mfma_f32_32x32x16_bf16 v[160:175], v[104:107], v[92:95], v[160:175]
    v_mfma_f32_32x32x16_bf16 v[176:191], v[108:111], v[92:95], v[176:191]
    v_add_u32 v25, 81920, v17
    v_add_u32 v112, 81920, v21
    v_add_u32 v26, 81920, v18
    v_add_u32 v113, 81920, v22
    v_add_u32 v27, 81920, v19
    v_add_u32 v114, 81920, v23
    v_add_u32 v28, 81920, v20
    v_add_u32 v115, 81920, v24
    s_waitcnt vmcnt(10)
    s_barrier
    ds_read_b128 v[32:35], v25
    ds_read_b64_tr_b16 v[36:37], v112 offset:0
    ds_read_b64_tr_b16 v[38:39], v112 offset:2048
    ds_read_b64_tr_b16 v[40:41], v113 offset:0
    ds_read_b64_tr_b16 v[42:43], v113 offset:2048
    ds_read_b64_tr_b16 v[44:45], v114 offset:0
    ds_read_b64_tr_b16 v[46:47], v114 offset:2048
    ds_read_b64_tr_b16 v[48:49], v115 offset:0
    ds_read_b64_tr_b16 v[50:51], v115 offset:2048
    ds_read_b128 v[52:55], v26
    ds_read_b64_tr_b16 v[56:57], v112 offset:8192
    ds_read_b64_tr_b16 v[58:59], v112 offset:10240
    ds_read_b64_tr_b16 v[60:61], v113 offset:8192
    ds_read_b64_tr_b16 v[62:63], v113 offset:10240
    ds_read_b64_tr_b16 v[64:65], v114 offset:8192
    ds_read_b64_tr_b16 v[66:67], v114 offset:10240
    ds_read_b64_tr_b16 v[68:69], v115 offset:8192
    ds_read_b64_tr_b16 v[70:71], v115 offset:10240
    s_waitcnt lgkmcnt(9)
    v_mfma_f32_32x32x16_bf16 v[128:143], v[36:39], v[32:35], v[128:143]
    v_mfma_f32_32x32x16_bf16 v[144:159], v[40:43], v[32:35], v[144:159]
    v_mfma_f32_32x32x16_bf16 v[160:175], v[44:47], v[32:35], v[160:175]
    v_mfma_f32_32x32x16_bf16 v[176:191], v[48:51], v[32:35], v[176:191]
    ds_read_b128 v[72:75], v27
    ds_read_b64_tr_b16 v[76:77], v112 offset:16384
    ds_read_b64_tr_b16 v[78:79], v112 offset:18432
    ds_read_b64_tr_b16 v[80:81], v113 offset:16384
    ds_read_b64_tr_b16 v[82:83], v113 offset:18432
    ds_read_b64_tr_b16 v[84:85], v114 offset:16384
    ds_read_b64_tr_b16 v[86:87], v114 offset:18432
    ds_read_b64_tr_b16 v[88:89], v115 offset:16384
    ds_read_b64_tr_b16 v[90:91], v115 offset:18432
    s_waitcnt lgkmcnt(9)
    v_mfma_f32_32x32x16_bf16 v[128:143], v[56:59], v[52:55], v[128:143]
    v_mfma_f32_32x32x16_bf16 v[144:159], v[60:63], v[52:55], v[144:159]
    v_mfma_f32_32x32x16_bf16 v[160:175], v[64:67], v[52:55], v[160:175]
    v_mfma_f32_32x32x16_bf16 v[176:191], v[68:71], v[52:55], v[176:191]
    ds_read_b128 v[92:95], v28
    ds_read_b64_tr_b16 v[96:97], v112 offset:24576
    ds_read_b64_tr_b16 v[98:99], v112 offset:26624
    ds_read_b64_tr_b16 v[100:101], v113 offset:24576
    ds_read_b64_tr_b16 v[102:103], v113 offset:26624
    ds_read_b64_tr_b16 v[104:105], v114 offset:24576
    ds_read_b64_tr_b16 v[106:107], v114 offset:26624
    ds_read_b64_tr_b16 v[108:109], v115 offset:24576
    ds_read_b64_tr_b16 v[110:111], v115 offset:26624
    s_waitcnt lgkmcnt(9)
    v_mfma_f32_32x32x16_bf16 v[128:143], v[76:79], v[72:75], v[128:143]
    v_mfma_f32_32x32x16_bf16 v[144:159], v[80:83], v[72:75], v[144:159]
    v_mfma_f32_32x32x16_bf16 v[160:175], v[84:87], v[72:75], v[160:175]
    v_mfma_f32_32x32x16_bf16 v[176:191], v[88:91], v[72:75], v[176:191]
    s_waitcnt lgkmcnt(0)
    v_mfma_f32_32x32x16_bf16 v[128:143], v[96:99], v[92:95], v[128:143]
    v_mfma_f32_32x32x16_bf16 v[144:159], v[100:103], v[92:95], v[144:159]
    v_mfma_f32_32x32x16_bf16 v[160:175], v[104:107], v[92:95], v[160:175]
    v_mfma_f32_32x32x16_bf16 v[176:191], v[108:111], v[92:95], v[176:191]
    v_add_u32 v25, 122880, v17
    v_add_u32 v112, 122880, v21
    v_add_u32 v26, 122880, v18
    v_add_u32 v113, 122880, v22
    v_add_u32 v27, 122880, v19
    v_add_u32 v114, 122880, v23
    v_add_u32 v28, 122880, v20
    v_add_u32 v115, 122880, v24
    s_waitcnt vmcnt(0)
    s_barrier
    ds_read_b128 v[32:35], v25
    ds_read_b64_tr_b16 v[36:37], v112 offset:0
    ds_read_b64_tr_b16 v[38:39], v112 offset:2048
    ds_read_b64_tr_b16 v[40:41], v113 offset:0
    ds_read_b64_tr_b16 v[42:43], v113 offset:2048
    ds_read_b64_tr_b16 v[44:45], v114 offset:0
    ds_read_b64_tr_b16 v[46:47], v114 offset:2048
    ds_read_b64_tr_b16 v[48:49], v115 offset:0
    ds_read_b64_tr_b16 v[50:51], v115 offset:2048
    ds_read_b128 v[52:55], v26
    ds_read_b64_tr_b16 v[56:57], v112 offset:8192
    ds_read_b64_tr_b16 v[58:59], v112 offset:10240
    ds_read_b64_tr_b16 v[60:61], v113 offset:8192
    ds_read_b64_tr_b16 v[62:63], v113 offset:10240
    ds_read_b64_tr_b16 v[64:65], v114 offset:8192
    ds_read_b64_tr_b16 v[66:67], v114 offset:10240
    ds_read_b64_tr_b16 v[68:69], v115 offset:8192
    ds_read_b64_tr_b16 v[70:71], v115 offset:10240
    s_waitcnt lgkmcnt(9)
    v_mfma_f32_32x32x16_bf16 v[128:143], v[36:39], v[32:35], v[128:143]
    v_mfma_f32_32x32x16_bf16 v[144:159], v[40:43], v[32:35], v[144:159]
    v_mfma_f32_32x32x16_bf16 v[160:175], v[44:47], v[32:35], v[160:175]
    v_mfma_f32_32x32x16_bf16 v[176:191], v[48:51], v[32:35], v[176:191]
    ds_read_b128 v[72:75], v27
    ds_read_b64_tr_b16 v[76:77], v112 offset:16384
    ds_read_b64_tr_b16 v[78:79], v112 offset:18432
    ds_read_b64_tr_b16 v[80:81], v113 offset:16384
    ds_read_b64_tr_b16 v[82:83], v113 offset:18432
    ds_read_b64_tr_b16 v[84:85], v114 offset:16384
    ds_read_b64_tr_b16 v[86:87], v114 offset:18432
    ds_read_b64_tr_b16 v[88:89], v115 offset:16384
    ds_read_b64_tr_b16 v[90:91], v115 offset:18432
    s_waitcnt lgkmcnt(9)
    v_mfma_f32_32x32x16_bf16 v[128:143], v[56:59], v[52:55], v[128:143]
    v_mfma_f32_32x32x16_bf16 v[144:159], v[60:63], v[52:55], v[144:159]
    v_mfma_f32_32x32x16_bf16 v[160:175], v[64:67], v[52:55], v[160:175]
    v_mfma_f32_32x32x16_bf16 v[176:191], v[68:71], v[52:55], v[176:191]
    ds_read_b128 v[92:95], v28
    ds_read_b64_tr_b16 v[96:97], v112 offset:24576
    ds_read_b64_tr_b16 v[98:99], v112 offset:26624
    ds_read_b64_tr_b16 v[100:101], v113 offset:24576
    ds_read_b64_tr_b16 v[102:103], v113 offset:26624
    ds_read_b64_tr_b16 v[104:105], v114 offset:24576
    ds_read_b64_tr_b16 v[106:107], v114 offset:26624
    ds_read_b64_tr_b16 v[108:109], v115 offset:24576
    ds_read_b64_tr_b16 v[110:111], v115 offset:26624
    s_waitcnt lgkmcnt(9)
    v_mfma_f32_32x32x16_bf16 v[128:143], v[76:79], v[72:75], v[128:143]
    v_mfma_f32_32x32x16_bf16 v[144:159], v[80:83], v[72:75], v[144:159]
    v_mfma_f32_32x32x16_bf16 v[160:175], v[84:87], v[72:75], v[160:175]
    v_mfma_f32_32x32x16_bf16 v[176:191], v[88:91], v[72:75], v[176:191]
    s_waitcnt lgkmcnt(0)
    v_mfma_f32_32x32x16_bf16 v[128:143], v[96:99], v[92:95], v[128:143]
    v_mfma_f32_32x32x16_bf16 v[144:159], v[100:103], v[92:95], v[144:159]
    v_mfma_f32_32x32x16_bf16 v[160:175], v[104:107], v[92:95], v[160:175]
    v_mfma_f32_32x32x16_bf16 v[176:191], v[108:111], v[92:95], v[176:191]
    s_branch L_mi_ep
L_mi_v:
    v_add_u32 v25, 0, v17
    v_add_u32 v112, 0, v21
    v_add_u32 v26, 0, v18
    v_add_u32 v113, 0, v22
    v_add_u32 v27, 0, v19
    v_add_u32 v114, 0, v23
    v_add_u32 v28, 0, v20
    v_add_u32 v115, 0, v24
    s_waitcnt vmcnt(30)
    s_barrier
    ds_read_b128 v[32:35], v25
    ds_read_b64_tr_b16 v[36:37], v112 offset:0
    ds_read_b64_tr_b16 v[38:39], v112 offset:2048
    ds_read_b64_tr_b16 v[40:41], v113 offset:0
    ds_read_b64_tr_b16 v[42:43], v113 offset:2048
    ds_read_b64_tr_b16 v[44:45], v114 offset:0
    ds_read_b64_tr_b16 v[46:47], v114 offset:2048
    ds_read_b64_tr_b16 v[48:49], v115 offset:0
    ds_read_b64_tr_b16 v[50:51], v115 offset:2048
    ds_read_b128 v[52:55], v26
    ds_read_b64_tr_b16 v[56:57], v112 offset:8192
    ds_read_b64_tr_b16 v[58:59], v112 offset:10240
    ds_read_b64_tr_b16 v[60:61], v113 offset:8192
    ds_read_b64_tr_b16 v[62:63], v113 offset:10240
    ds_read_b64_tr_b16 v[64:65], v114 offset:8192
    ds_read_b64_tr_b16 v[66:67], v114 offset:10240
    ds_read_b64_tr_b16 v[68:69], v115 offset:8192
    ds_read_b64_tr_b16 v[70:71], v115 offset:10240
    s_waitcnt lgkmcnt(9)
    v_mfma_f32_32x32x16_bf16 v[128:143], v[32:35], v[36:39], 0
    v_mfma_f32_32x32x16_bf16 v[144:159], v[32:35], v[40:43], 0
    v_mfma_f32_32x32x16_bf16 v[160:175], v[32:35], v[44:47], 0
    v_mfma_f32_32x32x16_bf16 v[176:191], v[32:35], v[48:51], 0
    ds_read_b128 v[72:75], v27
    ds_read_b64_tr_b16 v[76:77], v112 offset:16384
    ds_read_b64_tr_b16 v[78:79], v112 offset:18432
    ds_read_b64_tr_b16 v[80:81], v113 offset:16384
    ds_read_b64_tr_b16 v[82:83], v113 offset:18432
    ds_read_b64_tr_b16 v[84:85], v114 offset:16384
    ds_read_b64_tr_b16 v[86:87], v114 offset:18432
    ds_read_b64_tr_b16 v[88:89], v115 offset:16384
    ds_read_b64_tr_b16 v[90:91], v115 offset:18432
    s_waitcnt lgkmcnt(9)
    v_mfma_f32_32x32x16_bf16 v[128:143], v[52:55], v[56:59], v[128:143]
    v_mfma_f32_32x32x16_bf16 v[144:159], v[52:55], v[60:63], v[144:159]
    v_mfma_f32_32x32x16_bf16 v[160:175], v[52:55], v[64:67], v[160:175]
    v_mfma_f32_32x32x16_bf16 v[176:191], v[52:55], v[68:71], v[176:191]
    ds_read_b128 v[92:95], v28
    ds_read_b64_tr_b16 v[96:97], v112 offset:24576
    ds_read_b64_tr_b16 v[98:99], v112 offset:26624
    ds_read_b64_tr_b16 v[100:101], v113 offset:24576
    ds_read_b64_tr_b16 v[102:103], v113 offset:26624
    ds_read_b64_tr_b16 v[104:105], v114 offset:24576
    ds_read_b64_tr_b16 v[106:107], v114 offset:26624
    ds_read_b64_tr_b16 v[108:109], v115 offset:24576
    ds_read_b64_tr_b16 v[110:111], v115 offset:26624
    s_waitcnt lgkmcnt(9)
    v_mfma_f32_32x32x16_bf16 v[128:143], v[72:75], v[76:79], v[128:143]
    v_mfma_f32_32x32x16_bf16 v[144:159], v[72:75], v[80:83], v[144:159]
    v_mfma_f32_32x32x16_bf16 v[160:175], v[72:75], v[84:87], v[160:175]
    v_mfma_f32_32x32x16_bf16 v[176:191], v[72:75], v[88:91], v[176:191]
    s_waitcnt lgkmcnt(0)
    v_mfma_f32_32x32x16_bf16 v[128:143], v[92:95], v[96:99], v[128:143]
    v_mfma_f32_32x32x16_bf16 v[144:159], v[92:95], v[100:103], v[144:159]
    v_mfma_f32_32x32x16_bf16 v[160:175], v[92:95], v[104:107], v[160:175]
    v_mfma_f32_32x32x16_bf16 v[176:191], v[92:95], v[108:111], v[176:191]
    v_add_u32 v25, 40960, v17
    v_add_u32 v112, 40960, v21
    v_add_u32 v26, 40960, v18
    v_add_u32 v113, 40960, v22
    v_add_u32 v27, 40960, v19
    v_add_u32 v114, 40960, v23
    v_add_u32 v28, 40960, v20
    v_add_u32 v115, 40960, v24
    s_waitcnt vmcnt(20)
    s_barrier
    s_add_u32 m0, s46, 0
    s_add_u32 s47, s49, 512
    buffer_load_dwordx4 v2, s[20:23], s47 offen lds
    s_add_u32 m0, s46, 1024
    s_add_u32 s47, s49, 8704
    buffer_load_dwordx4 v16, s[20:23], s47 offen lds
    s_add_u32 m0, s54, 0
    s_add_u32 s47, s50, 2097152
    buffer_load_dwordx4 v3, s[24:27], s47 offen lds
    s_add_u32 m0, s54, 1024
    s_add_u32 s47, s50, 2113536
    buffer_load_dwordx4 v4, s[24:27], s47 offen lds
    s_add_u32 m0, s54, 2048
    s_add_u32 s47, s50, 2129920
    buffer_load_dwordx4 v3, s[24:27], s47 offen lds
    s_add_u32 m0, s54, 3072
    s_add_u32 s47, s50, 2146304
    buffer_load_dwordx4 v4, s[24:27], s47 offen lds
    s_add_u32 m0, s54, 4096
    s_add_u32 s47, s50, 2162688
    buffer_load_dwordx4 v3, s[24:27], s47 offen lds
    s_add_u32 m0, s54, 5120
    s_add_u32 s47, s50, 2179072
    buffer_load_dwordx4 v4, s[24:27], s47 offen lds
    s_add_u32 m0, s54, 6144
    s_add_u32 s47, s50, 2195456
    buffer_load_dwordx4 v3, s[24:27], s47 offen lds
    s_add_u32 m0, s54, 7168
    s_add_u32 s47, s50, 2211840
    buffer_load_dwordx4 v4, s[24:27], s47 offen lds
    ds_read_b128 v[32:35], v25
    ds_read_b64_tr_b16 v[36:37], v112 offset:0
    ds_read_b64_tr_b16 v[38:39], v112 offset:2048
    ds_read_b64_tr_b16 v[40:41], v113 offset:0
    ds_read_b64_tr_b16 v[42:43], v113 offset:2048
    ds_read_b64_tr_b16 v[44:45], v114 offset:0
    ds_read_b64_tr_b16 v[46:47], v114 offset:2048
    ds_read_b64_tr_b16 v[48:49], v115 offset:0
    ds_read_b64_tr_b16 v[50:51], v115 offset:2048
    ds_read_b128 v[52:55], v26
    ds_read_b64_tr_b16 v[56:57], v112 offset:8192
    ds_read_b64_tr_b16 v[58:59], v112 offset:10240
    ds_read_b64_tr_b16 v[60:61], v113 offset:8192
    ds_read_b64_tr_b16 v[62:63], v113 offset:10240
    ds_read_b64_tr_b16 v[64:65], v114 offset:8192
    ds_read_b64_tr_b16 v[66:67], v114 offset:10240
    ds_read_b64_tr_b16 v[68:69], v115 offset:8192
    ds_read_b64_tr_b16 v[70:71], v115 offset:10240
    s_waitcnt lgkmcnt(9)
    v_mfma_f32_32x32x16_bf16 v[128:143], v[32:35], v[36:39], v[128:143]
    v_mfma_f32_32x32x16_bf16 v[144:159], v[32:35], v[40:43], v[144:159]
    v_mfma_f32_32x32x16_bf16 v[160:175], v[32:35], v[44:47], v[160:175]
    v_mfma_f32_32x32x16_bf16 v[176:191], v[32:35], v[48:51], v[176:191]
    ds_read_b128 v[72:75], v27
    ds_read_b64_tr_b16 v[76:77], v112 offset:16384
    ds_read_b64_tr_b16 v[78:79], v112 offset:18432
    ds_read_b64_tr_b16 v[80:81], v113 offset:16384
    ds_read_b64_tr_b16 v[82:83], v113 offset:18432
    ds_read_b64_tr_b16 v[84:85], v114 offset:16384
    ds_read_b64_tr_b16 v[86:87], v114 offset:18432
    ds_read_b64_tr_b16 v[88:89], v115 offset:16384
    ds_read_b64_tr_b16 v[90:91], v115 offset:18432
    s_waitcnt lgkmcnt(9)
    v_mfma_f32_32x32x16_bf16 v[128:143], v[52:55], v[56:59], v[128:143]
    v_mfma_f32_32x32x16_bf16 v[144:159], v[52:55], v[60:63], v[144:159]
    v_mfma_f32_32x32x16_bf16 v[160:175], v[52:55], v[64:67], v[160:175]
    v_mfma_f32_32x32x16_bf16 v[176:191], v[52:55], v[68:71], v[176:191]
    ds_read_b128 v[92:95], v28
    ds_read_b64_tr_b16 v[96:97], v112 offset:24576
    ds_read_b64_tr_b16 v[98:99], v112 offset:26624
    ds_read_b64_tr_b16 v[100:101], v113 offset:24576
    ds_read_b64_tr_b16 v[102:103], v113 offset:26624
    ds_read_b64_tr_b16 v[104:105], v114 offset:24576
    ds_read_b64_tr_b16 v[106:107], v114 offset:26624
    ds_read_b64_tr_b16 v[108:109], v115 offset:24576
    ds_read_b64_tr_b16 v[110:111], v115 offset:26624
    s_waitcnt lgkmcnt(9)
    v_mfma_f32_32x32x16_bf16 v[128:143], v[72:75], v[76:79], v[128:143]
    v_mfma_f32_32x32x16_bf16 v[144:159], v[72:75], v[80:83], v[144:159]
    v_mfma_f32_32x32x16_bf16 v[160:175], v[72:75], v[84:87], v[160:175]
    v_mfma_f32_32x32x16_bf16 v[176:191], v[72:75], v[88:91], v[176:191]
    s_waitcnt lgkmcnt(0)
    v_mfma_f32_32x32x16_bf16 v[128:143], v[92:95], v[96:99], v[128:143]
    v_mfma_f32_32x32x16_bf16 v[144:159], v[92:95], v[100:103], v[144:159]
    v_mfma_f32_32x32x16_bf16 v[160:175], v[92:95], v[104:107], v[160:175]
    v_mfma_f32_32x32x16_bf16 v[176:191], v[92:95], v[108:111], v[176:191]
    v_add_u32 v25, 81920, v17
    v_add_u32 v112, 81920, v21
    v_add_u32 v26, 81920, v18
    v_add_u32 v113, 81920, v22
    v_add_u32 v27, 81920, v19
    v_add_u32 v114, 81920, v23
    v_add_u32 v28, 81920, v20
    v_add_u32 v115, 81920, v24
    s_waitcnt vmcnt(20)
    s_barrier
    s_add_u32 m0, s46, 40960
    s_add_u32 s47, s49, 640
    buffer_load_dwordx4 v2, s[20:23], s47 offen lds
    s_add_u32 m0, s46, 41984
    s_add_u32 s47, s49, 8832
    buffer_load_dwordx4 v16, s[20:23], s47 offen lds
    s_add_u32 m0, s54, 40960
    s_add_u32 s47, s50, 2621440
    buffer_load_dwordx4 v3, s[24:27], s47 offen lds
    s_add_u32 m0, s54, 41984
    s_add_u32 s47, s50, 2637824
    buffer_load_dwordx4 v4, s[24:27], s47 offen lds
    s_add_u32 m0, s54, 43008
    s_add_u32 s47, s50, 2654208
    buffer_load_dwordx4 v3, s[24:27], s47 offen lds
    s_add_u32 m0, s54, 44032
    s_add_u32 s47, s50, 2670592
    buffer_load_dwordx4 v4, s[24:27], s47 offen lds
    s_add_u32 m0, s54, 45056
    s_add_u32 s47, s50, 2686976
    buffer_load_dwordx4 v3, s[24:27], s47 offen lds
    s_add_u32 m0, s54, 46080
    s_add_u32 s47, s50, 2703360
    buffer_load_dwordx4 v4, s[24:27], s47 offen lds
    s_add_u32 m0, s54, 47104
    s_add_u32 s47, s50, 2719744
    buffer_load_dwordx4 v3, s[24:27], s47 offen lds
    s_add_u32 m0, s54, 48128
    s_add_u32 s47, s50, 2736128
    buffer_load_dwordx4 v4, s[24:27], s47 offen lds
    ds_read_b128 v[32:35], v25
    ds_read_b64_tr_b16 v[36:37], v112 offset:0
    ds_read_b64_tr_b16 v[38:39], v112 offset:2048
    ds_read_b64_tr_b16 v[40:41], v113 offset:0
    ds_read_b64_tr_b16 v[42:43], v113 offset:2048
    ds_read_b64_tr_b16 v[44:45], v114 offset:0
    ds_read_b64_tr_b16 v[46:47], v114 offset:2048
    ds_read_b64_tr_b16 v[48:49], v115 offset:0
    ds_read_b64_tr_b16 v[50:51], v115 offset:2048
    ds_read_b128 v[52:55], v26
    ds_read_b64_tr_b16 v[56:57], v112 offset:8192
    ds_read_b64_tr_b16 v[58:59], v112 offset:10240
    ds_read_b64_tr_b16 v[60:61], v113 offset:8192
    ds_read_b64_tr_b16 v[62:63], v113 offset:10240
    ds_read_b64_tr_b16 v[64:65], v114 offset:8192
    ds_read_b64_tr_b16 v[66:67], v114 offset:10240
    ds_read_b64_tr_b16 v[68:69], v115 offset:8192
    ds_read_b64_tr_b16 v[70:71], v115 offset:10240
    s_waitcnt lgkmcnt(9)
    v_mfma_f32_32x32x16_bf16 v[128:143], v[32:35], v[36:39], v[128:143]
    v_mfma_f32_32x32x16_bf16 v[144:159], v[32:35], v[40:43], v[144:159]
    v_mfma_f32_32x32x16_bf16 v[160:175], v[32:35], v[44:47], v[160:175]
    v_mfma_f32_32x32x16_bf16 v[176:191], v[32:35], v[48:51], v[176:191]
    ds_read_b128 v[72:75], v27
    ds_read_b64_tr_b16 v[76:77], v112 offset:16384
    ds_read_b64_tr_b16 v[78:79], v112 offset:18432
    ds_read_b64_tr_b16 v[80:81], v113 offset:16384
    ds_read_b64_tr_b16 v[82:83], v113 offset:18432
    ds_read_b64_tr_b16 v[84:85], v114 offset:16384
    ds_read_b64_tr_b16 v[86:87], v114 offset:18432
    ds_read_b64_tr_b16 v[88:89], v115 offset:16384
    ds_read_b64_tr_b16 v[90:91], v115 offset:18432
    s_waitcnt lgkmcnt(9)
    v_mfma_f32_32x32x16_bf16 v[128:143], v[52:55], v[56:59], v[128:143]
    v_mfma_f32_32x32x16_bf16 v[144:159], v[52:55], v[60:63], v[144:159]
    v_mfma_f32_32x32x16_bf16 v[160:175], v[52:55], v[64:67], v[160:175]
    v_mfma_f32_32x32x16_bf16 v[176:191], v[52:55], v[68:71], v[176:191]
    ds_read_b128 v[92:95], v28
    ds_read_b64_tr_b16 v[96:97], v112 offset:24576
    ds_read_b64_tr_b16 v[98:99], v112 offset:26624
    ds_read_b64_tr_b16 v[100:101], v113 offset:24576
    ds_read_b64_tr_b16 v[102:103], v113 offset:26624
    ds_read_b64_tr_b16 v[104:105], v114 offset:24576
    ds_read_b64_tr_b16 v[106:107], v114 offset:26624
    ds_read_b64_tr_b16 v[108:109], v115 offset:24576
    ds_read_b64_tr_b16 v[110:111], v115 offset:26624
    s_waitcnt lgkmcnt(9)
    v_mfma_f32_32x32x16_bf16 v[128:143], v[72:75], v[76:79], v[128:143]
    v_mfma_f32_32x32x16_bf16 v[144:159], v[72:75], v[80:83], v[144:159]
    v_mfma_f32_32x32x16_bf16 v[160:175], v[72:75], v[84:87], v[160:175]
    v_mfma_f32_32x32x16_bf16 v[176:191], v[72:75], v[88:91], v[176:191]
    s_waitcnt lgkmcnt(0)
    v_mfma_f32_32x32x16_bf16 v[128:143], v[92:95], v[96:99], v[128:143]
    v_mfma_f32_32x32x16_bf16 v[144:159], v[92:95], v[100:103], v[144:159]
    v_mfma_f32_32x32x16_bf16 v[160:175], v[92:95], v[104:107], v[160:175]
    v_mfma_f32_32x32x16_bf16 v[176:191], v[92:95], v[108:111], v[176:191]
    v_add_u32 v25, 122880, v17
    v_add_u32 v112, 122880, v21
    v_add_u32 v26, 122880, v18
    v_add_u32 v113, 122880, v22
    v_add_u32 v27, 122880, v19
    v_add_u32 v114, 122880, v23
    v_add_u32 v28, 122880, v20
    v_add_u32 v115, 122880, v24
    s_waitcnt vmcnt(20)
    s_barrier
    s_add_u32 m0, s46, 81920
    s_add_u32 s47, s49, 768
    buffer_load_dwordx4 v2, s[20:23], s47 offen lds
    s_add_u32 m0, s46, 82944
    s_add_u32 s47, s49, 8960
    buffer_load_dwordx4 v16, s[20:23], s47 offen lds
    s_add_u32 m0, s54, 81920
    s_add_u32 s47, s50, 3145728
    buffer_load_dwordx4 v3, s[24:27], s47 offen lds
    s_add_u32 m0, s54, 82944
    s_add_u32 s47, s50, 3162112
    buffer_load_dwordx4 v4, s[24:27], s47 offen lds
    s_add_u32 m0, s54, 83968
    s_add_u32 s47, s50, 3178496
    buffer_load_dwordx4 v3, s[24:27], s47 offen lds
    s_add_u32 m0, s54, 84992
    s_add_u32 s47, s50, 3194880
    buffer_load_dwordx4 v4, s[24:27], s47 offen lds
    s_add_u32 m0, s54, 86016
    s_add_u32 s47, s50, 3211264
    buffer_load_dwordx4 v3, s[24:27], s47 offen lds
    s_add_u32 m0, s54, 87040
    s_add_u32 s47, s50, 3227648
    buffer_load_dwordx4 v4, s[24:27], s47 offen lds
    s_add_u32 m0, s54, 88064
    s_add_u32 s47, s50, 3244032
    buffer_load_dwordx4 v3, s[24:27], s47 offen lds
    s_add_u32 m0, s54, 89088
    s_add_u32 s47, s50, 3260416
    buffer_load_dwordx4 v4, s[24:27], s47 offen lds
    ds_read_b128 v[32:35], v25
    ds_read_b64_tr_b16 v[36:37], v112 offset:0
    ds_read_b64_tr_b16 v[38:39], v112 offset:2048
    ds_read_b64_tr_b16 v[40:41], v113 offset:0
    ds_read_b64_tr_b16 v[42:43], v113 offset:2048
    ds_read_b64_tr_b16 v[44:45], v114 offset:0
    ds_read_b64_tr_b16 v[46:47], v114 offset:2048
    ds_read_b64_tr_b16 v[48:49], v115 offset:0
    ds_read_b64_tr_b16 v[50:51], v115 offset:2048
    ds_read_b128 v[52:55], v26
    ds_read_b64_tr_b16 v[56:57], v112 offset:8192
    ds_read_b64_tr_b16 v[58:59], v112 offset:10240
    ds_read_b64_tr_b16 v[60:61], v113 offset:8192
    ds_read_b64_tr_b16 v[62:63], v113 offset:10240
    ds_read_b64_tr_b16 v[64:65], v114 offset:8192
    ds_read_b64_tr_b16 v[66:67], v114 offset:10240
    ds_read_b64_tr_b16 v[68:69], v115 offset:8192
    ds_read_b64_tr_b16 v[70:71], v115 offset:10240
    s_waitcnt lgkmcnt(9)
    v_mfma_f32_32x32x16_bf16 v[128:143], v[32:35], v[36:39], v[128:143]
    v_mfma_f32_32x32x16_bf16 v[144:159], v[32:35], v[40:43], v[144:159]
    v_mfma_f32_32x32x16_bf16 v[160:175], v[32:35], v[44:47], v[160:175]
    v_mfma_f32_32x32x16_bf16 v[176:191], v[32:35], v[48:51], v[176:191]
    ds_read_b128 v[72:75], v27
    ds_read_b64_tr_b16 v[76:77], v112 offset:16384
    ds_read_b64_tr_b16 v[78:79], v112 offset:18432
    ds_read_b64_tr_b16 v[80:81], v113 offset:16384
    ds_read_b64_tr_b16 v[82:83], v113 offset:18432
    ds_read_b64_tr_b16 v[84:85], v114 offset:16384
    ds_read_b64_tr_b16 v[86:87], v114 offset:18432
    ds_read_b64_tr_b16 v[88:89], v115 offset:16384
    ds_read_b64_tr_b16 v[90:91], v115 offset:18432
    s_waitcnt lgkmcnt(9)
    v_mfma_f32_32x32x16_bf16 v[128:143], v[52:55], v[56:59], v[128:143]
    v_mfma_f32_32x32x16_bf16 v[144:159], v[52:55], v[60:63], v[144:159]
    v_mfma_f32_32x32x16_bf16 v[160:175], v[52:55], v[64:67], v[160:175]
    v_mfma_f32_32x32x16_bf16 v[176:191], v[52:55], v[68:71], v[176:191]
    ds_read_b128 v[92:95], v28
    ds_read_b64_tr_b16 v[96:97], v112 offset:24576
    ds_read_b64_tr_b16 v[98:99], v112 offset:26624
    ds_read_b64_tr_b16 v[100:101], v113 offset:24576
    ds_read_b64_tr_b16 v[102:103], v113 offset:26624
    ds_read_b64_tr_b16 v[104:105], v114 offset:24576
    ds_read_b64_tr_b16 v[106:107], v114 offset:26624
    ds_read_b64_tr_b16 v[108:109], v115 offset:24576
    ds_read_b64_tr_b16 v[110:111], v115 offset:26624
    s_waitcnt lgkmcnt(9)
    v_mfma_f32_32x32x16_bf16 v[128:143], v[72:75], v[76:79], v[128:143]
    v_mfma_f32_32x32x16_bf16 v[144:159], v[72:75], v[80:83], v[144:159]
    v_mfma_f32_32x32x16_bf16 v[160:175], v[72:75], v[84:87], v[160:175]
    v_mfma_f32_32x32x16_bf16 v[176:191], v[72:75], v[88:91], v[176:191]
    s_waitcnt lgkmcnt(0)
    v_mfma_f32_32x32x16_bf16 v[128:143], v[92:95], v[96:99], v[128:143]
    v_mfma_f32_32x32x16_bf16 v[144:159], v[92:95], v[100:103], v[144:159]
    v_mfma_f32_32x32x16_bf16 v[160:175], v[92:95], v[104:107], v[160:175]
    v_mfma_f32_32x32x16_bf16 v[176:191], v[92:95], v[108:111], v[176:191]
    v_add_u32 v25, 0, v17
    v_add_u32 v112, 0, v21
    v_add_u32 v26, 0, v18
    v_add_u32 v113, 0, v22
    v_add_u32 v27, 0, v19
    v_add_u32 v114, 0, v23
    v_add_u32 v28, 0, v20
    v_add_u32 v115, 0, v24
    s_waitcnt vmcnt(20)
    s_barrier
    s_add_u32 m0, s46, 122880
    s_add_u32 s47, s49, 896
    buffer_load_dwordx4 v2, s[20:23], s47 offen lds
    s_add_u32 m0, s46, 123904
    s_add_u32 s47, s49, 9088
    buffer_load_dwordx4 v16, s[20:23], s47 offen lds
    s_add_u32 m0, s54, 122880
    s_add_u32 s47, s50, 3670016
    buffer_load_dwordx4 v3, s[24:27], s47 offen lds
    s_add_u32 m0, s54, 123904
    s_add_u32 s47, s50, 3686400
    buffer_load_dwordx4 v4, s[24:27], s47 offen lds
    s_add_u32 m0, s54, 124928
    s_add_u32 s47, s50, 3702784
    buffer_load_dwordx4 v3, s[24:27], s47 offen lds
    s_add_u32 m0, s54, 125952
    s_add_u32 s47, s50, 3719168
    buffer_load_dwordx4 v4, s[24:27], s47 offen lds
    s_add_u32 m0, s54, 126976
    s_add_u32 s47, s50, 3735552
    buffer_load_dwordx4 v3, s[24:27], s47 offen lds
    s_add_u32 m0, s54, 128000
    s_add_u32 s47, s50, 3751936
    buffer_load_dwordx4 v4, s[24:27], s47 offen lds
    s_add_u32 m0, s54, 129024
    s_add_u32 s47, s50, 3768320
    buffer_load_dwordx4 v3, s[24:27], s47 offen lds
    s_add_u32 m0, s54, 130048
    s_add_u32 s47, s50, 3784704
    buffer_load_dwordx4 v4, s[24:27], s47 offen lds
    ds_read_b128 v[32:35], v25
    ds_read_b64_tr_b16 v[36:37], v112 offset:0
    ds_read_b64_tr_b16 v[38:39], v112 offset:2048
    ds_read_b64_tr_b16 v[40:41], v113 offset:0
    ds_read_b64_tr_b16 v[42:43], v113 offset:2048
    ds_read_b64_tr_b16 v[44:45], v114 offset:0
    ds_read_b64_tr_b16 v[46:47], v114 offset:2048
    ds_read_b64_tr_b16 v[48:49], v115 offset:0
    ds_read_b64_tr_b16 v[50:51], v115 offset:2048
    ds_read_b128 v[52:55], v26
    ds_read_b64_tr_b16 v[56:57], v112 offset:8192
    ds_read_b64_tr_b16 v[58:59], v112 offset:10240
    ds_read_b64_tr_b16 v[60:61], v113 offset:8192
    ds_read_b64_tr_b16 v[62:63], v113 offset:10240
    ds_read_b64_tr_b16 v[64:65], v114 offset:8192
    ds_read_b64_tr_b16 v[66:67], v114 offset:10240
    ds_read_b64_tr_b16 v[68:69], v115 offset:8192
    ds_read_b64_tr_b16 v[70:71], v115 offset:10240
    s_waitcnt lgkmcnt(9)
    v_mfma_f32_32x32x16_bf16 v[128:143], v[32:35], v[36:39], v[128:143]
    v_mfma_f32_32x32x16_bf16 v[144:159], v[32:35], v[40:43], v[144:159]
    v_mfma_f32_32x32x16_bf16 v[160:175], v[32:35], v[44:47], v[160:175]
    v_mfma_f32_32x32x16_bf16 v[176:191], v[32:35], v[48:51], v[176:191]
    ds_read_b128 v[72:75], v27
    ds_read_b64_tr_b16 v[76:77], v112 offset:16384
    ds_read_b64_tr_b16 v[78:79], v112 offset:18432
    ds_read_b64_tr_b16 v[80:81], v113 offset:16384
    ds_read_b64_tr_b16 v[82:83], v113 offset:18432
    ds_read_b64_tr_b16 v[84:85], v114 offset:16384
    ds_read_b64_tr_b16 v[86:87], v114 offset:18432
    ds_read_b64_tr_b16 v[88:89], v115 offset:16384
    ds_read_b64_tr_b16 v[90:91], v115 offset:18432
    s_waitcnt lgkmcnt(9)
    v_mfma_f32_32x32x16_bf16 v[128:143], v[52:55], v[56:59], v[128:143]
    v_mfma_f32_32x32x16_bf16 v[144:159], v[52:55], v[60:63], v[144:159]
    v_mfma_f32_32x32x16_bf16 v[160:175], v[52:55], v[64:67], v[160:175]
    v_mfma_f32_32x32x16_bf16 v[176:191], v[52:55], v[68:71], v[176:191]
    ds_read_b128 v[92:95], v28
    ds_read_b64_tr_b16 v[96:97], v112 offset:24576
    ds_read_b64_tr_b16 v[98:99], v112 offset:26624
    ds_read_b64_tr_b16 v[100:101], v113 offset:24576
    ds_read_b64_tr_b16 v[102:103], v113 offset:26624
    ds_read_b64_tr_b16 v[104:105], v114 offset:24576
    ds_read_b64_tr_b16 v[106:107], v114 offset:26624
    ds_read_b64_tr_b16 v[108:109], v115 offset:24576
    ds_read_b64_tr_b16 v[110:111], v115 offset:26624
    s_waitcnt lgkmcnt(9)
    v_mfma_f32_32x32x16_bf16 v[128:143], v[72:75], v[76:79], v[128:143]
    v_mfma_f32_32x32x16_bf16 v[144:159], v[72:75], v[80:83], v[144:159]
    v_mfma_f32_32x32x16_bf16 v[160:175], v[72:75], v[84:87], v[160:175]
    v_mfma_f32_32x32x16_bf16 v[176:191], v[72:75], v[88:91], v[176:191]
    s_waitcnt lgkmcnt(0)
    v_mfma_f32_32x32x16_bf16 v[128:143], v[92:95], v[96:99], v[128:143]
    v_mfma_f32_32x32x16_bf16 v[144:159], v[92:95], v[100:103], v[144:159]
    v_mfma_f32_32x32x16_bf16 v[160:175], v[92:95], v[104:107], v[160:175]
    v_mfma_f32_32x32x16_bf16 v[176:191], v[92:95], v[108:111], v[176:191]
    v_add_u32 v25, 40960, v17
    v_add_u32 v112, 40960, v21
    v_add_u32 v26, 40960, v18
    v_add_u32 v113, 40960, v22
    v_add_u32 v27, 40960, v19
    v_add_u32 v114, 40960, v23
    v_add_u32 v28, 40960, v20
    v_add_u32 v115, 40960, v24
    s_waitcnt vmcnt(20)
    s_barrier
    ds_read_b128 v[32:35], v25
    ds_read_b64_tr_b16 v[36:37], v112 offset:0
    ds_read_b64_tr_b16 v[38:39], v112 offset:2048
    ds_read_b64_tr_b16 v[40:41], v113 offset:0
    ds_read_b64_tr_b16 v[42:43], v113 offset:2048
    ds_read_b64_tr_b16 v[44:45], v114 offset:0
    ds_read_b64_tr_b16 v[46:47], v114 offset:2048
    ds_read_b64_tr_b16 v[48:49], v115 offset:0
    ds_read_b64_tr_b16 v[50:51], v115 offset:2048
    ds_read_b128 v[52:55], v26
    ds_read_b64_tr_b16 v[56:57], v112 offset:8192
    ds_read_b64_tr_b16 v[58:59], v112 offset:10240
    ds_read_b64_tr_b16 v[60:61], v113 offset:8192
    ds_read_b64_tr_b16 v[62:63], v113 offset:10240
    ds_read_b64_tr_b16 v[64:65], v114 offset:8192
    ds_read_b64_tr_b16 v[66:67], v114 offset:10240
    ds_read_b64_tr_b16 v[68:69], v115 offset:8192
    ds_read_b64_tr_b16 v[70:71], v115 offset:10240
    s_waitcnt lgkmcnt(9)
    v_mfma_f32_32x32x16_bf16 v[128:143], v[32:35], v[36:39], v[128:143]
    v_mfma_f32_32x32x16_bf16 v[144:159], v[32:35], v[40:43], v[144:159]
    v_mfma_f32_32x32x16_bf16 v[160:175], v[32:35], v[44:47], v[160:175]
    v_mfma_f32_32x32x16_bf16 v[176:191], v[32:35], v[48:51], v[176:191]
    ds_read_b128 v[72:75], v27
    ds_read_b64_tr_b16 v[76:77], v112 offset:16384
    ds_read_b64_tr_b16 v[78:79], v112 offset:18432
    ds_read_b64_tr_b16 v[80:81], v113 offset:16384
    ds_read_b64_tr_b16 v[82:83], v113 offset:18432
    ds_read_b64_tr_b16 v[84:85], v114 offset:16384
    ds_read_b64_tr_b16 v[86:87], v114 offset:18432
    ds_read_b64_tr_b16 v[88:89], v115 offset:16384
    ds_read_b64_tr_b16 v[90:91], v115 offset:18432
    s_waitcnt lgkmcnt(9)
    v_mfma_f32_32x32x16_bf16 v[128:143], v[52:55], v[56:59], v[128:143]
    v_mfma_f32_32x32x16_bf16 v[144:159], v[52:55], v[60:63], v[144:159]
    v_mfma_f32_32x32x16_bf16 v[160:175], v[52:55], v[64:67], v[160:175]
    v_mfma_f32_32x32x16_bf16 v[176:191], v[52:55], v[68:71], v[176:191]
    ds_read_b128 v[92:95], v28
    ds_read_b64_tr_b16 v[96:97], v112 offset:24576
    ds_read_b64_tr_b16 v[98:99], v112 offset:26624
    ds_read_b64_tr_b16 v[100:101], v113 offset:24576
    ds_read_b64_tr_b16 v[102:103], v113 offset:26624
    ds_read_b64_tr_b16 v[104:105], v114 offset:24576
    ds_read_b64_tr_b16 v[106:107], v114 offset:26624
    ds_read_b64_tr_b16 v[108:109], v115 offset:24576
    ds_read_b64_tr_b16 v[110:111], v115 offset:26624
    s_waitcnt lgkmcnt(9)
    v_mfma_f32_32x32x16_bf16 v[128:143], v[72:75], v[76:79], v[128:143]
    v_mfma_f32_32x32x16_bf16 v[144:159], v[72:75], v[80:83], v[144:159]
    v_mfma_f32_32x32x16_bf16 v[160:175], v[72:75], v[84:87], v[160:175]
    v_mfma_f32_32x32x16_bf16 v[176:191], v[72:75], v[88:91], v[176:191]
    s_waitcnt lgkmcnt(0)
    v_mfma_f32_32x32x16_bf16 v[128:143], v[92:95], v[96:99], v[128:143]
    v_mfma_f32_32x32x16_bf16 v[144:159], v[92:95], v[100:103], v[144:159]
    v_mfma_f32_32x32x16_bf16 v[160:175], v[92:95], v[104:107], v[160:175]
    v_mfma_f32_32x32x16_bf16 v[176:191], v[92:95], v[108:111], v[176:191]
    v_add_u32 v25, 81920, v17
    v_add_u32 v112, 81920, v21
    v_add_u32 v26, 81920, v18
    v_add_u32 v113, 81920, v22
    v_add_u32 v27, 81920, v19
    v_add_u32 v114, 81920, v23
    v_add_u32 v28, 81920, v20
    v_add_u32 v115, 81920, v24
    s_waitcnt vmcnt(10)
    s_barrier
    ds_read_b128 v[32:35], v25
    ds_read_b64_tr_b16 v[36:37], v112 offset:0
    ds_read_b64_tr_b16 v[38:39], v112 offset:2048
    ds_read_b64_tr_b16 v[40:41], v113 offset:0
    ds_read_b64_tr_b16 v[42:43], v113 offset:2048
    ds_read_b64_tr_b16 v[44:45], v114 offset:0
    ds_read_b64_tr_b16 v[46:47], v114 offset:2048
    ds_read_b64_tr_b16 v[48:49], v115 offset:0
    ds_read_b64_tr_b16 v[50:51], v115 offset:2048
    ds_read_b128 v[52:55], v26
    ds_read_b64_tr_b16 v[56:57], v112 offset:8192
    ds_read_b64_tr_b16 v[58:59], v112 offset:10240
    ds_read_b64_tr_b16 v[60:61], v113 offset:8192
    ds_read_b64_tr_b16 v[62:63], v113 offset:10240
    ds_read_b64_tr_b16 v[64:65], v114 offset:8192
    ds_read_b64_tr_b16 v[66:67], v114 offset:10240
    ds_read_b64_tr_b16 v[68:69], v115 offset:8192
    ds_read_b64_tr_b16 v[70:71], v115 offset:10240
    s_waitcnt lgkmcnt(9)
    v_mfma_f32_32x32x16_bf16 v[128:143], v[32:35], v[36:39], v[128:143]
    v_mfma_f32_32x32x16_bf16 v[144:159], v[32:35], v[40:43], v[144:159]
    v_mfma_f32_32x32x16_bf16 v[160:175], v[32:35], v[44:47], v[160:175]
    v_mfma_f32_32x32x16_bf16 v[176:191], v[32:35], v[48:51], v[176:191]
    ds_read_b128 v[72:75], v27
    ds_read_b64_tr_b16 v[76:77], v112 offset:16384
    ds_read_b64_tr_b16 v[78:79], v112 offset:18432
    ds_read_b64_tr_b16 v[80:81], v113 offset:16384
    ds_read_b64_tr_b16 v[82:83], v113 offset:18432
    ds_read_b64_tr_b16 v[84:85], v114 offset:16384
    ds_read_b64_tr_b16 v[86:87], v114 offset:18432
    ds_read_b64_tr_b16 v[88:89], v115 offset:16384
    ds_read_b64_tr_b16 v[90:91], v115 offset:18432
    s_waitcnt lgkmcnt(9)
    v_mfma_f32_32x32x16_bf16 v[128:143], v[52:55], v[56:59], v[128:143]
    v_mfma_f32_32x32x16_bf16 v[144:159], v[52:55], v[60:63], v[144:159]
    v_mfma_f32_32x32x16_bf16 v[160:175], v[52:55], v[64:67], v[160:175]
    v_mfma_f32_32x32x16_bf16 v[176:191], v[52:55], v[68:71], v[176:191]
    ds_read_b128 v[92:95], v28
    ds_read_b64_tr_b16 v[96:97], v112 offset:24576
    ds_read_b64_tr_b16 v[98:99], v112 offset:26624
    ds_read_b64_tr_b16 v[100:101], v113 offset:24576
    ds_read_b64_tr_b16 v[102:103], v113 offset:26624
    ds_read_b64_tr_b16 v[104:105], v114 offset:24576
    ds_read_b64_tr_b16 v[106:107], v114 offset:26624
    ds_read_b64_tr_b16 v[108:109], v115 offset:24576
    ds_read_b64_tr_b16 v[110:111], v115 offset:26624
    s_waitcnt lgkmcnt(9)
    v_mfma_f32_32x32x16_bf16 v[128:143], v[72:75], v[76:79], v[128:143]
    v_mfma_f32_32x32x16_bf16 v[144:159], v[72:75], v[80:83], v[144:159]
    v_mfma_f32_32x32x16_bf16 v[160:175], v[72:75], v[84:87], v[160:175]
    v_mfma_f32_32x32x16_bf16 v[176:191], v[72:75], v[88:91], v[176:191]
    s_waitcnt lgkmcnt(0)
    v_mfma_f32_32x32x16_bf16 v[128:143], v[92:95], v[96:99], v[128:143]
    v_mfma_f32_32x32x16_bf16 v[144:159], v[92:95], v[100:103], v[144:159]
    v_mfma_f32_32x32x16_bf16 v[160:175], v[92:95], v[104:107], v[160:175]
    v_mfma_f32_32x32x16_bf16 v[176:191], v[92:95], v[108:111], v[176:191]
    v_add_u32 v25, 122880, v17
    v_add_u32 v112, 122880, v21
    v_add_u32 v26, 122880, v18
    v_add_u32 v113, 122880, v22
    v_add_u32 v27, 122880, v19
    v_add_u32 v114, 122880, v23
    v_add_u32 v28, 122880, v20
    v_add_u32 v115, 122880, v24
    s_waitcnt vmcnt(0)
    s_barrier
    ds_read_b128 v[32:35], v25
    ds_read_b64_tr_b16 v[36:37], v112 offset:0
    ds_read_b64_tr_b16 v[38:39], v112 offset:2048
    ds_read_b64_tr_b16 v[40:41], v113 offset:0
    ds_read_b64_tr_b16 v[42:43], v113 offset:2048
    ds_read_b64_tr_b16 v[44:45], v114 offset:0
    ds_read_b64_tr_b16 v[46:47], v114 offset:2048
    ds_read_b64_tr_b16 v[48:49], v115 offset:0
    ds_read_b64_tr_b16 v[50:51], v115 offset:2048
    ds_read_b128 v[52:55], v26
    ds_read_b64_tr_b16 v[56:57], v112 offset:8192
    ds_read_b64_tr_b16 v[58:59], v112 offset:10240
    ds_read_b64_tr_b16 v[60:61], v113 offset:8192
    ds_read_b64_tr_b16 v[62:63], v113 offset:10240
    ds_read_b64_tr_b16 v[64:65], v114 offset:8192
    ds_read_b64_tr_b16 v[66:67], v114 offset:10240
    ds_read_b64_tr_b16 v[68:69], v115 offset:8192
    ds_read_b64_tr_b16 v[70:71], v115 offset:10240
    s_waitcnt lgkmcnt(9)
    v_mfma_f32_32x32x16_bf16 v[128:143], v[32:35], v[36:39], v[128:143]
    v_mfma_f32_32x32x16_bf16 v[144:159], v[32:35], v[40:43], v[144:159]
    v_mfma_f32_32x32x16_bf16 v[160:175], v[32:35], v[44:47], v[160:175]
    v_mfma_f32_32x32x16_bf16 v[176:191], v[32:35], v[48:51], v[176:191]
    ds_read_b128 v[72:75], v27
    ds_read_b64_tr_b16 v[76:77], v112 offset:16384
    ds_read_b64_tr_b16 v[78:79], v112 offset:18432
    ds_read_b64_tr_b16 v[80:81], v113 offset:16384
    ds_read_b64_tr_b16 v[82:83], v113 offset:18432
    ds_read_b64_tr_b16 v[84:85], v114 offset:16384
    ds_read_b64_tr_b16 v[86:87], v114 offset:18432
    ds_read_b64_tr_b16 v[88:89], v115 offset:16384
    ds_read_b64_tr_b16 v[90:91], v115 offset:18432
    s_waitcnt lgkmcnt(9)
    v_mfma_f32_32x32x16_bf16 v[128:143], v[52:55], v[56:59], v[128:143]
    v_mfma_f32_32x32x16_bf16 v[144:159], v[52:55], v[60:63], v[144:159]
    v_mfma_f32_32x32x16_bf16 v[160:175], v[52:55], v[64:67], v[160:175]
    v_mfma_f32_32x32x16_bf16 v[176:191], v[52:55], v[68:71], v[176:191]
    ds_read_b128 v[92:95], v28
    ds_read_b64_tr_b16 v[96:97], v112 offset:24576
    ds_read_b64_tr_b16 v[98:99], v112 offset:26624
    ds_read_b64_tr_b16 v[100:101], v113 offset:24576
    ds_read_b64_tr_b16 v[102:103], v113 offset:26624
    ds_read_b64_tr_b16 v[104:105], v114 offset:24576
    ds_read_b64_tr_b16 v[106:107], v114 offset:26624
    ds_read_b64_tr_b16 v[108:109], v115 offset:24576
    ds_read_b64_tr_b16 v[110:111], v115 offset:26624
    s_waitcnt lgkmcnt(9)
    v_mfma_f32_32x32x16_bf16 v[128:143], v[72:75], v[76:79], v[128:143]
    v_mfma_f32_32x32x16_bf16 v[144:159], v[72:75], v[80:83], v[144:159]
    v_mfma_f32_32x32x16_bf16 v[160:175], v[72:75], v[84:87], v[160:175]
    v_mfma_f32_32x32x16_bf16 v[176:191], v[72:75], v[88:91], v[176:191]
    s_waitcnt lgkmcnt(0)
    v_mfma_f32_32x32x16_bf16 v[128:143], v[92:95], v[96:99], v[128:143]
    v_mfma_f32_32x32x16_bf16 v[144:159], v[92:95], v[100:103], v[144:159]
    v_mfma_f32_32x32x16_bf16 v[160:175], v[92:95], v[104:107], v[160:175]
    v_mfma_f32_32x32x16_bf16 v[176:191], v[92:95], v[108:111], v[176:191]
L_mi_ep:
    v_bfe_u32 v14, v1, 4, 1
    v_lshlrev_b32 v13, 10, v14
    v_lshrrev_b32 v14, 5, v1
    v_lshl_add_u32 v13, v14, 8, v13
    v_and_b32 v14, 15, v1
    v_lshl_add_u32 v13, v14, 4, v13
    s_add_u32 s47, s45, 4096
    s_nop 7
    v_cvt_pk_bf16_f32 v32, v128, v129
    v_cvt_pk_bf16_f32 v33, v130, v131
    v_cvt_pk_bf16_f32 v34, v136, v137
    v_cvt_pk_bf16_f32 v35, v138, v139
    buffer_store_dwordx4 v[32:35], v13, s[4:7], s45 offen offset:0 sc1
    v_cvt_pk_bf16_f32 v36, v132, v133
    v_cvt_pk_bf16_f32 v37, v134, v135
    v_cvt_pk_bf16_f32 v38, v140, v141
    v_cvt_pk_bf16_f32 v39, v142, v143
    buffer_store_dwordx4 v[36:39], v13, s[4:7], s45 offen offset:512 sc1
    v_cvt_pk_bf16_f32 v40, v144, v145
    v_cvt_pk_bf16_f32 v41, v146, v147
    v_cvt_pk_bf16_f32 v42, v152, v153
    v_cvt_pk_bf16_f32 v43, v154, v155
    buffer_store_dwordx4 v[40:43], v13, s[4:7], s45 offen offset:2048 sc1
    v_cvt_pk_bf16_f32 v44, v148, v149
    v_cvt_pk_bf16_f32 v45, v150, v151
    v_cvt_pk_bf16_f32 v46, v156, v157
    v_cvt_pk_bf16_f32 v47, v158, v159
    buffer_store_dwordx4 v[44:47], v13, s[4:7], s45 offen offset:2560 sc1
    v_cvt_pk_bf16_f32 v48, v160, v161
    v_cvt_pk_bf16_f32 v49, v162, v163
    v_cvt_pk_bf16_f32 v50, v168, v169
    v_cvt_pk_bf16_f32 v51, v170, v171
    buffer_store_dwordx4 v[48:51], v13, s[4:7], s47 offen offset:0 sc1
    v_cvt_pk_bf16_f32 v52, v164, v165
    v_cvt_pk_bf16_f32 v53, v166, v167
    v_cvt_pk_bf16_f32 v54, v172, v173
    v_cvt_pk_bf16_f32 v55, v174, v175
    buffer_store_dwordx4 v[52:55], v13, s[4:7], s47 offen offset:512 sc1
    v_cvt_pk_bf16_f32 v56, v176, v177
    v_cvt_pk_bf16_f32 v57, v178, v179
    v_cvt_pk_bf16_f32 v58, v184, v185
    v_cvt_pk_bf16_f32 v59, v186, v187
    buffer_store_dwordx4 v[56:59], v13, s[4:7], s47 offen offset:2048 sc1
    v_cvt_pk_bf16_f32 v60, v180, v181
    v_cvt_pk_bf16_f32 v61, v182, v183
    v_cvt_pk_bf16_f32 v62, v188, v189
    v_cvt_pk_bf16_f32 v63, v190, v191
    buffer_store_dwordx4 v[60:63], v13, s[4:7], s47 offen offset:2560 sc1
    s_mov_b32 s47, 140
    v_mov_b32 v14, s47
    v_mov_b32 v15, 1
    s_waitcnt vmcnt(0)
    s_barrier
    s_cmp_lg_u32 s16, 0
    s_cbranch_scc1 L_w_s0
    s_mov_b64 exec, 1
    buffer_atomic_add v15, v14, s[8:11], 0 offen
    s_mov_b64 exec, -1
L_w_s0:
    s_add_u32 s40, s40, 224
L_w_big:
    s_sub_u32 s40, s40, 128
    s_mov_b32 s47, 136
    v_mov_b32 v14, s47
    v_mov_b32 v15, 1
    s_waitcnt vmcnt(0)
    s_barrier
    s_cmp_lg_u32 s16, 0
    s_cbranch_scc1 L_w_s1
    s_mov_b64 exec, 1
    buffer_atomic_add v15, v14, s[8:11], 0 offen
    s_mov_b64 exec, -1
L_w_s1:
L_sa_tile:
    s_cmp_ge_u32 s40, 256
    s_cbranch_scc1 L_sa_d2
    s_cmp_ge_u32 s40, 96
    s_cbranch_scc1 L_sa_d1
    s_mul_i32 s42, s40, 21846
    s_lshr_b32 s42, s42, 16
    s_mul_i32 s47, s42, 3
    s_sub_u32 s41, s40, s47
    s_add_u32 s41, s41, 1
    s_branch L_sa_dkv
L_sa_d1:
    s_sub_u32 s42, s40, 96
    s_and_b32 s41, s42, 3
    s_add_u32 s41, s41, 4
    s_lshr_b32 s42, s42, 2
L_sa_dkv:
    s_mov_b32 s44, 8192
    s_mov_b32 s26, 0x400000
    s_cmp_ge_u32 s42, 16
    s_cbranch_scc1 L_sa_dv
    s_mov_b32 s43, 0
    s_mov_b32 s24, s34
    s_mov_b32 s25, s35
    s_mov_b32 s45, 16777216
    s_branch L_sa_dq2
L_sa_dv:
    s_sub_u32 s42, s42, 16
    s_mov_b32 s43, 1
    s_mov_b32 s24, s36
    s_mov_b32 s25, s37
    s_mov_b32 s45, 33554432
    s_branch L_sa_dq2
L_sa_d2:
    s_and_b32 s41, s40, 7
    s_cmp_ge_u32 s40, 384
    s_cbranch_scc1 L_sa_dh
    s_sub_u32 s42, s40, 256
    s_lshr_b32 s42, s42, 3
    s_mov_b32 s44, 8192
    s_mov_b32 s26, 0x400000
    s_mov_b32 s43, 0
    s_mov_b32 s24, s32
    s_mov_b32 s25, s33
    s_mov_b32 s45, 50331648
L_sa_dq2:
    s_lshl_b32 s47, s41, 3
    s_lshr_b32 s48, s16, 1
    s_lshl_b32 s48, s48, 2
    s_add_u32 s47, s47, s48
    s_lshl_b32 s47, s47, 5
    s_lshl_b32 s48, s42, 1
    s_add_u32 s47, s47, s48
    s_and_b32 s48, s16, 1
    s_add_u32 s47, s47, s48
    s_lshl_b32 s47, s47, 13
    s_add_u32 s45, s45, s47
    s_branch L_sa_dd
L_sa_dh:
    s_sub_u32 s42, s40, 384
    s_lshr_b32 s42, s42, 3
    s_mov_b32 s44, 3584
    s_mov_b32 s26, 1835008
    s_mov_b32 s43, 2
    s_mov_b32 s24, s38
    s_mov_b32 s25, s39
    s_lshl_b32 s47, s41, 3
    s_lshr_b32 s48, s16, 1
    s_lshl_b32 s48, s48, 2
    s_add_u32 s47, s47, s48
    s_mul_i32 s47, s47, 56
    s_lshl_b32 s48, s42, 3
    s_add_u32 s47, s47, s48
    s_and_b32 s48, s16, 1
    s_lshl_b32 s48, s48, 2
    s_add_u32 s47, s47, s48
    s_lshl_b32 s47, s47, 11
    s_add_u32 s45, s47, 67108864
L_sa_dd:
    s_mov_b32 s27, 0x20000
    s_lshl_b32 s49, s41, 18
    s_lshl_b32 s47, s16, 16
    s_add_u32 s49, s49, s47
    s_lshl_b32 s47, s16, 4
    s_mul_i32 s50, s47, s44
    s_lshl_b32 s47, s42, 9
    s_add_u32 s50, s50, s47
    s_lshl_b32 s54, s44, 1
    v_lshrrev_b32 v14, 5, v1
    v_and_b32 v15, 31, v1
    v_lshlrev_b32 v16, 2, v14
    v_xor_b32 v15, v15, v16
    v_lshlrev_b32 v15, 4, v15
    v_mul_lo_u32 v14, v14, s44
    v_add_u32 v3, v14, v15
    v_xor_b32 v15, 128, v15
    v_add_u32 v4, v14, v15
    v_xor_b32 v16, 64, v2
    s_add_u32 m0, s51, 0
    s_add_u32 s47, s49, 0
    buffer_load_dwordx4 v2, s[20:23], s47 offen lds
    s_add_u32 m0, s51, 1024
    s_add_u32 s47, s49, 8192
    buffer_load_dwordx4 v16, s[20:23], s47 offen lds
    s_add_u32 m0, s51, 2048
    s_add_u32 s47, s49, 16384
    buffer_load_dwordx4 v2, s[20:23], s47 offen lds
    s_add_u32 m0, s51, 3072
    s_add_u32 s47, s49, 24576
    buffer_load_dwordx4 v16, s[20:23], s47 offen lds
    s_add_u32 m0, s51, 4096
    s_add_u32 s47, s49, 32768
    buffer_load_dwordx4 v2, s[20:23], s47 offen lds
    s_add_u32 m0, s51, 5120
    s_add_u32 s47, s49, 40960
    buffer_load_dwordx4 v16, s[20:23], s47 offen lds
    s_add_u32 m0, s51, 6144
    s_add_u32 s47, s49, 49152
    buffer_load_dwordx4 v2, s[20:23], s47 offen lds
    s_add_u32 m0, s51, 7168
    s_add_u32 s47, s49, 57344
    buffer_load_dwordx4 v16, s[20:23], s47 offen lds
    s_add_u32 m0, s52, 0
    s_mov_b32 s48, s50
    buffer_load_dwordx4 v3, s[24:27], s48 offen lds
    s_add_u32 m0, s52, 1024
    s_add_u32 s48, s48, s54
    buffer_load_dwordx4 v4, s[24:27], s48 offen lds
    s_add_u32 m0, s52, 2048
    s_add_u32 s48, s48, s54
    buffer_load_dwordx4 v3, s[24:27], s48 offen lds
    s_add_u32 m0, s52, 3072
    s_add_u32 s48, s48, s54
    buffer_load_dwordx4 v4, s[24:27], s48 offen lds
    s_add_u32 m0, s52, 4096
    s_add_u32 s48, s48, s54
    buffer_load_dwordx4 v3, s[24:27], s48 offen lds
    s_add_u32 m0, s52, 5120
    s_add_u32 s48, s48, s54
    buffer_load_dwordx4 v4, s[24:27], s48 offen lds
    s_add_u32 m0, s52, 6144
    s_add_u32 s48, s48, s54
    buffer_load_dwordx4 v3, s[24:27], s48 offen lds
    s_add_u32 m0, s52, 7168
    s_add_u32 s48, s48, s54
    buffer_load_dwordx4 v4, s[24:27], s48 offen lds
    s_add_u32 s49, s49, 128
    s_lshl_b32 s47, s44, 6
    s_add_u32 s50, s50, s47
    v_accvgpr_write_b32 a0, 0
    v_accvgpr_write_b32 a1, 0
    v_accvgpr_write_b32 a2, 0
    v_accvgpr_write_b32 a3, 0
    v_accvgpr_write_b32 a4, 0
    v_accvgpr_write_b32 a5, 0
    v_accvgpr_write_b32 a6, 0
    v_accvgpr_write_b32 a7, 0
    v_accvgpr_write_b32 a8, 0
    v_accvgpr_write_b32 a9, 0
    v_accvgpr_write_b32 a10, 0
    v_accvgpr_write_b32 a11, 0
    v_accvgpr_write_b32 a12, 0
    v_accvgpr_write_b32 a13, 0
    v_accvgpr_write_b32 a14, 0
    v_accvgpr_write_b32 a15, 0
    v_accvgpr_write_b32 a16, 0
    v_accvgpr_write_b32 a17, 0
    v_accvgpr_write_b32 a18, 0
    v_accvgpr_write_b32 a19, 0
    v_accvgpr_write_b32 a20, 0
    v_accvgpr_write_b32 a21, 0
    v_accvgpr_write_b32 a22, 0
    v_accvgpr_write_b32 a23, 0
    v_accvgpr_write_b32 a24, 0
    v_accvgpr_write_b32 a25, 0
    v_accvgpr_write_b32 a26, 0
    v_accvgpr_write_b32 a27, 0
    v_accvgpr_write_b32 a28, 0
    v_accvgpr_write_b32 a29, 0
    v_accvgpr_write_b32 a30, 0
    v_accvgpr_write_b32 a31, 0
    v_accvgpr_write_b32 a32, 0
    v_accvgpr_write_b32 a33, 0
    v_accvgpr_write_b32 a34, 0
    v_accvgpr_write_b32 a35, 0
    v_accvgpr_write_b32 a36, 0
    v_accvgpr_write_b32 a37, 0
    v_accvgpr_write_b32 a38, 0
    v_accvgpr_write_b32 a39, 0
    v_accvgpr_write_b32 a40, 0
    v_accvgpr_write_b32 a41, 0
    v_accvgpr_write_b32 a42, 0
    v_accvgpr_write_b32 a43, 0
    v_accvgpr_write_b32 a44, 0
    v_accvgpr_write_b32 a45, 0
    v_accvgpr_write_b32 a46, 0
    v_accvgpr_write_b32 a47, 0
    v_accvgpr_write_b32 a48, 0
    v_accvgpr_write_b32 a49, 0
    v_accvgpr_write_b32 a50, 0
    v_accvgpr_write_b32 a51, 0
    v_accvgpr_write_b32 a52, 0
    v_accvgpr_write_b32 a53, 0
    v_accvgpr_write_b32 a54, 0
    v_accvgpr_write_b32 a55, 0
    v_accvgpr_write_b32 a56, 0
    v_accvgpr_write_b32 a57, 0
    v_accvgpr_write_b32 a58, 0
    v_accvgpr_write_b32 a59, 0
    v_accvgpr_write_b32 a60, 0
    v_accvgpr_write_b32 a61, 0
    v_accvgpr_write_b32 a62, 0
    v_accvgpr_write_b32 a63, 0
    v_accvgpr_write_b32 a64, 0
    v_accvgpr_write_b32 a65, 0
    v_accvgpr_write_b32 a66, 0
    v_accvgpr_write_b32 a67, 0
    v_accvgpr_write_b32 a68, 0
    v_accvgpr_write_b32 a69, 0
    v_accvgpr_write_b32 a70, 0
    v_accvgpr_write_b32 a71, 0
    v_accvgpr_write_b32 a72, 0
    v_accvgpr_write_b32 a73, 0
    v_accvgpr_write_b32 a74, 0
    v_accvgpr_write_b32 a75, 0
    v_accvgpr_write_b32 a76, 0
    v_accvgpr_write_b32 a77, 0
    v_accvgpr_write_b32 a78, 0
    v_accvgpr_write_b32 a79, 0
    v_accvgpr_write_b32 a80, 0
    v_accvgpr_write_b32 a81, 0
    v_accvgpr_write_b32 a82, 0
    v_accvgpr_write_b32 a83, 0
    v_accvgpr_write_b32 a84, 0
    v_accvgpr_write_b32 a85, 0
    v_accvgpr_write_b32 a86, 0
    v_accvgpr_write_b32 a87, 0
    v_accvgpr_write_b32 a88, 0
    v_accvgpr_write_b32 a89, 0
    v_accvgpr_write_b32 a90, 0
    v_accvgpr_write_b32 a91, 0
    v_accvgpr_write_b32 a92, 0
    v_accvgpr_write_b32 a93, 0
    v_accvgpr_write_b32 a94, 0
    v_accvgpr_write_b32 a95, 0
    v_accvgpr_write_b32 a96, 0
    v_accvgpr_write_b32 a97, 0
    v_accvgpr_write_b32 a98, 0
    v_accvgpr_write_b32 a99, 0
    v_accvgpr_write_b32 a100, 0
    v_accvgpr_write_b32 a101, 0
    v_accvgpr_write_b32 a102, 0
    v_accvgpr_write_b32 a103, 0
    v_accvgpr_write_b32 a104, 0
    v_accvgpr_write_b32 a105, 0
    v_accvgpr_write_b32 a106, 0
    v_accvgpr_write_b32 a107, 0
    v_accvgpr_write_b32 a108, 0
    v_accvgpr_write_b32 a109, 0
    v_accvgpr_write_b32 a110, 0
    v_accvgpr_write_b32 a111, 0
    v_accvgpr_write_b32 a112, 0
    v_accvgpr_write_b32 a113, 0
    v_accvgpr_write_b32 a114, 0
    v_accvgpr_write_b32 a115, 0
    v_accvgpr_write_b32 a116, 0
    v_accvgpr_write_b32 a117, 0
    v_accvgpr_write_b32 a118, 0
    v_accvgpr_write_b32 a119, 0
    v_accvgpr_write_b32 a120, 0
    v_accvgpr_write_b32 a121, 0
    v_accvgpr_write_b32 a122, 0
    v_accvgpr_write_b32 a123, 0
    v_accvgpr_write_b32 a124, 0
    v_accvgpr_write_b32 a125, 0
    v_accvgpr_write_b32 a126, 0
    v_accvgpr_write_b32 a127, 0
    v_accvgpr_write_b32 a128, 0
    v_accvgpr_write_b32 a129, 0
    v_accvgpr_write_b32 a130, 0
    v_accvgpr_write_b32 a131, 0
    v_accvgpr_write_b32 a132, 0
    v_accvgpr_write_b32 a133, 0
    v_accvgpr_write_b32 a134, 0
    v_accvgpr_write_b32 a135, 0
    v_accvgpr_write_b32 a136, 0
    v_accvgpr_write_b32 a137, 0
    v_accvgpr_write_b32 a138, 0
    v_accvgpr_write_b32 a139, 0
    v_accvgpr_write_b32 a140, 0
    v_accvgpr_write_b32 a141, 0
    v_accvgpr_write_b32 a142, 0
    v_accvgpr_write_b32 a143, 0
    v_accvgpr_write_b32 a144, 0
    v_accvgpr_write_b32 a145, 0
    v_accvgpr_write_b32 a146, 0
    v_accvgpr_write_b32 a147, 0
    v_accvgpr_write_b32 a148, 0
    v_accvgpr_write_b32 a149, 0
    v_accvgpr_write_b32 a150, 0
    v_accvgpr_write_b32 a151, 0
    v_accvgpr_write_b32 a152, 0
    v_accvgpr_write_b32 a153, 0
    v_accvgpr_write_b32 a154, 0
    v_accvgpr_write_b32 a155, 0
    v_accvgpr_write_b32 a156, 0
    v_accvgpr_write_b32 a157, 0
    v_accvgpr_write_b32 a158, 0
    v_accvgpr_write_b32 a159, 0
    v_accvgpr_write_b32 a160, 0
    v_accvgpr_write_b32 a161, 0
    v_accvgpr_write_b32 a162, 0
    v_accvgpr_write_b32 a163, 0
    v_accvgpr_write_b32 a164, 0
    v_accvgpr_write_b32 a165, 0
    v_accvgpr_write_b32 a166, 0
    v_accvgpr_write_b32 a167, 0
    v_accvgpr_write_b32 a168, 0
    v_accvgpr_write_b32 a169, 0
    v_accvgpr_write_b32 a170, 0
    v_accvgpr_write_b32 a171, 0
    v_accvgpr_write_b32 a172, 0
    v_accvgpr_write_b32 a173, 0
    v_accvgpr_write_b32 a174, 0
    v_accvgpr_write_b32 a175, 0
    v_accvgpr_write_b32 a176, 0
    v_accvgpr_write_b32 a177, 0
    v_accvgpr_write_b32 a178, 0
    v_accvgpr_write_b32 a179, 0
    v_accvgpr_write_b32 a180, 0
    v_accvgpr_write_b32 a181, 0
    v_accvgpr_write_b32 a182, 0
    v_accvgpr_write_b32 a183, 0
    v_accvgpr_write_b32 a184, 0
    v_accvgpr_write_b32 a185, 0
    v_accvgpr_write_b32 a186, 0
    v_accvgpr_write_b32 a187, 0
    v_accvgpr_write_b32 a188, 0
    v_accvgpr_write_b32 a189, 0
    v_accvgpr_write_b32 a190, 0
    v_accvgpr_write_b32 a191, 0
    v_accvgpr_write_b32 a192, 0
    v_accvgpr_write_b32 a193, 0
    v_accvgpr_write_b32 a194, 0
    v_accvgpr_write_b32 a195, 0
    v_accvgpr_write_b32 a196, 0
    v_accvgpr_write_b32 a197, 0
    v_accvgpr_write_b32 a198, 0
    v_accvgpr_write_b32 a199, 0
    v_accvgpr_write_b32 a200, 0
    v_accvgpr_write_b32 a201, 0
    v_accvgpr_write_b32 a202, 0
    v_accvgpr_write_b32 a203, 0
    v_accvgpr_write_b32 a204, 0
    v_accvgpr_write_b32 a205, 0
    v_accvgpr_write_b32 a206, 0
    v_accvgpr_write_b32 a207, 0
    v_accvgpr_write_b32 a208, 0
    v_accvgpr_write_b32 a209, 0
    v_accvgpr_write_b32 a210, 0
    v_accvgpr_write_b32 a211, 0
    v_accvgpr_write_b32 a212, 0
    v_accvgpr_write_b32 a213, 0
    v_accvgpr_write_b32 a214, 0
    v_accvgpr_write_b32 a215, 0
    v_accvgpr_write_b32 a216, 0
    v_accvgpr_write_b32 a217, 0
    v_accvgpr_write_b32 a218, 0
    v_accvgpr_write_b32 a219, 0
    v_accvgpr_write_b32 a220, 0
    v_accvgpr_write_b32 a221, 0
    v_accvgpr_write_b32 a222, 0
    v_accvgpr_write_b32 a223, 0
    v_accvgpr_write_b32 a224, 0
    v_accvgpr_write_b32 a225, 0
    v_accvgpr_write_b32 a226, 0
    v_accvgpr_write_b32 a227, 0
    v_accvgpr_write_b32 a228, 0
    v_accvgpr_write_b32 a229, 0
    v_accvgpr_write_b32 a230, 0
    v_accvgpr_write_b32 a231, 0
    v_accvgpr_write_b32 a232, 0
    v_accvgpr_write_b32 a233, 0
    v_accvgpr_write_b32 a234, 0
    v_accvgpr_write_b32 a235, 0
    v_accvgpr_write_b32 a236, 0
    v_accvgpr_write_b32 a237, 0
    v_accvgpr_write_b32 a238, 0
    v_accvgpr_write_b32 a239, 0
    v_accvgpr_write_b32 a240, 0
    v_accvgpr_write_b32 a241, 0
    v_accvgpr_write_b32 a242, 0
    v_accvgpr_write_b32 a243, 0
    v_accvgpr_write_b32 a244, 0
    v_accvgpr_write_b32 a245, 0
    v_accvgpr_write_b32 a246, 0
    v_accvgpr_write_b32 a247, 0
    v_accvgpr_write_b32 a248, 0
    v_accvgpr_write_b32 a249, 0
    v_accvgpr_write_b32 a250, 0
    v_accvgpr_write_b32 a251, 0
    v_accvgpr_write_b32 a252, 0
    v_accvgpr_write_b32 a253, 0
    v_accvgpr_write_b32 a254, 0
    v_accvgpr_write_b32 a255, 0
    s_cmp_eq_u32 s43, 1
    s_cbranch_scc1 L_sa_mv
    s_mov_b32 s46, 0
L_sa_kt:
    s_waitcnt vmcnt(0)
    s_barrier
    ds_read_b128 v[32:35], v5 offset:0
    ds_read_b128 v[36:39], v5 offset:4096
    ds_read_b128 v[40:43], v5 offset:8192
    ds_read_b128 v[44:47], v5 offset:12288
    ds_read_b64_tr_b16 v[48:49], v9 offset:0
    ds_read_b64_tr_b16 v[50:51], v9 offset:2048
    ds_read_b64_tr_b16 v[52:53], v10 offset:0
    ds_read_b64_tr_b16 v[54:55], v10 offset:2048
    ds_read_b64_tr_b16 v[56:57], v11 offset:0
    ds_read_b64_tr_b16 v[58:59], v11 offset:2048
    ds_read_b64_tr_b16 v[60:61], v12 offset:0
    ds_read_b64_tr_b16 v[62:63], v12 offset:2048
    s_waitcnt lgkmcnt(0)
    v_mfma_f32_32x32x16_bf16 a[0:15], v[48:51], v[32:35], a[0:15]
    ds_read_b128 v[64:67], v6 offset:0
    v_mfma_f32_32x32x16_bf16 a[16:31], v[52:55], v[32:35], a[16:31]
    ds_read_b128 v[68:71], v6 offset:4096
    s_add_u32 m0, s51, 65536
    s_add_u32 s47, s49, 0
    buffer_load_dwordx4 v2, s[20:23], s47 offen lds
    v_mfma_f32_32x32x16_bf16 a[32:47], v[56:59], v[32:35], a[32:47]
    ds_read_b128 v[72:75], v6 offset:8192
    v_mfma_f32_32x32x16_bf16 a[48:63], v[60:63], v[32:35], a[48:63]
    ds_read_b128 v[76:79], v6 offset:12288
    s_add_u32 m0, s51, 66560
    s_add_u32 s47, s49, 8192
    buffer_load_dwordx4 v16, s[20:23], s47 offen lds
    v_mfma_f32_32x32x16_bf16 a[64:79], v[48:51], v[36:39], a[64:79]
    ds_read_b64_tr_b16 v[80:81], v9 offset:8192
    v_mfma_f32_32x32x16_bf16 a[80:95], v[52:55], v[36:39], a[80:95]
    ds_read_b64_tr_b16 v[82:83], v9 offset:10240
    s_add_u32 m0, s51, 67584
    s_add_u32 s47, s49, 16384
    buffer_load_dwordx4 v2, s[20:23], s47 offen lds
    v_mfma_f32_32x32x16_bf16 a[96:111], v[56:59], v[36:39], a[96:111]
    ds_read_b64_tr_b16 v[84:85], v10 offset:8192
    v_mfma_f32_32x32x16_bf16 a[112:127], v[60:63], v[36:39], a[112:127]
    ds_read_b64_tr_b16 v[86:87], v10 offset:10240
    s_add_u32 m0, s51, 68608
    s_add_u32 s47, s49, 24576
    buffer_load_dwordx4 v16, s[20:23], s47 offen lds
    v_mfma_f32_32x32x16_bf16 a[128:143], v[48:51], v[40:43], a[128:143]
    ds_read_b64_tr_b16 v[88:89], v11 offset:8192
    v_mfma_f32_32x32x16_bf16 a[144:159], v[52:55], v[40:43], a[144:159]
    ds_read_b64_tr_b16 v[90:91], v11 offset:10240
    s_add_u32 m0, s51, 69632
    s_add_u32 s47, s49, 32768
    buffer_load_dwordx4 v2, s[20:23], s47 offen lds
    v_mfma_f32_32x32x16_bf16 a[160:175], v[56:59], v[40:43], a[160:175]
    ds_read_b64_tr_b16 v[92:93], v12 offset:8192
    v_mfma_f32_32x32x16_bf16 a[176:191], v[60:63], v[40:43], a[176:191]
    ds_read_b64_tr_b16 v[94:95], v12 offset:10240
    s_add_u32 m0, s51, 70656
    s_add_u32 s47, s49, 40960
    buffer_load_dwordx4 v16, s[20:23], s47 offen lds
    v_mfma_f32_32x32x16_bf16 a[192:207], v[48:51], v[44:47], a[192:207]
    v_mfma_f32_32x32x16_bf16 a[208:223], v[52:55], v[44:47], a[208:223]
    s_add_u32 m0, s51, 71680
    s_add_u32 s47, s49, 49152
    buffer_load_dwordx4 v2, s[20:23], s47 offen lds
    v_mfma_f32_32x32x16_bf16 a[224:239], v[56:59], v[44:47], a[224:239]
    v_mfma_f32_32x32x16_bf16 a[240:255], v[60:63], v[44:47], a[240:255]
    s_add_u32 m0, s51, 72704
    s_add_u32 s47, s49, 57344
    buffer_load_dwordx4 v16, s[20:23], s47 offen lds
    s_waitcnt lgkmcnt(0)
    v_mfma_f32_32x32x16_bf16 a[0:15], v[80:83], v[64:67], a[0:15]
    ds_read_b128 v[32:35], v7 offset:0
    v_mfma_f32_32x32x16_bf16 a[16:31], v[84:87], v[64:67], a[16:31]
    ds_read_b128 v[36:39], v7 offset:4096
    s_add_u32 m0, s52, 65536
    s_mov_b32 s48, s50
    buffer_load_dwordx4 v3, s[24:27], s48 offen lds
    v_mfma_f32_32x32x16_bf16 a[32:47], v[88:91], v[64:67], a[32:47]
    ds_read_b128 v[40:43], v7 offset:8192
    v_mfma_f32_32x32x16_bf16 a[48:63], v[92:95], v[64:67], a[48:63]
    ds_read_b128 v[44:47], v7 offset:12288
    s_add_u32 m0, s52, 66560
    s_add_u32 s48, s48, s54
    buffer_load_dwordx4 v4, s[24:27], s48 offen lds
    v_mfma_f32_32x32x16_bf16 a[64:79], v[80:83], v[68:71], a[64:79]
    ds_read_b64_tr_b16 v[48:49], v9 offset:16384
    v_mfma_f32_32x32x16_bf16 a[80:95], v[84:87], v[68:71], a[80:95]
    ds_read_b64_tr_b16 v[50:51], v9 offset:18432
    s_add_u32 m0, s52, 67584
    s_add_u32 s48, s48, s54
    buffer_load_dwordx4 v3, s[24:27], s48 offen lds
    v_mfma_f32_32x32x16_bf16 a[96:111], v[88:91], v[68:71], a[96:111]
    ds_read_b64_tr_b16 v[52:53], v10 offset:16384
    v_mfma_f32_32x32x16_bf16 a[112:127], v[92:95], v[68:71], a[112:127]
    ds_read_b64_tr_b16 v[54:55], v10 offset:18432
    s_add_u32 m0, s52, 68608
    s_add_u32 s48, s48, s54
    buffer_load_dwordx4 v4, s[24:27], s48 offen lds
    v_mfma_f32_32x32x16_bf16 a[128:143], v[80:83], v[72:75], a[128:143]
    ds_read_b64_tr_b16 v[56:57], v11 offset:16384
    v_mfma_f32_32x32x16_bf16 a[144:159], v[84:87], v[72:75], a[144:159]
    ds_read_b64_tr_b16 v[58:59], v11 offset:18432
    s_add_u32 m0, s52, 69632
    s_add_u32 s48, s48, s54
    buffer_load_dwordx4 v3, s[24:27], s48 offen lds
    v_mfma_f32_32x32x16_bf16 a[160:175], v[88:91], v[72:75], a[160:175]
    ds_read_b64_tr_b16 v[60:61], v12 offset:16384
    v_mfma_f32_32x32x16_bf16 a[176:191], v[92:95], v[72:75], a[176:191]
    ds_read_b64_tr_b16 v[62:63], v12 offset:18432
    s_add_u32 m0, s52, 70656
    s_add_u32 s48, s48, s54
    buffer_load_dwordx4 v4, s[24:27], s48 offen lds
    v_mfma_f32_32x32x16_bf16 a[192:207], v[80:83], v[76:79], a[192:207]
    v_mfma_f32_32x32x16_bf16 a[208:223], v[84:87], v[76:79], a[208:223]
    s_add_u32 m0, s52, 71680
    s_add_u32 s48, s48, s54
    buffer_load_dwordx4 v3, s[24:27], s48 offen lds
    v_mfma_f32_32x32x16_bf16 a[224:239], v[88:91], v[76:79], a[224:239]
    v_mfma_f32_32x32x16_bf16 a[240:255], v[92:95], v[76:79], a[240:255]
    s_add_u32 m0, s52, 72704
    s_add_u32 s48, s48, s54
    buffer_load_dwordx4 v4, s[24:27], s48 offen lds
    s_add_u32 s49, s49, 128
    s_lshl_b32 s47, s44, 6
    s_add_u32 s50, s50, s47
    s_waitcnt lgkmcnt(0)
    v_mfma_f32_32x32x16_bf16 a[0:15], v[48:51], v[32:35], a[0:15]
    ds_read_b128 v[64:67], v8 offset:0
    v_mfma_f32_32x32x16_bf16 a[16:31], v[52:55], v[32:35], a[16:31]
    ds_read_b128 v[68:71], v8 offset:4096
    v_mfma_f32_32x32x16_bf16 a[32:47], v[56:59], v[32:35], a[32:47]
    ds_read_b128 v[72:75], v8 offset:8192
    v_mfma_f32_32x32x16_bf16 a[48:63], v[60:63], v[32:35], a[48:63]
    ds_read_b128 v[76:79], v8 offset:12288
    v_mfma_f32_32x32x16_bf16 a[64:79], v[48:51], v[36:39], a[64:79]
    ds_read_b64_tr_b16 v[80:81], v9 offset:24576
    v_mfma_f32_32x32x16_bf16 a[80:95], v[52:55], v[36:39], a[80:95]
    ds_read_b64_tr_b16 v[82:83], v9 offset:26624
    v_mfma_f32_32x32x16_bf16 a[96:111], v[56:59], v[36:39], a[96:111]
    ds_read_b64_tr_b16 v[84:85], v10 offset:24576
    v_mfma_f32_32x32x16_bf16 a[112:127], v[60:63], v[36:39], a[112:127]
    ds_read_b64_tr_b16 v[86:87], v10 offset:26624
    v_mfma_f32_32x32x16_bf16 a[128:143], v[48:51], v[40:43], a[128:143]
    ds_read_b64_tr_b16 v[88:89], v11 offset:24576
    v_mfma_f32_32x32x16_bf16 a[144:159], v[52:55], v[40:43], a[144:159]
    ds_read_b64_tr_b16 v[90:91], v11 offset:26624
    v_mfma_f32_32x32x16_bf16 a[160:175], v[56:59], v[40:43], a[160:175]
    ds_read_b64_tr_b16 v[92:93], v12 offset:24576
    v_mfma_f32_32x32x16_bf16 a[176:191], v[60:63], v[40:43], a[176:191]
    ds_read_b64_tr_b16 v[94:95], v12 offset:26624
    v_mfma_f32_32x32x16_bf16 a[192:207], v[48:51], v[44:47], a[192:207]
    v_mfma_f32_32x32x16_bf16 a[208:223], v[52:55], v[44:47], a[208:223]
    v_mfma_f32_32x32x16_bf16 a[224:239], v[56:59], v[44:47], a[224:239]
    v_mfma_f32_32x32x16_bf16 a[240:255], v[60:63], v[44:47], a[240:255]
    s_waitcnt lgkmcnt(0)
    v_mfma_f32_32x32x16_bf16 a[0:15], v[80:83], v[64:67], a[0:15]
    v_mfma_f32_32x32x16_bf16 a[16:31], v[84:87], v[64:67], a[16:31]
    v_mfma_f32_32x32x16_bf16 a[32:47], v[88:91], v[64:67], a[32:47]
    v_mfma_f32_32x32x16_bf16 a[48:63], v[92:95], v[64:67], a[48:63]
    v_mfma_f32_32x32x16_bf16 a[64:79], v[80:83], v[68:71], a[64:79]
    v_mfma_f32_32x32x16_bf16 a[80:95], v[84:87], v[68:71], a[80:95]
    v_mfma_f32_32x32x16_bf16 a[96:111], v[88:91], v[68:71], a[96:111]
    v_mfma_f32_32x32x16_bf16 a[112:127], v[92:95], v[68:71], a[112:127]
    v_mfma_f32_32x32x16_bf16 a[128:143], v[80:83], v[72:75], a[128:143]
    v_mfma_f32_32x32x16_bf16 a[144:159], v[84:87], v[72:75], a[144:159]
    v_mfma_f32_32x32x16_bf16 a[160:175], v[88:91], v[72:75], a[160:175]
    v_mfma_f32_32x32x16_bf16 a[176:191], v[92:95], v[72:75], a[176:191]
    v_mfma_f32_32x32x16_bf16 a[192:207], v[80:83], v[76:79], a[192:207]
    v_mfma_f32_32x32x16_bf16 a[208:223], v[84:87], v[76:79], a[208:223]
    v_mfma_f32_32x32x16_bf16 a[224:239], v[88:91], v[76:79], a[224:239]
    v_mfma_f32_32x32x16_bf16 a[240:255], v[92:95], v[76:79], a[240:255]
    v_xor_b32 v5, 65536, v5
    v_xor_b32 v6, 65536, v6
    v_xor_b32 v7, 65536, v7
    v_xor_b32 v8, 65536, v8
    v_xor_b32 v9, 65536, v9
    v_xor_b32 v10, 65536, v10
    v_xor_b32 v11, 65536, v11
    v_xor_b32 v12, 65536, v12
    s_waitcnt vmcnt(0)
    s_barrier
    ds_read_b128 v[32:35], v5 offset:0
    ds_read_b128 v[36:39], v5 offset:4096
    ds_read_b128 v[40:43], v5 offset:8192
    ds_read_b128 v[44:47], v5 offset:12288
    ds_read_b64_tr_b16 v[48:49], v9 offset:0
    ds_read_b64_tr_b16 v[50:51], v9 offset:2048
    ds_read_b64_tr_b16 v[52:53], v10 offset:0
    ds_read_b64_tr_b16 v[54:55], v10 offset:2048
    ds_read_b64_tr_b16 v[56:57], v11 offset:0
    ds_read_b64_tr_b16 v[58:59], v11 offset:2048
    ds_read_b64_tr_b16 v[60:61], v12 offset:0
    ds_read_b64_tr_b16 v[62:63], v12 offset:2048
    s_waitcnt lgkmcnt(0)
    v_mfma_f32_32x32x16_bf16 a[0:15], v[48:51], v[32:35], a[0:15]
    ds_read_b128 v[64:67], v6 offset:0
    v_mfma_f32_32x32x16_bf16 a[16:31], v[52:55], v[32:35], a[16:31]
    ds_read_b128 v[68:71], v6 offset:4096
    s_cmp_eq_u32 s46, 3
    s_cbranch_scc1 L_sa_skt_0_1
    s_add_u32 m0, s51, 0
    s_add_u32 s47, s49, 0
    buffer_load_dwordx4 v2, s[20:23], s47 offen lds
L_sa_skt_0_1:
    v_mfma_f32_32x32x16_bf16 a[32:47], v[56:59], v[32:35], a[32:47]
    ds_read_b128 v[72:75], v6 offset:8192
    v_mfma_f32_32x32x16_bf16 a[48:63], v[60:63], v[32:35], a[48:63]
    ds_read_b128 v[76:79], v6 offset:12288
    s_cmp_eq_u32 s46, 3
    s_cbranch_scc1 L_sa_skt_0_3
    s_add_u32 m0, s51, 1024
    s_add_u32 s47, s49, 8192
    buffer_load_dwordx4 v16, s[20:23], s47 offen lds
L_sa_skt_0_3:
    v_mfma_f32_32x32x16_bf16 a[64:79], v[48:51], v[36:39], a[64:79]
    ds_read_b64_tr_b16 v[80:81], v9 offset:8192
    v_mfma_f32_32x32x16_bf16 a[80:95], v[52:55], v[36:39], a[80:95]
    ds_read_b64_tr_b16 v[82:83], v9 offset:10240
    s_cmp_eq_u32 s46, 3
    s_cbranch_scc1 L_sa_skt_0_5
    s_add_u32 m0, s51, 2048
    s_add_u32 s47, s49, 16384
    buffer_load_dwordx4 v2, s[20:23], s47 offen lds
L_sa_skt_0_5:
    v_mfma_f32_32x32x16_bf16 a[96:111], v[56:59], v[36:39], a[96:111]
    ds_read_b64_tr_b16 v[84:85], v10 offset:8192
    v_mfma_f32_32x32x16_bf16 a[112:127], v[60:63], v[36:39], a[112:127]
    ds_read_b64_tr_b16 v[86:87], v10 offset:10240
    s_cmp_eq_u32 s46, 3
    s_cbranch_scc1 L_sa_skt_0_7
    s_add_u32 m0, s51, 3072
    s_add_u32 s47, s49, 24576
    buffer_load_dwordx4 v16, s[20:23], s47 offen lds
L_sa_skt_0_7:
    v_mfma_f32_32x32x16_bf16 a[128:143], v[48:51], v[40:43], a[128:143]
    ds_read_b64_tr_b16 v[88:89], v11 offset:8192
    v_mfma_f32_32x32x16_bf16 a[144:159], v[52:55], v[40:43], a[144:159]
    ds_read_b64_tr_b16 v[90:91], v11 offset:10240
    s_cmp_eq_u32 s46, 3
    s_cbranch_scc1 L_sa_skt_0_9
    s_add_u32 m0, s51, 4096
    s_add_u32 s47, s49, 32768
    buffer_load_dwordx4 v2, s[20:23], s47 offen lds
L_sa_skt_0_9:
    v_mfma_f32_32x32x16_bf16 a[160:175], v[56:59], v[40:43], a[160:175]
    ds_read_b64_tr_b16 v[92:93], v12 offset:8192
    v_mfma_f32_32x32x16_bf16 a[176:191], v[60:63], v[40:43], a[176:191]
    ds_read_b64_tr_b16 v[94:95], v12 offset:10240
    s_cmp_eq_u32 s46, 3
    s_cbranch_scc1 L_sa_skt_0_11
    s_add_u32 m0, s51, 5120
    s_add_u32 s47, s49, 40960
    buffer_load_dwordx4 v16, s[20:23], s47 offen lds
L_sa_skt_0_11:
    v_mfma_f32_32x32x16_bf16 a[192:207], v[48:51], v[44:47], a[192:207]
    v_mfma_f32_32x32x16_bf16 a[208:223], v[52:55], v[44:47], a[208:223]
    s_cmp_eq_u32 s46, 3
    s_cbranch_scc1 L_sa_skt_0_13
    s_add_u32 m0, s51, 6144
    s_add_u32 s47, s49, 49152
    buffer_load_dwordx4 v2, s[20:23], s47 offen lds
L_sa_skt_0_13:
    v_mfma_f32_32x32x16_bf16 a[224:239], v[56:59], v[44:47], a[224:239]
    v_mfma_f32_32x32x16_bf16 a[240:255], v[60:63], v[44:47], a[240:255]
    s_cmp_eq_u32 s46, 3
    s_cbranch_scc1 L_sa_skt_0_15
    s_add_u32 m0, s51, 7168
    s_add_u32 s47, s49, 57344
    buffer_load_dwordx4 v16, s[20:23], s47 offen lds
L_sa_skt_0_15:
    s_waitcnt lgkmcnt(0)
    v_mfma_f32_32x32x16_bf16 a[0:15], v[80:83], v[64:67], a[0:15]
    ds_read_b128 v[32:35], v7 offset:0
    v_mfma_f32_32x32x16_bf16 a[16:31], v[84:87], v[64:67], a[16:31]
    ds_read_b128 v[36:39], v7 offset:4096
    s_cmp_eq_u32 s46, 3
    s_cbranch_scc1 L_sa_skt_1_1
    s_add_u32 m0, s52, 0
    s_mov_b32 s48, s50
    buffer_load_dwordx4 v3, s[24:27], s48 offen lds
L_sa_skt_1_1:
    v_mfma_f32_32x32x16_bf16 a[32:47], v[88:91], v[64:67], a[32:47]
    ds_read_b128 v[40:43], v7 offset:8192
    v_mfma_f32_32x32x16_bf16 a[48:63], v[92:95], v[64:67], a[48:63]
    ds_read_b128 v[44:47], v7 offset:12288
    s_cmp_eq_u32 s46, 3
    s_cbranch_scc1 L_sa_skt_1_3
    s_add_u32 m0, s52, 1024
    s_add_u32 s48, s48, s54
    buffer_load_dwordx4 v4, s[24:27], s48 offen lds
L_sa_skt_1_3:
    v_mfma_f32_32x32x16_bf16 a[64:79], v[80:83], v[68:71], a[64:79]
    ds_read_b64_tr_b16 v[48:49], v9 offset:16384
    v_mfma_f32_32x32x16_bf16 a[80:95], v[84:87], v[68:71], a[80:95]
    ds_read_b64_tr_b16 v[50:51], v9 offset:18432
    s_cmp_eq_u32 s46, 3
    s_cbranch_scc1 L_sa_skt_1_5
    s_add_u32 m0, s52, 2048
    s_add_u32 s48, s48, s54
    buffer_load_dwordx4 v3, s[24:27], s48 offen lds
L_sa_skt_1_5:
    v_mfma_f32_32x32x16_bf16 a[96:111], v[88:91], v[68:71], a[96:111]
    ds_read_b64_tr_b16 v[52:53], v10 offset:16384
    v_mfma_f32_32x32x16_bf16 a[112:127], v[92:95], v[68:71], a[112:127]
    ds_read_b64_tr_b16 v[54:55], v10 offset:18432
    s_cmp_eq_u32 s46, 3
    s_cbranch_scc1 L_sa_skt_1_7
    s_add_u32 m0, s52, 3072
    s_add_u32 s48, s48, s54
    buffer_load_dwordx4 v4, s[24:27], s48 offen lds
L_sa_skt_1_7:
    v_mfma_f32_32x32x16_bf16 a[128:143], v[80:83], v[72:75], a[128:143]
    ds_read_b64_tr_b16 v[56:57], v11 offset:16384
    v_mfma_f32_32x32x16_bf16 a[144:159], v[84:87], v[72:75], a[144:159]
    ds_read_b64_tr_b16 v[58:59], v11 offset:18432
    s_cmp_eq_u32 s46, 3
    s_cbranch_scc1 L_sa_skt_1_9
    s_add_u32 m0, s52, 4096
    s_add_u32 s48, s48, s54
    buffer_load_dwordx4 v3, s[24:27], s48 offen lds
L_sa_skt_1_9:
    v_mfma_f32_32x32x16_bf16 a[160:175], v[88:91], v[72:75], a[160:175]
    ds_read_b64_tr_b16 v[60:61], v12 offset:16384
    v_mfma_f32_32x32x16_bf16 a[176:191], v[92:95], v[72:75], a[176:191]
    ds_read_b64_tr_b16 v[62:63], v12 offset:18432
    s_cmp_eq_u32 s46, 3
    s_cbranch_scc1 L_sa_skt_1_11
    s_add_u32 m0, s52, 5120
    s_add_u32 s48, s48, s54
    buffer_load_dwordx4 v4, s[24:27], s48 offen lds
L_sa_skt_1_11:
    v_mfma_f32_32x32x16_bf16 a[192:207], v[80:83], v[76:79], a[192:207]
    v_mfma_f32_32x32x16_bf16 a[208:223], v[84:87], v[76:79], a[208:223]
    s_cmp_eq_u32 s46, 3
    s_cbranch_scc1 L_sa_skt_1_13
    s_add_u32 m0, s52, 6144
    s_add_u32 s48, s48, s54
    buffer_load_dwordx4 v3, s[24:27], s48 offen lds
L_sa_skt_1_13:
    v_mfma_f32_32x32x16_bf16 a[224:239], v[88:91], v[76:79], a[224:239]
    v_mfma_f32_32x32x16_bf16 a[240:255], v[92:95], v[76:79], a[240:255]
    s_cmp_eq_u32 s46, 3
    s_cbranch_scc1 L_sa_skt_1_15
    s_add_u32 m0, s52, 7168
    s_add_u32 s48, s48, s54
    buffer_load_dwordx4 v4, s[24:27], s48 offen lds
    s_add_u32 s49, s49, 128
    s_lshl_b32 s47, s44, 6
    s_add_u32 s50, s50, s47
L_sa_skt_1_15:
    s_waitcnt lgkmcnt(0)
    v_mfma_f32_32x32x16_bf16 a[0:15], v[48:51], v[32:35], a[0:15]
    ds_read_b128 v[64:67], v8 offset:0
    v_mfma_f32_32x32x16_bf16 a[16:31], v[52:55], v[32:35], a[16:31]
    ds_read_b128 v[68:71], v8 offset:4096
    v_mfma_f32_32x32x16_bf16 a[32:47], v[56:59], v[32:35], a[32:47]
    ds_read_b128 v[72:75], v8 offset:8192
    v_mfma_f32_32x32x16_bf16 a[48:63], v[60:63], v[32:35], a[48:63]
    ds_read_b128 v[76:79], v8 offset:12288
    v_mfma_f32_32x32x16_bf16 a[64:79], v[48:51], v[36:39], a[64:79]
    ds_read_b64_tr_b16 v[80:81], v9 offset:24576
    v_mfma_f32_32x32x16_bf16 a[80:95], v[52:55], v[36:39], a[80:95]
    ds_read_b64_tr_b16 v[82:83], v9 offset:26624
    v_mfma_f32_32x32x16_bf16 a[96:111], v[56:59], v[36:39], a[96:111]
    ds_read_b64_tr_b16 v[84:85], v10 offset:24576
    v_mfma_f32_32x32x16_bf16 a[112:127], v[60:63], v[36:39], a[112:127]
    ds_read_b64_tr_b16 v[86:87], v10 offset:26624
    v_mfma_f32_32x32x16_bf16 a[128:143], v[48:51], v[40:43], a[128:143]
    ds_read_b64_tr_b16 v[88:89], v11 offset:24576
    v_mfma_f32_32x32x16_bf16 a[144:159], v[52:55], v[40:43], a[144:159]
    ds_read_b64_tr_b16 v[90:91], v11 offset:26624
    v_mfma_f32_32x32x16_bf16 a[160:175], v[56:59], v[40:43], a[160:175]
    ds_read_b64_tr_b16 v[92:93], v12 offset:24576
    v_mfma_f32_32x32x16_bf16 a[176:191], v[60:63], v[40:43], a[176:191]
    ds_read_b64_tr_b16 v[94:95], v12 offset:26624
    v_mfma_f32_32x32x16_bf16 a[192:207], v[48:51], v[44:47], a[192:207]
    v_mfma_f32_32x32x16_bf16 a[208:223], v[52:55], v[44:47], a[208:223]
    v_mfma_f32_32x32x16_bf16 a[224:239], v[56:59], v[44:47], a[224:239]
    v_mfma_f32_32x32x16_bf16 a[240:255], v[60:63], v[44:47], a[240:255]
    s_waitcnt lgkmcnt(0)
    v_mfma_f32_32x32x16_bf16 a[0:15], v[80:83], v[64:67], a[0:15]
    v_mfma_f32_32x32x16_bf16 a[16:31], v[84:87], v[64:67], a[16:31]
    v_mfma_f32_32x32x16_bf16 a[32:47], v[88:91], v[64:67], a[32:47]
    v_mfma_f32_32x32x16_bf16 a[48:63], v[92:95], v[64:67], a[48:63]
    v_mfma_f32_32x32x16_bf16 a[64:79], v[80:83], v[68:71], a[64:79]
    v_mfma_f32_32x32x16_bf16 a[80:95], v[84:87], v[68:71], a[80:95]
    v_mfma_f32_32x32x16_bf16 a[96:111], v[88:91], v[68:71], a[96:111]
    v_mfma_f32_32x32x16_bf16 a[112:127], v[92:95], v[68:71], a[112:127]
    v_mfma_f32_32x32x16_bf16 a[128:143], v[80:83], v[72:75], a[128:143]
    v_mfma_f32_32x32x16_bf16 a[144:159], v[84:87], v[72:75], a[144:159]
    v_mfma_f32_32x32x16_bf16 a[160:175], v[88:91], v[72:75], a[160:175]
    v_mfma_f32_32x32x16_bf16 a[176:191], v[92:95], v[72:75], a[176:191]
    v_mfma_f32_32x32x16_bf16 a[192:207], v[80:83], v[76:79], a[192:207]
    v_mfma_f32_32x32x16_bf16 a[208:223], v[84:87], v[76:79], a[208:223]
    v_mfma_f32_32x32x16_bf16 a[224:239], v[88:91], v[76:79], a[224:239]
    v_mfma_f32_32x32x16_bf16 a[240:255], v[92:95], v[76:79], a[240:255]
    v_xor_b32 v5, 65536, v5
    v_xor_b32 v6, 65536, v6
    v_xor_b32 v7, 65536, v7
    v_xor_b32 v8, 65536, v8
    v_xor_b32 v9, 65536, v9
    v_xor_b32 v10, 65536, v10
    v_xor_b32 v11, 65536, v11
    v_xor_b32 v12, 65536, v12
    s_add_u32 s46, s46, 1
    s_cmp_lt_u32 s46, 4
    s_cbranch_scc1 L_sa_kt
    s_branch L_sa_ep
L_sa_mv:
    s_mov_b32 s46, 0
L_sa_kv:
    s_waitcnt vmcnt(0)
    s_barrier
    ds_read_b128 v[32:35], v5 offset:0
    ds_read_b128 v[36:39], v5 offset:4096
    ds_read_b128 v[40:43], v5 offset:8192
    ds_read_b128 v[44:47], v5 offset:12288
    ds_read_b64_tr_b16 v[48:49], v9 offset:0
    ds_read_b64_tr_b16 v[50:51], v9 offset:2048
    ds_read_b64_tr_b16 v[52:53], v10 offset:0
    ds_read_b64_tr_b16 v[54:55], v10 offset:2048
    ds_read_b64_tr_b16 v[56:57], v11 offset:0
    ds_read_b64_tr_b16 v[58:59], v11 offset:2048
    ds_read_b64_tr_b16 v[60:61], v12 offset:0
    ds_read_b64_tr_b16 v[62:63], v12 offset:2048
    s_waitcnt lgkmcnt(0)
    v_mfma_f32_32x32x16_bf16 a[0:15], v[32:35], v[48:51], a[0:15]
    ds_read_b128 v[64:67], v6 offset:0
    v_mfma_f32_32x32x16_bf16 a[16:31], v[32:35], v[52:55], a[16:31]
    ds_read_b128 v[68:71], v6 offset:4096
    s_add_u32 m0, s51, 65536
    s_add_u32 s47, s49, 0
    buffer_load_dwordx4 v2, s[20:23], s47 offen lds
    v_mfma_f32_32x32x16_bf16 a[32:47], v[32:35], v[56:59], a[32:47]
    ds_read_b128 v[72:75], v6 offset:8192
    v_mfma_f32_32x32x16_bf16 a[48:63], v[32:35], v[60:63], a[48:63]
    ds_read_b128 v[76:79], v6 offset:12288
    s_add_u32 m0, s51, 66560
    s_add_u32 s47, s49, 8192
    buffer_load_dwordx4 v16, s[20:23], s47 offen lds
    v_mfma_f32_32x32x16_bf16 a[64:79], v[36:39], v[48:51], a[64:79]
    ds_read_b64_tr_b16 v[80:81], v9 offset:8192
    v_mfma_f32_32x32x16_bf16 a[80:95], v[36:39], v[52:55], a[80:95]
    ds_read_b64_tr_b16 v[82:83], v9 offset:10240
    s_add_u32 m0, s51, 67584
    s_add_u32 s47, s49, 16384
    buffer_load_dwordx4 v2, s[20:23], s47 offen lds
    v_mfma_f32_32x32x16_bf16 a[96:111], v[36:39], v[56:59], a[96:111]
    ds_read_b64_tr_b16 v[84:85], v10 offset:8192
    v_mfma_f32_32x32x16_bf16 a[112:127], v[36:39], v[60:63], a[112:127]
    ds_read_b64_tr_b16 v[86:87], v10 offset:10240
    s_add_u32 m0, s51, 68608
    s_add_u32 s47, s49, 24576
    buffer_load_dwordx4 v16, s[20:23], s47 offen lds
    v_mfma_f32_32x32x16_bf16 a[128:143], v[40:43], v[48:51], a[128:143]
    ds_read_b64_tr_b16 v[88:89], v11 offset:8192
    v_mfma_f32_32x32x16_bf16 a[144:159], v[40:43], v[52:55], a[144:159]
    ds_read_b64_tr_b16 v[90:91], v11 offset:10240
    s_add_u32 m0, s51, 69632
    s_add_u32 s47, s49, 32768
    buffer_load_dwordx4 v2, s[20:23], s47 offen lds
    v_mfma_f32_32x32x16_bf16 a[160:175], v[40:43], v[56:59], a[160:175]
    ds_read_b64_tr_b16 v[92:93], v12 offset:8192
    v_mfma_f32_32x32x16_bf16 a[176:191], v[40:43], v[60:63], a[176:191]
    ds_read_b64_tr_b16 v[94:95], v12 offset:10240
    s_add_u32 m0, s51, 70656
    s_add_u32 s47, s49, 40960
    buffer_load_dwordx4 v16, s[20:23], s47 offen lds
    v_mfma_f32_32x32x16_bf16 a[192:207], v[44:47], v[48:51], a[192:207]
    v_mfma_f32_32x32x16_bf16 a[208:223], v[44:47], v[52:55], a[208:223]
    s_add_u32 m0, s51, 71680
    s_add_u32 s47, s49, 49152
    buffer_load_dwordx4 v2, s[20:23], s47 offen lds
    v_mfma_f32_32x32x16_bf16 a[224:239], v[44:47], v[56:59], a[224:239]
    v_mfma_f32_32x32x16_bf16 a[240:255], v[44:47], v[60:63], a[240:255]
    s_add_u32 m0, s51, 72704
    s_add_u32 s47, s49, 57344
    buffer_load_dwordx4 v16, s[20:23], s47 offen lds
    s_waitcnt lgkmcnt(0)
    v_mfma_f32_32x32x16_bf16 a[0:15], v[64:67], v[80:83], a[0:15]
    ds_read_b128 v[32:35], v7 offset:0
    v_mfma_f32_32x32x16_bf16 a[16:31], v[64:67], v[84:87], a[16:31]
    ds_read_b128 v[36:39], v7 offset:4096
    s_add_u32 m0, s52, 65536
    s_mov_b32 s48, s50
    buffer_load_dwordx4 v3, s[24:27], s48 offen lds
    v_mfma_f32_32x32x16_bf16 a[32:47], v[64:67], v[88:91], a[32:47]
    ds_read_b128 v[40:43], v7 offset:8192
    v_mfma_f32_32x32x16_bf16 a[48:63], v[64:67], v[92:95], a[48:63]
    ds_read_b128 v[44:47], v7 offset:12288
    s_add_u32 m0, s52, 66560
    s_add_u32 s48, s48, s54
    buffer_load_dwordx4 v4, s[24:27], s48 offen lds
    v_mfma_f32_32x32x16_bf16 a[64:79], v[68:71], v[80:83], a[64:79]
    ds_read_b64_tr_b16 v[48:49], v9 offset:16384
    v_mfma_f32_32x32x16_bf16 a[80:95], v[68:71], v[84:87], a[80:95]
    ds_read_b64_tr_b16 v[50:51], v9 offset:18432
    s_add_u32 m0, s52, 67584
    s_add_u32 s48, s48, s54
    buffer_load_dwordx4 v3, s[24:27], s48 offen lds
    v_mfma_f32_32x32x16_bf16 a[96:111], v[68:71], v[88:91], a[96:111]
    ds_read_b64_tr_b16 v[52:53], v10 offset:16384
    v_mfma_f32_32x32x16_bf16 a[112:127], v[68:71], v[92:95], a[112:127]
    ds_read_b64_tr_b16 v[54:55], v10 offset:18432
    s_add_u32 m0, s52, 68608
    s_add_u32 s48, s48, s54
    buffer_load_dwordx4 v4, s[24:27], s48 offen lds
    v_mfma_f32_32x32x16_bf16 a[128:143], v[72:75], v[80:83], a[128:143]
    ds_read_b64_tr_b16 v[56:57], v11 offset:16384
    v_mfma_f32_32x32x16_bf16 a[144:159], v[72:75], v[84:87], a[144:159]
    ds_read_b64_tr_b16 v[58:59], v11 offset:18432
    s_add_u32 m0, s52, 69632
    s_add_u32 s48, s48, s54
    buffer_load_dwordx4 v3, s[24:27], s48 offen lds
    v_mfma_f32_32x32x16_bf16 a[160:175], v[72:75], v[88:91], a[160:175]
    ds_read_b64_tr_b16 v[60:61], v12 offset:16384
    v_mfma_f32_32x32x16_bf16 a[176:191], v[72:75], v[92:95], a[176:191]
    ds_read_b64_tr_b16 v[62:63], v12 offset:18432
    s_add_u32 m0, s52, 70656
    s_add_u32 s48, s48, s54
    buffer_load_dwordx4 v4, s[24:27], s48 offen lds
    v_mfma_f32_32x32x16_bf16 a[192:207], v[76:79], v[80:83], a[192:207]
    v_mfma_f32_32x32x16_bf16 a[208:223], v[76:79], v[84:87], a[208:223]
    s_add_u32 m0, s52, 71680
    s_add_u32 s48, s48, s54
    buffer_load_dwordx4 v3, s[24:27], s48 offen lds
    v_mfma_f32_32x32x16_bf16 a[224:239], v[76:79], v[88:91], a[224:239]
    v_mfma_f32_32x32x16_bf16 a[240:255], v[76:79], v[92:95], a[240:255]
    s_add_u32 m0, s52, 72704
    s_add_u32 s48, s48, s54
    buffer_load_dwordx4 v4, s[24:27], s48 offen lds
    s_add_u32 s49, s49, 128
    s_lshl_b32 s47, s44, 6
    s_add_u32 s50, s50, s47
    s_waitcnt lgkmcnt(0)
    v_mfma_f32_32x32x16_bf16 a[0:15], v[32:35], v[48:51], a[0:15]
    ds_read_b128 v[64:67], v8 offset:0
    v_mfma_f32_32x32x16_bf16 a[16:31], v[32:35], v[52:55], a[16:31]
    ds_read_b128 v[68:71], v8 offset:4096
    v_mfma_f32_32x32x16_bf16 a[32:47], v[32:35], v[56:59], a[32:47]
    ds_read_b128 v[72:75], v8 offset:8192
    v_mfma_f32_32x32x16_bf16 a[48:63], v[32:35], v[60:63], a[48:63]
    ds_read_b128 v[76:79], v8 offset:12288
    v_mfma_f32_32x32x16_bf16 a[64:79], v[36:39], v[48:51], a[64:79]
    ds_read_b64_tr_b16 v[80:81], v9 offset:24576
    v_mfma_f32_32x32x16_bf16 a[80:95], v[36:39], v[52:55], a[80:95]
    ds_read_b64_tr_b16 v[82:83], v9 offset:26624
    v_mfma_f32_32x32x16_bf16 a[96:111], v[36:39], v[56:59], a[96:111]
    ds_read_b64_tr_b16 v[84:85], v10 offset:24576
    v_mfma_f32_32x32x16_bf16 a[112:127], v[36:39], v[60:63], a[112:127]
    ds_read_b64_tr_b16 v[86:87], v10 offset:26624
    v_mfma_f32_32x32x16_bf16 a[128:143], v[40:43], v[48:51], a[128:143]
    ds_read_b64_tr_b16 v[88:89], v11 offset:24576
    v_mfma_f32_32x32x16_bf16 a[144:159], v[40:43], v[52:55], a[144:159]
    ds_read_b64_tr_b16 v[90:91], v11 offset:26624
    v_mfma_f32_32x32x16_bf16 a[160:175], v[40:43], v[56:59], a[160:175]
    ds_read_b64_tr_b16 v[92:93], v12 offset:24576
    v_mfma_f32_32x32x16_bf16 a[176:191], v[40:43], v[60:63], a[176:191]
    ds_read_b64_tr_b16 v[94:95], v12 offset:26624
    v_mfma_f32_32x32x16_bf16 a[192:207], v[44:47], v[48:51], a[192:207]
    v_mfma_f32_32x32x16_bf16 a[208:223], v[44:47], v[52:55], a[208:223]
    v_mfma_f32_32x32x16_bf16 a[224:239], v[44:47], v[56:59], a[224:239]
    v_mfma_f32_32x32x16_bf16 a[240:255], v[44:47], v[60:63], a[240:255]
    s_waitcnt lgkmcnt(0)
    v_mfma_f32_32x32x16_bf16 a[0:15], v[64:67], v[80:83], a[0:15]
    v_mfma_f32_32x32x16_bf16 a[16:31], v[64:67], v[84:87], a[16:31]
    v_mfma_f32_32x32x16_bf16 a[32:47], v[64:67], v[88:91], a[32:47]
    v_mfma_f32_32x32x16_bf16 a[48:63], v[64:67], v[92:95], a[48:63]
    v_mfma_f32_32x32x16_bf16 a[64:79], v[68:71], v[80:83], a[64:79]
    v_mfma_f32_32x32x16_bf16 a[80:95], v[68:71], v[84:87], a[80:95]
    v_mfma_f32_32x32x16_bf16 a[96:111], v[68:71], v[88:91], a[96:111]
    v_mfma_f32_32x32x16_bf16 a[112:127], v[68:71], v[92:95], a[112:127]
    v_mfma_f32_32x32x16_bf16 a[128:143], v[72:75], v[80:83], a[128:143]
    v_mfma_f32_32x32x16_bf16 a[144:159], v[72:75], v[84:87], a[144:159]
    v_mfma_f32_32x32x16_bf16 a[160:175], v[72:75], v[88:91], a[160:175]
    v_mfma_f32_32x32x16_bf16 a[176:191], v[72:75], v[92:95], a[176:191]
    v_mfma_f32_32x32x16_bf16 a[192:207], v[76:79], v[80:83], a[192:207]
    v_mfma_f32_32x32x16_bf16 a[208:223], v[76:79], v[84:87], a[208:223]
    v_mfma_f32_32x32x16_bf16 a[224:239], v[76:79], v[88:91], a[224:239]
    v_mfma_f32_32x32x16_bf16 a[240:255], v[76:79], v[92:95], a[240:255]
    v_xor_b32 v5, 65536, v5
    v_xor_b32 v6, 65536, v6
    v_xor_b32 v7, 65536, v7
    v_xor_b32 v8, 65536, v8
    v_xor_b32 v9, 65536, v9
    v_xor_b32 v10, 65536, v10
    v_xor_b32 v11, 65536, v11
    v_xor_b32 v12, 65536, v12
    s_waitcnt vmcnt(0)
    s_barrier
    ds_read_b128 v[32:35], v5 offset:0
    ds_read_b128 v[36:39], v5 offset:4096
    ds_read_b128 v[40:43], v5 offset:8192
    ds_read_b128 v[44:47], v5 offset:12288
    ds_read_b64_tr_b16 v[48:49], v9 offset:0
    ds_read_b64_tr_b16 v[50:51], v9 offset:2048
    ds_read_b64_tr_b16 v[52:53], v10 offset:0
    ds_read_b64_tr_b16 v[54:55], v10 offset:2048
    ds_read_b64_tr_b16 v[56:57], v11 offset:0
    ds_read_b64_tr_b16 v[58:59], v11 offset:2048
    ds_read_b64_tr_b16 v[60:61], v12 offset:0
    ds_read_b64_tr_b16 v[62:63], v12 offset:2048
    s_waitcnt lgkmcnt(0)
    v_mfma_f32_32x32x16_bf16 a[0:15], v[32:35], v[48:51], a[0:15]
    ds_read_b128 v[64:67], v6 offset:0
    v_mfma_f32_32x32x16_bf16 a[16:31], v[32:35], v[52:55], a[16:31]
    ds_read_b128 v[68:71], v6 offset:4096
    s_cmp_eq_u32 s46, 3
    s_cbranch_scc1 L_sa_skv_0_1
    s_add_u32 m0, s51, 0
    s_add_u32 s47, s49, 0
    buffer_load_dwordx4 v2, s[20:23], s47 offen lds
L_sa_skv_0_1:
    v_mfma_f32_32x32x16_bf16 a[32:47], v[32:35], v[56:59], a[32:47]
    ds_read_b128 v[72:75], v6 offset:8192
    v_mfma_f32_32x32x16_bf16 a[48:63], v[32:35], v[60:63], a[48:63]
    ds_read_b128 v[76:79], v6 offset:12288
    s_cmp_eq_u32 s46, 3
    s_cbranch_scc1 L_sa_skv_0_3
    s_add_u32 m0, s51, 1024
    s_add_u32 s47, s49, 8192
    buffer_load_dwordx4 v16, s[20:23], s47 offen lds
L_sa_skv_0_3:
    v_mfma_f32_32x32x16_bf16 a[64:79], v[36:39], v[48:51], a[64:79]
    ds_read_b64_tr_b16 v[80:81], v9 offset:8192
    v_mfma_f32_32x32x16_bf16 a[80:95], v[36:39], v[52:55], a[80:95]
    ds_read_b64_tr_b16 v[82:83], v9 offset:10240
    s_cmp_eq_u32 s46, 3
    s_cbranch_scc1 L_sa_skv_0_5
    s_add_u32 m0, s51, 2048
    s_add_u32 s47, s49, 16384
    buffer_load_dwordx4 v2, s[20:23], s47 offen lds
L_sa_skv_0_5:
    v_mfma_f32_32x32x16_bf16 a[96:111], v[36:39], v[56:59], a[96:111]
    ds_read_b64_tr_b16 v[84:85], v10 offset:8192
    v_mfma_f32_32x32x16_bf16 a[112:127], v[36:39], v[60:63], a[112:127]
    ds_read_b64_tr_b16 v[86:87], v10 offset:10240
    s_cmp_eq_u32 s46, 3
    s_cbranch_scc1 L_sa_skv_0_7
    s_add_u32 m0, s51, 3072
    s_add_u32 s47, s49, 24576
    buffer_load_dwordx4 v16, s[20:23], s47 offen lds
L_sa_skv_0_7:
    v_mfma_f32_32x32x16_bf16 a[128:143], v[40:43], v[48:51], a[128:143]
    ds_read_b64_tr_b16 v[88:89], v11 offset:8192
    v_mfma_f32_32x32x16_bf16 a[144:159], v[40:43], v[52:55], a[144:159]
    ds_read_b64_tr_b16 v[90:91], v11 offset:10240
    s_cmp_eq_u32 s46, 3
    s_cbranch_scc1 L_sa_skv_0_9
    s_add_u32 m0, s51, 4096
    s_add_u32 s47, s49, 32768
    buffer_load_dwordx4 v2, s[20:23], s47 offen lds
L_sa_skv_0_9:
    v_mfma_f32_32x32x16_bf16 a[160:175], v[40:43], v[56:59], a[160:175]
    ds_read_b64_tr_b16 v[92:93], v12 offset:8192
    v_mfma_f32_32x32x16_bf16 a[176:191], v[40:43], v[60:63], a[176:191]
    ds_read_b64_tr_b16 v[94:95], v12 offset:10240
    s_cmp_eq_u32 s46, 3
    s_cbranch_scc1 L_sa_skv_0_11
    s_add_u32 m0, s51, 5120
    s_add_u32 s47, s49, 40960
    buffer_load_dwordx4 v16, s[20:23], s47 offen lds
L_sa_skv_0_11:
    v_mfma_f32_32x32x16_bf16 a[192:207], v[44:47], v[48:51], a[192:207]
    v_mfma_f32_32x32x16_bf16 a[208:223], v[44:47], v[52:55], a[208:223]
    s_cmp_eq_u32 s46, 3
    s_cbranch_scc1 L_sa_skv_0_13
    s_add_u32 m0, s51, 6144
    s_add_u32 s47, s49, 49152
    buffer_load_dwordx4 v2, s[20:23], s47 offen lds
L_sa_skv_0_13:
    v_mfma_f32_32x32x16_bf16 a[224:239], v[44:47], v[56:59], a[224:239]
    v_mfma_f32_32x32x16_bf16 a[240:255], v[44:47], v[60:63], a[240:255]
    s_cmp_eq_u32 s46, 3
    s_cbranch_scc1 L_sa_skv_0_15
    s_add_u32 m0, s51, 7168
    s_add_u32 s47, s49, 57344
    buffer_load_dwordx4 v16, s[20:23], s47 offen lds
L_sa_skv_0_15:
    s_waitcnt lgkmcnt(0)
    v_mfma_f32_32x32x16_bf16 a[0:15], v[64:67], v[80:83], a[0:15]
    ds_read_b128 v[32:35], v7 offset:0
    v_mfma_f32_32x32x16_bf16 a[16:31], v[64:67], v[84:87], a[16:31]
    ds_read_b128 v[36:39], v7 offset:4096
    s_cmp_eq_u32 s46, 3
    s_cbranch_scc1 L_sa_skv_1_1
    s_add_u32 m0, s52, 0
    s_mov_b32 s48, s50
    buffer_load_dwordx4 v3, s[24:27], s48 offen lds
L_sa_skv_1_1:
    v_mfma_f32_32x32x16_bf16 a[32:47], v[64:67], v[88:91], a[32:47]
    ds_read_b128 v[40:43], v7 offset:8192
    v_mfma_f32_32x32x16_bf16 a[48:63], v[64:67], v[92:95], a[48:63]
    ds_read_b128 v[44:47], v7 offset:12288
    s_cmp_eq_u32 s46, 3
    s_cbranch_scc1 L_sa_skv_1_3
    s_add_u32 m0, s52, 1024
    s_add_u32 s48, s48, s54
    buffer_load_dwordx4 v4, s[24:27], s48 offen lds
L_sa_skv_1_3:
    v_mfma_f32_32x32x16_bf16 a[64:79], v[68:71], v[80:83], a[64:79]
    ds_read_b64_tr_b16 v[48:49], v9 offset:16384
    v_mfma_f32_32x32x16_bf16 a[80:95], v[68:71], v[84:87], a[80:95]
    ds_read_b64_tr_b16 v[50:51], v9 offset:18432
    s_cmp_eq_u32 s46, 3
    s_cbranch_scc1 L_sa_skv_1_5
    s_add_u32 m0, s52, 2048
    s_add_u32 s48, s48, s54
    buffer_load_dwordx4 v3, s[24:27], s48 offen lds
L_sa_skv_1_5:
    v_mfma_f32_32x32x16_bf16 a[96:111], v[68:71], v[88:91], a[96:111]
    ds_read_b64_tr_b16 v[52:53], v10 offset:16384
    v_mfma_f32_32x32x16_bf16 a[112:127], v[68:71], v[92:95], a[112:127]
    ds_read_b64_tr_b16 v[54:55], v10 offset:18432
    s_cmp_eq_u32 s46, 3
    s_cbranch_scc1 L_sa_skv_1_7
    s_add_u32 m0, s52, 3072
    s_add_u32 s48, s48, s54
    buffer_load_dwordx4 v4, s[24:27], s48 offen lds
L_sa_skv_1_7:
    v_mfma_f32_32x32x16_bf16 a[128:143], v[72:75], v[80:83], a[128:143]
    ds_read_b64_tr_b16 v[56:57], v11 offset:16384
    v_mfma_f32_32x32x16_bf16 a[144:159], v[72:75], v[84:87], a[144:159]
    ds_read_b64_tr_b16 v[58:59], v11 offset:18432
    s_cmp_eq_u32 s46, 3
    s_cbranch_scc1 L_sa_skv_1_9
    s_add_u32 m0, s52, 4096
    s_add_u32 s48, s48, s54
    buffer_load_dwordx4 v3, s[24:27], s48 offen lds
L_sa_skv_1_9:
    v_mfma_f32_32x32x16_bf16 a[160:175], v[72:75], v[88:91], a[160:175]
    ds_read_b64_tr_b16 v[60:61], v12 offset:16384
    v_mfma_f32_32x32x16_bf16 a[176:191], v[72:75], v[92:95], a[176:191]
    ds_read_b64_tr_b16 v[62:63], v12 offset:18432
    s_cmp_eq_u32 s46, 3
    s_cbranch_scc1 L_sa_skv_1_11
    s_add_u32 m0, s52, 5120
    s_add_u32 s48, s48, s54
    buffer_load_dwordx4 v4, s[24:27], s48 offen lds
L_sa_skv_1_11:
    v_mfma_f32_32x32x16_bf16 a[192:207], v[76:79], v[80:83], a[192:207]
    v_mfma_f32_32x32x16_bf16 a[208:223], v[76:79], v[84:87], a[208:223]
    s_cmp_eq_u32 s46, 3
    s_cbranch_scc1 L_sa_skv_1_13
    s_add_u32 m0, s52, 6144
    s_add_u32 s48, s48, s54
    buffer_load_dwordx4 v3, s[24:27], s48 offen lds
L_sa_skv_1_13:
    v_mfma_f32_32x32x16_bf16 a[224:239], v[76:79], v[88:91], a[224:239]
    v_mfma_f32_32x32x16_bf16 a[240:255], v[76:79], v[92:95], a[240:255]
    s_cmp_eq_u32 s46, 3
    s_cbranch_scc1 L_sa_skv_1_15
    s_add_u32 m0, s52, 7168
    s_add_u32 s48, s48, s54
    buffer_load_dwordx4 v4, s[24:27], s48 offen lds
    s_add_u32 s49, s49, 128
    s_lshl_b32 s47, s44, 6
    s_add_u32 s50, s50, s47
L_sa_skv_1_15:
    s_waitcnt lgkmcnt(0)
    v_mfma_f32_32x32x16_bf16 a[0:15], v[32:35], v[48:51], a[0:15]
    ds_read_b128 v[64:67], v8 offset:0
    v_mfma_f32_32x32x16_bf16 a[16:31], v[32:35], v[52:55], a[16:31]
    ds_read_b128 v[68:71], v8 offset:4096
    v_mfma_f32_32x32x16_bf16 a[32:47], v[32:35], v[56:59], a[32:47]
    ds_read_b128 v[72:75], v8 offset:8192
    v_mfma_f32_32x32x16_bf16 a[48:63], v[32:35], v[60:63], a[48:63]
    ds_read_b128 v[76:79], v8 offset:12288
    v_mfma_f32_32x32x16_bf16 a[64:79], v[36:39], v[48:51], a[64:79]
    ds_read_b64_tr_b16 v[80:81], v9 offset:24576
    v_mfma_f32_32x32x16_bf16 a[80:95], v[36:39], v[52:55], a[80:95]
    ds_read_b64_tr_b16 v[82:83], v9 offset:26624
    v_mfma_f32_32x32x16_bf16 a[96:111], v[36:39], v[56:59], a[96:111]
    ds_read_b64_tr_b16 v[84:85], v10 offset:24576
    v_mfma_f32_32x32x16_bf16 a[112:127], v[36:39], v[60:63], a[112:127]
    ds_read_b64_tr_b16 v[86:87], v10 offset:26624
    v_mfma_f32_32x32x16_bf16 a[128:143], v[40:43], v[48:51], a[128:143]
    ds_read_b64_tr_b16 v[88:89], v11 offset:24576
    v_mfma_f32_32x32x16_bf16 a[144:159], v[40:43], v[52:55], a[144:159]
    ds_read_b64_tr_b16 v[90:91], v11 offset:26624
    v_mfma_f32_32x32x16_bf16 a[160:175], v[40:43], v[56:59], a[160:175]
    ds_read_b64_tr_b16 v[92:93], v12 offset:24576
    v_mfma_f32_32x32x16_bf16 a[176:191], v[40:43], v[60:63], a[176:191]
    ds_read_b64_tr_b16 v[94:95], v12 offset:26624
    v_mfma_f32_32x32x16_bf16 a[192:207], v[44:47], v[48:51], a[192:207]
    v_mfma_f32_32x32x16_bf16 a[208:223], v[44:47], v[52:55], a[208:223]
    v_mfma_f32_32x32x16_bf16 a[224:239], v[44:47], v[56:59], a[224:239]
    v_mfma_f32_32x32x16_bf16 a[240:255], v[44:47], v[60:63], a[240:255]
    s_waitcnt lgkmcnt(0)
    v_mfma_f32_32x32x16_bf16 a[0:15], v[64:67], v[80:83], a[0:15]
    v_mfma_f32_32x32x16_bf16 a[16:31], v[64:67], v[84:87], a[16:31]
    v_mfma_f32_32x32x16_bf16 a[32:47], v[64:67], v[88:91], a[32:47]
    v_mfma_f32_32x32x16_bf16 a[48:63], v[64:67], v[92:95], a[48:63]
    v_mfma_f32_32x32x16_bf16 a[64:79], v[68:71], v[80:83], a[64:79]
    v_mfma_f32_32x32x16_bf16 a[80:95], v[68:71], v[84:87], a[80:95]
    v_mfma_f32_32x32x16_bf16 a[96:111], v[68:71], v[88:91], a[96:111]
    v_mfma_f32_32x32x16_bf16 a[112:127], v[68:71], v[92:95], a[112:127]
    v_mfma_f32_32x32x16_bf16 a[128:143], v[72:75], v[80:83], a[128:143]
    v_mfma_f32_32x32x16_bf16 a[144:159], v[72:75], v[84:87], a[144:159]
    v_mfma_f32_32x32x16_bf16 a[160:175], v[72:75], v[88:91], a[160:175]
    v_mfma_f32_32x32x16_bf16 a[176:191], v[72:75], v[92:95], a[176:191]
    v_mfma_f32_32x32x16_bf16 a[192:207], v[76:79], v[80:83], a[192:207]
    v_mfma_f32_32x32x16_bf16 a[208:223], v[76:79], v[84:87], a[208:223]
    v_mfma_f32_32x32x16_bf16 a[224:239], v[76:79], v[88:91], a[224:239]
    v_mfma_f32_32x32x16_bf16 a[240:255], v[76:79], v[92:95], a[240:255]
    v_xor_b32 v5, 65536, v5
    v_xor_b32 v6, 65536, v6
    v_xor_b32 v7, 65536, v7
    v_xor_b32 v8, 65536, v8
    v_xor_b32 v9, 65536, v9
    v_xor_b32 v10, 65536, v10
    v_xor_b32 v11, 65536, v11
    v_xor_b32 v12, 65536, v12
    s_add_u32 s46, s46, 1
    s_cmp_lt_u32 s46, 4
    s_cbranch_scc1 L_sa_kv
L_sa_ep:
    s_nop 15
    s_cmp_eq_u32 s43, 2
    s_cbranch_scc1 L_sa_eh
    v_bfe_u32 v14, v1, 4, 1
    v_lshlrev_b32 v13, 10, v14
    v_lshrrev_b32 v14, 5, v1
    v_lshl_add_u32 v13, v14, 8, v13
    v_and_b32 v14, 15, v1
    v_lshl_add_u32 v13, v14, 4, v13
    s_add_u32 s47, s45, 0
    v_accvgpr_read_b32 v100, a0
    v_accvgpr_read_b32 v101, a1
    v_accvgpr_read_b32 v102, a2
    v_accvgpr_read_b32 v103, a3
    v_accvgpr_read_b32 v104, a8
    v_accvgpr_read_b32 v105, a9
    v_accvgpr_read_b32 v106, a10
    v_accvgpr_read_b32 v107, a11
    v_cvt_pk_bf16_f32 v96, v100, v101
    v_cvt_pk_bf16_f32 v97, v102, v103
    v_cvt_pk_bf16_f32 v98, v104, v105
    v_cvt_pk_bf16_f32 v99, v106, v107
    buffer_store_dwordx4 v[96:99], v13, s[4:7], s47 offen offset:0 sc1
    v_accvgpr_read_b32 v112, a4
    v_accvgpr_read_b32 v113, a5
    v_accvgpr_read_b32 v114, a6
    v_accvgpr_read_b32 v115, a7
    v_accvgpr_read_b32 v116, a12
    v_accvgpr_read_b32 v117, a13
    v_accvgpr_read_b32 v118, a14
    v_accvgpr_read_b32 v119, a15
    v_cvt_pk_bf16_f32 v108, v112, v113
    v_cvt_pk_bf16_f32 v109, v114, v115
    v_cvt_pk_bf16_f32 v110, v116, v117
    v_cvt_pk_bf16_f32 v111, v118, v119
    buffer_store_dwordx4 v[108:111], v13, s[4:7], s47 offen offset:512 sc1
    v_accvgpr_read_b32 v100, a16
    v_accvgpr_read_b32 v101, a17
    v_accvgpr_read_b32 v102, a18
    v_accvgpr_read_b32 v103, a19
    v_accvgpr_read_b32 v104, a24
    v_accvgpr_read_b32 v105, a25
    v_accvgpr_read_b32 v106, a26
    v_accvgpr_read_b32 v107, a27
    v_cvt_pk_bf16_f32 v96, v100, v101
    v_cvt_pk_bf16_f32 v97, v102, v103
    v_cvt_pk_bf16_f32 v98, v104, v105
    v_cvt_pk_bf16_f32 v99, v106, v107
    buffer_store_dwordx4 v[96:99], v13, s[4:7], s47 offen offset:2048 sc1
    v_accvgpr_read_b32 v112, a20
    v_accvgpr_read_b32 v113, a21
    v_accvgpr_read_b32 v114, a22
    v_accvgpr_read_b32 v115, a23
    v_accvgpr_read_b32 v116, a28
    v_accvgpr_read_b32 v117, a29
    v_accvgpr_read_b32 v118, a30
    v_accvgpr_read_b32 v119, a31
    v_cvt_pk_bf16_f32 v108, v112, v113
    v_cvt_pk_bf16_f32 v109, v114, v115
    v_cvt_pk_bf16_f32 v110, v116, v117
    v_cvt_pk_bf16_f32 v111, v118, v119
    buffer_store_dwordx4 v[108:111], v13, s[4:7], s47 offen offset:2560 sc1
    s_add_u32 s47, s45, 4096
    v_accvgpr_read_b32 v100, a32
    v_accvgpr_read_b32 v101, a33
    v_accvgpr_read_b32 v102, a34
    v_accvgpr_read_b32 v103, a35
    v_accvgpr_read_b32 v104, a40
    v_accvgpr_read_b32 v105, a41
    v_accvgpr_read_b32 v106, a42
    v_accvgpr_read_b32 v107, a43
    v_cvt_pk_bf16_f32 v96, v100, v101
    v_cvt_pk_bf16_f32 v97, v102, v103
    v_cvt_pk_bf16_f32 v98, v104, v105
    v_cvt_pk_bf16_f32 v99, v106, v107
    buffer_store_dwordx4 v[96:99], v13, s[4:7], s47 offen offset:0 sc1
    v_accvgpr_read_b32 v112, a36
    v_accvgpr_read_b32 v113, a37
    v_accvgpr_read_b32 v114, a38
    v_accvgpr_read_b32 v115, a39
    v_accvgpr_read_b32 v116, a44
    v_accvgpr_read_b32 v117, a45
    v_accvgpr_read_b32 v118, a46
    v_accvgpr_read_b32 v119, a47
    v_cvt_pk_bf16_f32 v108, v112, v113
    v_cvt_pk_bf16_f32 v109, v114, v115
    v_cvt_pk_bf16_f32 v110, v116, v117
    v_cvt_pk_bf16_f32 v111, v118, v119
    buffer_store_dwordx4 v[108:111], v13, s[4:7], s47 offen offset:512 sc1
    v_accvgpr_read_b32 v100, a48
    v_accvgpr_read_b32 v101, a49
    v_accvgpr_read_b32 v102, a50
    v_accvgpr_read_b32 v103, a51
    v_accvgpr_read_b32 v104, a56
    v_accvgpr_read_b32 v105, a57
    v_accvgpr_read_b32 v106, a58
    v_accvgpr_read_b32 v107, a59
    v_cvt_pk_bf16_f32 v96, v100, v101
    v_cvt_pk_bf16_f32 v97, v102, v103
    v_cvt_pk_bf16_f32 v98, v104, v105
    v_cvt_pk_bf16_f32 v99, v106, v107
    buffer_store_dwordx4 v[96:99], v13, s[4:7], s47 offen offset:2048 sc1
    v_accvgpr_read_b32 v112, a52
    v_accvgpr_read_b32 v113, a53
    v_accvgpr_read_b32 v114, a54
    v_accvgpr_read_b32 v115, a55
    v_accvgpr_read_b32 v116, a60
    v_accvgpr_read_b32 v117, a61
    v_accvgpr_read_b32 v118, a62
    v_accvgpr_read_b32 v119, a63
    v_cvt_pk_bf16_f32 v108, v112, v113
    v_cvt_pk_bf16_f32 v109, v114, v115
    v_cvt_pk_bf16_f32 v110, v116, v117
    v_cvt_pk_bf16_f32 v111, v118, v119
    buffer_store_dwordx4 v[108:111], v13, s[4:7], s47 offen offset:2560 sc1
    s_add_u32 s47, s45, 262144
    v_accvgpr_read_b32 v100, a64
    v_accvgpr_read_b32 v101, a65
    v_accvgpr_read_b32 v102, a66
    v_accvgpr_read_b32 v103, a67
    v_accvgpr_read_b32 v104, a72
    v_accvgpr_read_b32 v105, a73
    v_accvgpr_read_b32 v106, a74
    v_accvgpr_read_b32 v107, a75
    v_cvt_pk_bf16_f32 v96, v100, v101
    v_cvt_pk_bf16_f32 v97, v102, v103
    v_cvt_pk_bf16_f32 v98, v104, v105
    v_cvt_pk_bf16_f32 v99, v106, v107
    buffer_store_dwordx4 v[96:99], v13, s[4:7], s47 offen offset:0 sc1
    v_accvgpr_read_b32 v112, a68
    v_accvgpr_read_b32 v113, a69
    v_accvgpr_read_b32 v114, a70
    v_accvgpr_read_b32 v115, a71
    v_accvgpr_read_b32 v116, a76
    v_accvgpr_read_b32 v117, a77
    v_accvgpr_read_b32 v118, a78
    v_accvgpr_read_b32 v119, a79
    v_cvt_pk_bf16_f32 v108, v112, v113
    v_cvt_pk_bf16_f32 v109, v114, v115
    v_cvt_pk_bf16_f32 v110, v116, v117
    v_cvt_pk_bf16_f32 v111, v118, v119
    buffer_store_dwordx4 v[108:111], v13, s[4:7], s47 offen offset:512 sc1
    v_accvgpr_read_b32 v100, a80
    v_accvgpr_read_b32 v101, a81
    v_accvgpr_read_b32 v102, a82
    v_accvgpr_read_b32 v103, a83
    v_accvgpr_read_b32 v104, a88
    v_accvgpr_read_b32 v105, a89
    v_accvgpr_read_b32 v106, a90
    v_accvgpr_read_b32 v107, a91
    v_cvt_pk_bf16_f32 v96, v100, v101
    v_cvt_pk_bf16_f32 v97, v102, v103
    v_cvt_pk_bf16_f32 v98, v104, v105
    v_cvt_pk_bf16_f32 v99, v106, v107
    buffer_store_dwordx4 v[96:99], v13, s[4:7], s47 offen offset:2048 sc1
    v_accvgpr_read_b32 v112, a84
    v_accvgpr_read_b32 v113, a85
    v_accvgpr_read_b32 v114, a86
    v_accvgpr_read_b32 v115, a87
    v_accvgpr_read_b32 v116, a92
    v_accvgpr_read_b32 v117, a93
    v_accvgpr_read_b32 v118, a94
    v_accvgpr_read_b32 v119, a95
    v_cvt_pk_bf16_f32 v108, v112, v113
    v_cvt_pk_bf16_f32 v109, v114, v115
    v_cvt_pk_bf16_f32 v110, v116, v117
    v_cvt_pk_bf16_f32 v111, v118, v119
    buffer_store_dwordx4 v[108:111], v13, s[4:7], s47 offen offset:2560 sc1
    s_add_u32 s47, s45, 266240
    v_accvgpr_read_b32 v100, a96
    v_accvgpr_read_b32 v101, a97
    v_accvgpr_read_b32 v102, a98
    v_accvgpr_read_b32 v103, a99
    v_accvgpr_read_b32 v104, a104
    v_accvgpr_read_b32 v105, a105
    v_accvgpr_read_b32 v106, a106
    v_accvgpr_read_b32 v107, a107
    v_cvt_pk_bf16_f32 v96, v100, v101
    v_cvt_pk_bf16_f32 v97, v102, v103
    v_cvt_pk_bf16_f32 v98, v104, v105
    v_cvt_pk_bf16_f32 v99, v106, v107
    buffer_store_dwordx4 v[96:99], v13, s[4:7], s47 offen offset:0 sc1
    v_accvgpr_read_b32 v112, a100
    v_accvgpr_read_b32 v113, a101
    v_accvgpr_read_b32 v114, a102
    v_accvgpr_read_b32 v115, a103
    v_accvgpr_read_b32 v116, a108
    v_accvgpr_read_b32 v117, a109
    v_accvgpr_read_b32 v118, a110
    v_accvgpr_read_b32 v119, a111
    v_cvt_pk_bf16_f32 v108, v112, v113
    v_cvt_pk_bf16_f32 v109, v114, v115
    v_cvt_pk_bf16_f32 v110, v116, v117
    v_cvt_pk_bf16_f32 v111, v118, v119
    buffer_store_dwordx4 v[108:111], v13, s[4:7], s47 offen offset:512 sc1
    v_accvgpr_read_b32 v100, a112
    v_accvgpr_read_b32 v101, a113
    v_accvgpr_read_b32 v102, a114
    v_accvgpr_read_b32 v103, a115
    v_accvgpr_read_b32 v104, a120
    v_accvgpr_read_b32 v105, a121
    v_accvgpr_read_b32 v106, a122
    v_accvgpr_read_b32 v107, a123
    v_cvt_pk_bf16_f32 v96, v100, v101
    v_cvt_pk_bf16_f32 v97, v102, v103
    v_cvt_pk_bf16_f32 v98, v104, v105
    v_cvt_pk_bf16_f32 v99, v106, v107
    buffer_store_dwordx4 v[96:99], v13, s[4:7], s47 offen offset:2048 sc1
    v_accvgpr_read_b32 v112, a116
    v_accvgpr_read_b32 v113, a117
    v_accvgpr_read_b32 v114, a118
    v_accvgpr_read_b32 v115, a119
    v_accvgpr_read_b32 v116, a124
    v_accvgpr_read_b32 v117, a125
    v_accvgpr_read_b32 v118, a126
    v_accvgpr_read_b32 v119, a127
    v_cvt_pk_bf16_f32 v108, v112, v113
    v_cvt_pk_bf16_f32 v109, v114, v115
    v_cvt_pk_bf16_f32 v110, v116, v117
    v_cvt_pk_bf16_f32 v111, v118, v119
    buffer_store_dwordx4 v[108:111], v13, s[4:7], s47 offen offset:2560 sc1
    s_add_u32 s47, s45, 524288
    v_accvgpr_read_b32 v100, a128
    v_accvgpr_read_b32 v101, a129
    v_accvgpr_read_b32 v102, a130
    v_accvgpr_read_b32 v103, a131
    v_accvgpr_read_b32 v104, a136
    v_accvgpr_read_b32 v105, a137
    v_accvgpr_read_b32 v106, a138
    v_accvgpr_read_b32 v107, a139
    v_cvt_pk_bf16_f32 v96, v100, v101
    v_cvt_pk_bf16_f32 v97, v102, v103
    v_cvt_pk_bf16_f32 v98, v104, v105
    v_cvt_pk_bf16_f32 v99, v106, v107
    buffer_store_dwordx4 v[96:99], v13, s[4:7], s47 offen offset:0 sc1
    v_accvgpr_read_b32 v112, a132
    v_accvgpr_read_b32 v113, a133
    v_accvgpr_read_b32 v114, a134
    v_accvgpr_read_b32 v115, a135
    v_accvgpr_read_b32 v116, a140
    v_accvgpr_read_b32 v117, a141
    v_accvgpr_read_b32 v118, a142
    v_accvgpr_read_b32 v119, a143
    v_cvt_pk_bf16_f32 v108, v112, v113
    v_cvt_pk_bf16_f32 v109, v114, v115
    v_cvt_pk_bf16_f32 v110, v116, v117
    v_cvt_pk_bf16_f32 v111, v118, v119
    buffer_store_dwordx4 v[108:111], v13, s[4:7], s47 offen offset:512 sc1
    v_accvgpr_read_b32 v100, a144
    v_accvgpr_read_b32 v101, a145
    v_accvgpr_read_b32 v102, a146
    v_accvgpr_read_b32 v103, a147
    v_accvgpr_read_b32 v104, a152
    v_accvgpr_read_b32 v105, a153
    v_accvgpr_read_b32 v106, a154
    v_accvgpr_read_b32 v107, a155
    v_cvt_pk_bf16_f32 v96, v100, v101
    v_cvt_pk_bf16_f32 v97, v102, v103
    v_cvt_pk_bf16_f32 v98, v104, v105
    v_cvt_pk_bf16_f32 v99, v106, v107
    buffer_store_dwordx4 v[96:99], v13, s[4:7], s47 offen offset:2048 sc1
    v_accvgpr_read_b32 v112, a148
    v_accvgpr_read_b32 v113, a149
    v_accvgpr_read_b32 v114, a150
    v_accvgpr_read_b32 v115, a151
    v_accvgpr_read_b32 v116, a156
    v_accvgpr_read_b32 v117, a157
    v_accvgpr_read_b32 v118, a158
    v_accvgpr_read_b32 v119, a159
    v_cvt_pk_bf16_f32 v108, v112, v113
    v_cvt_pk_bf16_f32 v109, v114, v115
    v_cvt_pk_bf16_f32 v110, v116, v117
    v_cvt_pk_bf16_f32 v111, v118, v119
    buffer_store_dwordx4 v[108:111], v13, s[4:7], s47 offen offset:2560 sc1
    s_add_u32 s47, s45, 528384
    v_accvgpr_read_b32 v100, a160
    v_accvgpr_read_b32 v101, a161
    v_accvgpr_read_b32 v102, a162
    v_accvgpr_read_b32 v103, a163
    v_accvgpr_read_b32 v104, a168
    v_accvgpr_read_b32 v105, a169
    v_accvgpr_read_b32 v106, a170
    v_accvgpr_read_b32 v107, a171
    v_cvt_pk_bf16_f32 v96, v100, v101
    v_cvt_pk_bf16_f32 v97, v102, v103
    v_cvt_pk_bf16_f32 v98, v104, v105
    v_cvt_pk_bf16_f32 v99, v106, v107
    buffer_store_dwordx4 v[96:99], v13, s[4:7], s47 offen offset:0 sc1
    v_accvgpr_read_b32 v112, a164
    v_accvgpr_read_b32 v113, a165
    v_accvgpr_read_b32 v114, a166
    v_accvgpr_read_b32 v115, a167
    v_accvgpr_read_b32 v116, a172
    v_accvgpr_read_b32 v117, a173
    v_accvgpr_read_b32 v118, a174
    v_accvgpr_read_b32 v119, a175
    v_cvt_pk_bf16_f32 v108, v112, v113
    v_cvt_pk_bf16_f32 v109, v114, v115
    v_cvt_pk_bf16_f32 v110, v116, v117
    v_cvt_pk_bf16_f32 v111, v118, v119
    buffer_store_dwordx4 v[108:111], v13, s[4:7], s47 offen offset:512 sc1
    v_accvgpr_read_b32 v100, a176
    v_accvgpr_read_b32 v101, a177
    v_accvgpr_read_b32 v102, a178
    v_accvgpr_read_b32 v103, a179
    v_accvgpr_read_b32 v104, a184
    v_accvgpr_read_b32 v105, a185
    v_accvgpr_read_b32 v106, a186
    v_accvgpr_read_b32 v107, a187
    v_cvt_pk_bf16_f32 v96, v100, v101
    v_cvt_pk_bf16_f32 v97, v102, v103
    v_cvt_pk_bf16_f32 v98, v104, v105
    v_cvt_pk_bf16_f32 v99, v106, v107
    buffer_store_dwordx4 v[96:99], v13, s[4:7], s47 offen offset:2048 sc1
    v_accvgpr_read_b32 v112, a180
    v_accvgpr_read_b32 v113, a181
    v_accvgpr_read_b32 v114, a182
    v_accvgpr_read_b32 v115, a183
    v_accvgpr_read_b32 v116, a188
    v_accvgpr_read_b32 v117, a189
    v_accvgpr_read_b32 v118, a190
    v_accvgpr_read_b32 v119, a191
    v_cvt_pk_bf16_f32 v108, v112, v113
    v_cvt_pk_bf16_f32 v109, v114, v115
    v_cvt_pk_bf16_f32 v110, v116, v117
    v_cvt_pk_bf16_f32 v111, v118, v119
    buffer_store_dwordx4 v[108:111], v13, s[4:7], s47 offen offset:2560 sc1
    s_add_u32 s47, s45, 786432
    v_accvgpr_read_b32 v100, a192
    v_accvgpr_read_b32 v101, a193
    v_accvgpr_read_b32 v102, a194
    v_accvgpr_read_b32 v103, a195
    v_accvgpr_read_b32 v104, a200
    v_accvgpr_read_b32 v105, a201
    v_accvgpr_read_b32 v106, a202
    v_accvgpr_read_b32 v107, a203
    v_cvt_pk_bf16_f32 v96, v100, v101
    v_cvt_pk_bf16_f32 v97, v102, v103
    v_cvt_pk_bf16_f32 v98, v104, v105
    v_cvt_pk_bf16_f32 v99, v106, v107
    buffer_store_dwordx4 v[96:99], v13, s[4:7], s47 offen offset:0 sc1
    v_accvgpr_read_b32 v112, a196
    v_accvgpr_read_b32 v113, a197
    v_accvgpr_read_b32 v114, a198
    v_accvgpr_read_b32 v115, a199
    v_accvgpr_read_b32 v116, a204
    v_accvgpr_read_b32 v117, a205
    v_accvgpr_read_b32 v118, a206
    v_accvgpr_read_b32 v119, a207
    v_cvt_pk_bf16_f32 v108, v112, v113
    v_cvt_pk_bf16_f32 v109, v114, v115
    v_cvt_pk_bf16_f32 v110, v116, v117
    v_cvt_pk_bf16_f32 v111, v118, v119
    buffer_store_dwordx4 v[108:111], v13, s[4:7], s47 offen offset:512 sc1
    v_accvgpr_read_b32 v100, a208
    v_accvgpr_read_b32 v101, a209
    v_accvgpr_read_b32 v102, a210
    v_accvgpr_read_b32 v103, a211
    v_accvgpr_read_b32 v104, a216
    v_accvgpr_read_b32 v105, a217
    v_accvgpr_read_b32 v106, a218
    v_accvgpr_read_b32 v107, a219
    v_cvt_pk_bf16_f32 v96, v100, v101
    v_cvt_pk_bf16_f32 v97, v102, v103
    v_cvt_pk_bf16_f32 v98, v104, v105
    v_cvt_pk_bf16_f32 v99, v106, v107
    buffer_store_dwordx4 v[96:99], v13, s[4:7], s47 offen offset:2048 sc1
    v_accvgpr_read_b32 v112, a212
    v_accvgpr_read_b32 v113, a213
    v_accvgpr_read_b32 v114, a214
    v_accvgpr_read_b32 v115, a215
    v_accvgpr_read_b32 v116, a220
    v_accvgpr_read_b32 v117, a221
    v_accvgpr_read_b32 v118, a222
    v_accvgpr_read_b32 v119, a223
    v_cvt_pk_bf16_f32 v108, v112, v113
    v_cvt_pk_bf16_f32 v109, v114, v115
    v_cvt_pk_bf16_f32 v110, v116, v117
    v_cvt_pk_bf16_f32 v111, v118, v119
    buffer_store_dwordx4 v[108:111], v13, s[4:7], s47 offen offset:2560 sc1
    s_add_u32 s47, s45, 790528
    v_accvgpr_read_b32 v100, a224
    v_accvgpr_read_b32 v101, a225
    v_accvgpr_read_b32 v102, a226
    v_accvgpr_read_b32 v103, a227
    v_accvgpr_read_b32 v104, a232
    v_accvgpr_read_b32 v105, a233
    v_accvgpr_read_b32 v106, a234
    v_accvgpr_read_b32 v107, a235
    v_cvt_pk_bf16_f32 v96, v100, v101
    v_cvt_pk_bf16_f32 v97, v102, v103
    v_cvt_pk_bf16_f32 v98, v104, v105
    v_cvt_pk_bf16_f32 v99, v106, v107
    buffer_store_dwordx4 v[96:99], v13, s[4:7], s47 offen offset:0 sc1
    v_accvgpr_read_b32 v112, a228
    v_accvgpr_read_b32 v113, a229
    v_accvgpr_read_b32 v114, a230
    v_accvgpr_read_b32 v115, a231
    v_accvgpr_read_b32 v116, a236
    v_accvgpr_read_b32 v117, a237
    v_accvgpr_read_b32 v118, a238
    v_accvgpr_read_b32 v119, a239
    v_cvt_pk_bf16_f32 v108, v112, v113
    v_cvt_pk_bf16_f32 v109, v114, v115
    v_cvt_pk_bf16_f32 v110, v116, v117
    v_cvt_pk_bf16_f32 v111, v118, v119
    buffer_store_dwordx4 v[108:111], v13, s[4:7], s47 offen offset:512 sc1
    v_accvgpr_read_b32 v100, a240
    v_accvgpr_read_b32 v101, a241
    v_accvgpr_read_b32 v102, a242
    v_accvgpr_read_b32 v103, a243
    v_accvgpr_read_b32 v104, a248
    v_accvgpr_read_b32 v105, a249
    v_accvgpr_read_b32 v106, a250
    v_accvgpr_read_b32 v107, a251
    v_cvt_pk_bf16_f32 v96, v100, v101
    v_cvt_pk_bf16_f32 v97, v102, v103
    v_cvt_pk_bf16_f32 v98, v104, v105
    v_cvt_pk_bf16_f32 v99, v106, v107
    buffer_store_dwordx4 v[96:99], v13, s[4:7], s47 offen offset:2048 sc1
    v_accvgpr_read_b32 v112, a244
    v_accvgpr_read_b32 v113, a245
    v_accvgpr_read_b32 v114, a246
    v_accvgpr_read_b32 v115, a247
    v_accvgpr_read_b32 v116, a252
    v_accvgpr_read_b32 v117, a253
    v_accvgpr_read_b32 v118, a254
    v_accvgpr_read_b32 v119, a255
    v_cvt_pk_bf16_f32 v108, v112, v113
    v_cvt_pk_bf16_f32 v109, v114, v115
    v_cvt_pk_bf16_f32 v110, v116, v117
    v_cvt_pk_bf16_f32 v111, v118, v119
    buffer_store_dwordx4 v[108:111], v13, s[4:7], s47 offen offset:2560 sc1
    s_branch L_sa_done
L_sa_eh:
    v_lshrrev_b32 v14, 5, v1
    v_lshlrev_b32 v14, 3, v14
    s_lshl_b32 s47, s42, 9
    s_and_b32 s48, s16, 1
    s_lshl_b32 s48, s48, 8
    s_add_u32 s47, s47, s48
    v_lshlrev_b32 v13, 4, v1
    buffer_load_dwordx2 v[192:193], v14, s[28:31], s47 offen offset:0
    buffer_load_dwordx2 v[194:195], v14, s[28:31], s47 offen offset:16
    buffer_load_dwordx2 v[196:197], v14, s[28:31], s47 offen offset:32
    buffer_load_dwordx2 v[198:199], v14, s[28:31], s47 offen offset:48
    buffer_load_dwordx2 v[200:201], v14, s[28:31], s47 offen offset:64
    buffer_load_dwordx2 v[202:203], v14, s[28:31], s47 offen offset:80
    buffer_load_dwordx2 v[204:205], v14, s[28:31], s47 offen offset:96
    buffer_load_dwordx2 v[206:207], v14, s[28:31], s47 offen offset:112
    buffer_load_dwordx2 v[208:209], v14, s[28:31], s47 offen offset:128
    buffer_load_dwordx2 v[210:211], v14, s[28:31], s47 offen offset:144
    buffer_load_dwordx2 v[212:213], v14, s[28:31], s47 offen offset:160
    buffer_load_dwordx2 v[214:215], v14, s[28:31], s47 offen offset:176
    buffer_load_dwordx2 v[216:217], v14, s[28:31], s47 offen offset:192
    buffer_load_dwordx2 v[218:219], v14, s[28:31], s47 offen offset:208
    buffer_load_dwordx2 v[220:221], v14, s[28:31], s47 offen offset:224
    buffer_load_dwordx2 v[222:223], v14, s[28:31], s47 offen offset:240
    s_waitcnt vmcnt(0)
    v_lshlrev_b32 v128, 16, v192
    v_and_b32 v129, 0xffff0000, v192
    v_lshlrev_b32 v130, 16, v193
    v_and_b32 v131, 0xffff0000, v193
    v_lshlrev_b32 v132, 16, v194
    v_and_b32 v133, 0xffff0000, v194
    v_lshlrev_b32 v134, 16, v195
    v_and_b32 v135, 0xffff0000, v195
    v_lshlrev_b32 v136, 16, v196
    v_and_b32 v137, 0xffff0000, v196
    v_lshlrev_b32 v138, 16, v197
    v_and_b32 v139, 0xffff0000, v197
    v_lshlrev_b32 v140, 16, v198
    v_and_b32 v141, 0xffff0000, v198
    v_lshlrev_b32 v142, 16, v199
    v_and_b32 v143, 0xffff0000, v199
    v_lshlrev_b32 v144, 16, v200
    v_and_b32 v145, 0xffff0000, v200
    v_lshlrev_b32 v146, 16, v201
    v_and_b32 v147, 0xffff0000, v201
    v_lshlrev_b32 v148, 16, v202
    v_and_b32 v149, 0xffff0000, v202
    v_lshlrev_b32 v150, 16, v203
    v_and_b32 v151, 0xffff0000, v203
    v_lshlrev_b32 v152, 16, v204
    v_and_b32 v153, 0xffff0000, v204
    v_lshlrev_b32 v154, 16, v205
    v_and_b32 v155, 0xffff0000, v205
    v_lshlrev_b32 v156, 16, v206
    v_and_b32 v157, 0xffff0000, v206
    v_lshlrev_b32 v158, 16, v207
    v_and_b32 v159, 0xffff0000, v207
    v_lshlrev_b32 v160, 16, v208
    v_and_b32 v161, 0xffff0000, v208
    v_lshlrev_b32 v162, 16, v209
    v_and_b32 v163, 0xffff0000, v209
    v_lshlrev_b32 v164, 16, v210
    v_and_b32 v165, 0xffff0000, v210
    v_lshlrev_b32 v166, 16, v211
    v_and_b32 v167, 0xffff0000, v211
    v_lshlrev_b32 v168, 16, v212
    v_and_b32 v169, 0xffff0000, v212
    v_lshlrev_b32 v170, 16, v213
    v_and_b32 v171, 0xffff0000, v213
    v_lshlrev_b32 v172, 16, v214
    v_and_b32 v173, 0xffff0000, v214
    v_lshlrev_b32 v174, 16, v215
    v_and_b32 v175, 0xffff0000, v215
    v_lshlrev_b32 v176, 16, v216
    v_and_b32 v177, 0xffff0000, v216
    v_lshlrev_b32 v178, 16, v217
    v_and_b32 v179, 0xffff0000, v217
    v_lshlrev_b32 v180, 16, v218
    v_and_b32 v181, 0xffff0000, v218
    v_lshlrev_b32 v182, 16, v219
    v_and_b32 v183, 0xffff0000, v219
    v_lshlrev_b32 v184, 16, v220
    v_and_b32 v185, 0xffff0000, v220
    v_lshlrev_b32 v186, 16, v221
    v_and_b32 v187, 0xffff0000, v221
    v_lshlrev_b32 v188, 16, v222
    v_and_b32 v189, 0xffff0000, v222
    v_lshlrev_b32 v190, 16, v223
    v_and_b32 v191, 0xffff0000, v223
    s_add_u32 s47, s45, 0
    v_accvgpr_read_b32 v100, a0
    v_accvgpr_read_b32 v101, a1
    v_accvgpr_read_b32 v102, a2
    v_accvgpr_read_b32 v103, a3
    v_accvgpr_read_b32 v104, a8
    v_accvgpr_read_b32 v105, a9
    v_accvgpr_read_b32 v106, a10
    v_accvgpr_read_b32 v107, a11
    v_cvt_pk_bf16_f32 v96, v100, v101
    v_cvt_pk_bf16_f32 v97, v102, v103
    v_cvt_pk_bf16_f32 v98, v104, v105
    v_cvt_pk_bf16_f32 v99, v106, v107
    v_lshlrev_b32 v100, 16, v96
    v_and_b32 v101, 0xffff0000, v96
    v_lshlrev_b32 v102, 16, v97
    v_and_b32 v103, 0xffff0000, v97
    v_lshlrev_b32 v104, 16, v98
    v_and_b32 v105, 0xffff0000, v98
    v_lshlrev_b32 v106, 16, v99
    v_and_b32 v107, 0xffff0000, v99
    v_add_f32 v100, v100, v128
    v_add_f32 v101, v101, v129
    v_add_f32 v102, v102, v130
    v_add_f32 v103, v103, v131
    v_add_f32 v104, v104, v136
    v_add_f32 v105, v105, v137
    v_add_f32 v106, v106, v138
    v_add_f32 v107, v107, v139
    v_cvt_pk_bf16_f32 v96, v100, v101
    v_cvt_pk_bf16_f32 v97, v102, v103
    v_cvt_pk_bf16_f32 v98, v104, v105
    v_cvt_pk_bf16_f32 v99, v106, v107
    v_lshlrev_b32 v100, 16, v96
    v_and_b32 v101, 0xffff0000, v96
    v_lshlrev_b32 v102, 16, v97
    v_and_b32 v103, 0xffff0000, v97
    v_lshlrev_b32 v104, 16, v98
    v_and_b32 v105, 0xffff0000, v98
    v_lshlrev_b32 v106, 16, v99
    v_and_b32 v107, 0xffff0000, v99
    v_max_f32 v100, 0, v100
    v_max_f32 v101, 0, v101
    v_max_f32 v102, 0, v102
    v_max_f32 v103, 0, v103
    v_max_f32 v104, 0, v104
    v_max_f32 v105, 0, v105
    v_max_f32 v106, 0, v106
    v_max_f32 v107, 0, v107
    v_mul_f32 v100, v100, v100
    v_mul_f32 v101, v101, v101
    v_mul_f32 v102, v102, v102
    v_mul_f32 v103, v103, v103
    v_mul_f32 v104, v104, v104
    v_mul_f32 v105, v105, v105
    v_mul_f32 v106, v106, v106
    v_mul_f32 v107, v107, v107
    v_cvt_pk_bf16_f32 v96, v100, v101
    v_cvt_pk_bf16_f32 v97, v102, v103
    v_cvt_pk_bf16_f32 v98, v104, v105
    v_cvt_pk_bf16_f32 v99, v106, v107
    buffer_store_dwordx4 v[96:99], v13, s[4:7], s47 offen offset:0 sc1
    v_accvgpr_read_b32 v112, a4
    v_accvgpr_read_b32 v113, a5
    v_accvgpr_read_b32 v114, a6
    v_accvgpr_read_b32 v115, a7
    v_accvgpr_read_b32 v116, a12
    v_accvgpr_read_b32 v117, a13
    v_accvgpr_read_b32 v118, a14
    v_accvgpr_read_b32 v119, a15
    v_cvt_pk_bf16_f32 v108, v112, v113
    v_cvt_pk_bf16_f32 v109, v114, v115
    v_cvt_pk_bf16_f32 v110, v116, v117
    v_cvt_pk_bf16_f32 v111, v118, v119
    v_lshlrev_b32 v112, 16, v108
    v_and_b32 v113, 0xffff0000, v108
    v_lshlrev_b32 v114, 16, v109
    v_and_b32 v115, 0xffff0000, v109
    v_lshlrev_b32 v116, 16, v110
    v_and_b32 v117, 0xffff0000, v110
    v_lshlrev_b32 v118, 16, v111
    v_and_b32 v119, 0xffff0000, v111
    v_add_f32 v112, v112, v132
    v_add_f32 v113, v113, v133
    v_add_f32 v114, v114, v134
    v_add_f32 v115, v115, v135
    v_add_f32 v116, v116, v140
    v_add_f32 v117, v117, v141
    v_add_f32 v118, v118, v142
    v_add_f32 v119, v119, v143
    v_cvt_pk_bf16_f32 v108, v112, v113
    v_cvt_pk_bf16_f32 v109, v114, v115
    v_cvt_pk_bf16_f32 v110, v116, v117
    v_cvt_pk_bf16_f32 v111, v118, v119
    v_lshlrev_b32 v112, 16, v108
    v_and_b32 v113, 0xffff0000, v108
    v_lshlrev_b32 v114, 16, v109
    v_and_b32 v115, 0xffff0000, v109
    v_lshlrev_b32 v116, 16, v110
    v_and_b32 v117, 0xffff0000, v110
    v_lshlrev_b32 v118, 16, v111
    v_and_b32 v119, 0xffff0000, v111
    v_max_f32 v112, 0, v112
    v_max_f32 v113, 0, v113
    v_max_f32 v114, 0, v114
    v_max_f32 v115, 0, v115
    v_max_f32 v116, 0, v116
    v_max_f32 v117, 0, v117
    v_max_f32 v118, 0, v118
    v_max_f32 v119, 0, v119
    v_mul_f32 v112, v112, v112
    v_mul_f32 v113, v113, v113
    v_mul_f32 v114, v114, v114
    v_mul_f32 v115, v115, v115
    v_mul_f32 v116, v116, v116
    v_mul_f32 v117, v117, v117
    v_mul_f32 v118, v118, v118
    v_mul_f32 v119, v119, v119
    v_cvt_pk_bf16_f32 v108, v112, v113
    v_cvt_pk_bf16_f32 v109, v114, v115
    v_cvt_pk_bf16_f32 v110, v116, v117
    v_cvt_pk_bf16_f32 v111, v118, v119
    buffer_store_dwordx4 v[108:111], v13, s[4:7], s47 offen offset:1024 sc1
    v_accvgpr_read_b32 v100, a16
    v_accvgpr_read_b32 v101, a17
    v_accvgpr_read_b32 v102, a18
    v_accvgpr_read_b32 v103, a19
    v_accvgpr_read_b32 v104, a24
    v_accvgpr_read_b32 v105, a25
    v_accvgpr_read_b32 v106, a26
    v_accvgpr_read_b32 v107, a27
    v_cvt_pk_bf16_f32 v96, v100, v101
    v_cvt_pk_bf16_f32 v97, v102, v103
    v_cvt_pk_bf16_f32 v98, v104, v105
    v_cvt_pk_bf16_f32 v99, v106, v107
    v_lshlrev_b32 v100, 16, v96
    v_and_b32 v101, 0xffff0000, v96
    v_lshlrev_b32 v102, 16, v97
    v_and_b32 v103, 0xffff0000, v97
    v_lshlrev_b32 v104, 16, v98
    v_and_b32 v105, 0xffff0000, v98
    v_lshlrev_b32 v106, 16, v99
    v_and_b32 v107, 0xffff0000, v99
    v_add_f32 v100, v100, v144
    v_add_f32 v101, v101, v145
    v_add_f32 v102, v102, v146
    v_add_f32 v103, v103, v147
    v_add_f32 v104, v104, v152
    v_add_f32 v105, v105, v153
    v_add_f32 v106, v106, v154
    v_add_f32 v107, v107, v155
    v_cvt_pk_bf16_f32 v96, v100, v101
    v_cvt_pk_bf16_f32 v97, v102, v103
    v_cvt_pk_bf16_f32 v98, v104, v105
    v_cvt_pk_bf16_f32 v99, v106, v107
    v_lshlrev_b32 v100, 16, v96
    v_and_b32 v101, 0xffff0000, v96
    v_lshlrev_b32 v102, 16, v97
    v_and_b32 v103, 0xffff0000, v97
    v_lshlrev_b32 v104, 16, v98
    v_and_b32 v105, 0xffff0000, v98
    v_lshlrev_b32 v106, 16, v99
    v_and_b32 v107, 0xffff0000, v99
    v_max_f32 v100, 0, v100
    v_max_f32 v101, 0, v101
    v_max_f32 v102, 0, v102
    v_max_f32 v103, 0, v103
    v_max_f32 v104, 0, v104
    v_max_f32 v105, 0, v105
    v_max_f32 v106, 0, v106
    v_max_f32 v107, 0, v107
    v_mul_f32 v100, v100, v100
    v_mul_f32 v101, v101, v101
    v_mul_f32 v102, v102, v102
    v_mul_f32 v103, v103, v103
    v_mul_f32 v104, v104, v104
    v_mul_f32 v105, v105, v105
    v_mul_f32 v106, v106, v106
    v_mul_f32 v107, v107, v107
    v_cvt_pk_bf16_f32 v96, v100, v101
    v_cvt_pk_bf16_f32 v97, v102, v103
    v_cvt_pk_bf16_f32 v98, v104, v105
    v_cvt_pk_bf16_f32 v99, v106, v107
    buffer_store_dwordx4 v[96:99], v13, s[4:7], s47 offen offset:2048 sc1
    v_accvgpr_read_b32 v112, a20
    v_accvgpr_read_b32 v113, a21
    v_accvgpr_read_b32 v114, a22
    v_accvgpr_read_b32 v115, a23
    v_accvgpr_read_b32 v116, a28
    v_accvgpr_read_b32 v117, a29
    v_accvgpr_read_b32 v118, a30
    v_accvgpr_read_b32 v119, a31
    v_cvt_pk_bf16_f32 v108, v112, v113
    v_cvt_pk_bf16_f32 v109, v114, v115
    v_cvt_pk_bf16_f32 v110, v116, v117
    v_cvt_pk_bf16_f32 v111, v118, v119
    v_lshlrev_b32 v112, 16, v108
    v_and_b32 v113, 0xffff0000, v108
    v_lshlrev_b32 v114, 16, v109
    v_and_b32 v115, 0xffff0000, v109
    v_lshlrev_b32 v116, 16, v110
    v_and_b32 v117, 0xffff0000, v110
    v_lshlrev_b32 v118, 16, v111
    v_and_b32 v119, 0xffff0000, v111
    v_add_f32 v112, v112, v148
    v_add_f32 v113, v113, v149
    v_add_f32 v114, v114, v150
    v_add_f32 v115, v115, v151
    v_add_f32 v116, v116, v156
    v_add_f32 v117, v117, v157
    v_add_f32 v118, v118, v158
    v_add_f32 v119, v119, v159
    v_cvt_pk_bf16_f32 v108, v112, v113
    v_cvt_pk_bf16_f32 v109, v114, v115
    v_cvt_pk_bf16_f32 v110, v116, v117
    v_cvt_pk_bf16_f32 v111, v118, v119
    v_lshlrev_b32 v112, 16, v108
    v_and_b32 v113, 0xffff0000, v108
    v_lshlrev_b32 v114, 16, v109
    v_and_b32 v115, 0xffff0000, v109
    v_lshlrev_b32 v116, 16, v110
    v_and_b32 v117, 0xffff0000, v110
    v_lshlrev_b32 v118, 16, v111
    v_and_b32 v119, 0xffff0000, v111
    v_max_f32 v112, 0, v112
    v_max_f32 v113, 0, v113
    v_max_f32 v114, 0, v114
    v_max_f32 v115, 0, v115
    v_max_f32 v116, 0, v116
    v_max_f32 v117, 0, v117
    v_max_f32 v118, 0, v118
    v_max_f32 v119, 0, v119
    v_mul_f32 v112, v112, v112
    v_mul_f32 v113, v113, v113
    v_mul_f32 v114, v114, v114
    v_mul_f32 v115, v115, v115
    v_mul_f32 v116, v116, v116
    v_mul_f32 v117, v117, v117
    v_mul_f32 v118, v118, v118
    v_mul_f32 v119, v119, v119
    v_cvt_pk_bf16_f32 v108, v112, v113
    v_cvt_pk_bf16_f32 v109, v114, v115
    v_cvt_pk_bf16_f32 v110, v116, v117
    v_cvt_pk_bf16_f32 v111, v118, v119
    buffer_store_dwordx4 v[108:111], v13, s[4:7], s47 offen offset:3072 sc1
    s_add_u32 s47, s45, 4096
    v_accvgpr_read_b32 v100, a32
    v_accvgpr_read_b32 v101, a33
    v_accvgpr_read_b32 v102, a34
    v_accvgpr_read_b32 v103, a35
    v_accvgpr_read_b32 v104, a40
    v_accvgpr_read_b32 v105, a41
    v_accvgpr_read_b32 v106, a42
    v_accvgpr_read_b32 v107, a43
    v_cvt_pk_bf16_f32 v96, v100, v101
    v_cvt_pk_bf16_f32 v97, v102, v103
    v_cvt_pk_bf16_f32 v98, v104, v105
    v_cvt_pk_bf16_f32 v99, v106, v107
    v_lshlrev_b32 v100, 16, v96
    v_and_b32 v101, 0xffff0000, v96
    v_lshlrev_b32 v102, 16, v97
    v_and_b32 v103, 0xffff0000, v97
    v_lshlrev_b32 v104, 16, v98
    v_and_b32 v105, 0xffff0000, v98
    v_lshlrev_b32 v106, 16, v99
    v_and_b32 v107, 0xffff0000, v99
    v_add_f32 v100, v100, v160
    v_add_f32 v101, v101, v161
    v_add_f32 v102, v102, v162
    v_add_f32 v103, v103, v163
    v_add_f32 v104, v104, v168
    v_add_f32 v105, v105, v169
    v_add_f32 v106, v106, v170
    v_add_f32 v107, v107, v171
    v_cvt_pk_bf16_f32 v96, v100, v101
    v_cvt_pk_bf16_f32 v97, v102, v103
    v_cvt_pk_bf16_f32 v98, v104, v105
    v_cvt_pk_bf16_f32 v99, v106, v107
    v_lshlrev_b32 v100, 16, v96
    v_and_b32 v101, 0xffff0000, v96
    v_lshlrev_b32 v102, 16, v97
    v_and_b32 v103, 0xffff0000, v97
    v_lshlrev_b32 v104, 16, v98
    v_and_b32 v105, 0xffff0000, v98
    v_lshlrev_b32 v106, 16, v99
    v_and_b32 v107, 0xffff0000, v99
    v_max_f32 v100, 0, v100
    v_max_f32 v101, 0, v101
    v_max_f32 v102, 0, v102
    v_max_f32 v103, 0, v103
    v_max_f32 v104, 0, v104
    v_max_f32 v105, 0, v105
    v_max_f32 v106, 0, v106
    v_max_f32 v107, 0, v107
    v_mul_f32 v100, v100, v100
    v_mul_f32 v101, v101, v101
    v_mul_f32 v102, v102, v102
    v_mul_f32 v103, v103, v103
    v_mul_f32 v104, v104, v104
    v_mul_f32 v105, v105, v105
    v_mul_f32 v106, v106, v106
    v_mul_f32 v107, v107, v107
    v_cvt_pk_bf16_f32 v96, v100, v101
    v_cvt_pk_bf16_f32 v97, v102, v103
    v_cvt_pk_bf16_f32 v98, v104, v105
    v_cvt_pk_bf16_f32 v99, v106, v107
    buffer_store_dwordx4 v[96:99], v13, s[4:7], s47 offen offset:0 sc1
    v_accvgpr_read_b32 v112, a36
    v_accvgpr_read_b32 v113, a37
    v_accvgpr_read_b32 v114, a38
    v_accvgpr_read_b32 v115, a39
    v_accvgpr_read_b32 v116, a44
    v_accvgpr_read_b32 v117, a45
    v_accvgpr_read_b32 v118, a46
    v_accvgpr_read_b32 v119, a47
    v_cvt_pk_bf16_f32 v108, v112, v113
    v_cvt_pk_bf16_f32 v109, v114, v115
    v_cvt_pk_bf16_f32 v110, v116, v117
    v_cvt_pk_bf16_f32 v111, v118, v119
    v_lshlrev_b32 v112, 16, v108
    v_and_b32 v113, 0xffff0000, v108
    v_lshlrev_b32 v114, 16, v109
    v_and_b32 v115, 0xffff0000, v109
    v_lshlrev_b32 v116, 16, v110
    v_and_b32 v117, 0xffff0000, v110
    v_lshlrev_b32 v118, 16, v111
    v_and_b32 v119, 0xffff0000, v111
    v_add_f32 v112, v112, v164
    v_add_f32 v113, v113, v165
    v_add_f32 v114, v114, v166
    v_add_f32 v115, v115, v167
    v_add_f32 v116, v116, v172
    v_add_f32 v117, v117, v173
    v_add_f32 v118, v118, v174
    v_add_f32 v119, v119, v175
    v_cvt_pk_bf16_f32 v108, v112, v113
    v_cvt_pk_bf16_f32 v109, v114, v115
    v_cvt_pk_bf16_f32 v110, v116, v117
    v_cvt_pk_bf16_f32 v111, v118, v119
    v_lshlrev_b32 v112, 16, v108
    v_and_b32 v113, 0xffff0000, v108
    v_lshlrev_b32 v114, 16, v109
    v_and_b32 v115, 0xffff0000, v109
    v_lshlrev_b32 v116, 16, v110
    v_and_b32 v117, 0xffff0000, v110
    v_lshlrev_b32 v118, 16, v111
    v_and_b32 v119, 0xffff0000, v111
    v_max_f32 v112, 0, v112
    v_max_f32 v113, 0, v113
    v_max_f32 v114, 0, v114
    v_max_f32 v115, 0, v115
    v_max_f32 v116, 0, v116
    v_max_f32 v117, 0, v117
    v_max_f32 v118, 0, v118
    v_max_f32 v119, 0, v119
    v_mul_f32 v112, v112, v112
    v_mul_f32 v113, v113, v113
    v_mul_f32 v114, v114, v114
    v_mul_f32 v115, v115, v115
    v_mul_f32 v116, v116, v116
    v_mul_f32 v117, v117, v117
    v_mul_f32 v118, v118, v118
    v_mul_f32 v119, v119, v119
    v_cvt_pk_bf16_f32 v108, v112, v113
    v_cvt_pk_bf16_f32 v109, v114, v115
    v_cvt_pk_bf16_f32 v110, v116, v117
    v_cvt_pk_bf16_f32 v111, v118, v119
    buffer_store_dwordx4 v[108:111], v13, s[4:7], s47 offen offset:1024 sc1
    v_accvgpr_read_b32 v100, a48
    v_accvgpr_read_b32 v101, a49
    v_accvgpr_read_b32 v102, a50
    v_accvgpr_read_b32 v103, a51
    v_accvgpr_read_b32 v104, a56
    v_accvgpr_read_b32 v105, a57
    v_accvgpr_read_b32 v106, a58
    v_accvgpr_read_b32 v107, a59
    v_cvt_pk_bf16_f32 v96, v100, v101
    v_cvt_pk_bf16_f32 v97, v102, v103
    v_cvt_pk_bf16_f32 v98, v104, v105
    v_cvt_pk_bf16_f32 v99, v106, v107
    v_lshlrev_b32 v100, 16, v96
    v_and_b32 v101, 0xffff0000, v96
    v_lshlrev_b32 v102, 16, v97
    v_and_b32 v103, 0xffff0000, v97
    v_lshlrev_b32 v104, 16, v98
    v_and_b32 v105, 0xffff0000, v98
    v_lshlrev_b32 v106, 16, v99
    v_and_b32 v107, 0xffff0000, v99
    v_add_f32 v100, v100, v176
    v_add_f32 v101, v101, v177
    v_add_f32 v102, v102, v178
    v_add_f32 v103, v103, v179
    v_add_f32 v104, v104, v184
    v_add_f32 v105, v105, v185
    v_add_f32 v106, v106, v186
    v_add_f32 v107, v107, v187
    v_cvt_pk_bf16_f32 v96, v100, v101
    v_cvt_pk_bf16_f32 v97, v102, v103
    v_cvt_pk_bf16_f32 v98, v104, v105
    v_cvt_pk_bf16_f32 v99, v106, v107
    v_lshlrev_b32 v100, 16, v96
    v_and_b32 v101, 0xffff0000, v96
    v_lshlrev_b32 v102, 16, v97
    v_and_b32 v103, 0xffff0000, v97
    v_lshlrev_b32 v104, 16, v98
    v_and_b32 v105, 0xffff0000, v98
    v_lshlrev_b32 v106, 16, v99
    v_and_b32 v107, 0xffff0000, v99
    v_max_f32 v100, 0, v100
    v_max_f32 v101, 0, v101
    v_max_f32 v102, 0, v102
    v_max_f32 v103, 0, v103
    v_max_f32 v104, 0, v104
    v_max_f32 v105, 0, v105
    v_max_f32 v106, 0, v106
    v_max_f32 v107, 0, v107
    v_mul_f32 v100, v100, v100
    v_mul_f32 v101, v101, v101
    v_mul_f32 v102, v102, v102
    v_mul_f32 v103, v103, v103
    v_mul_f32 v104, v104, v104
    v_mul_f32 v105, v105, v105
    v_mul_f32 v106, v106, v106
    v_mul_f32 v107, v107, v107
    v_cvt_pk_bf16_f32 v96, v100, v101
    v_cvt_pk_bf16_f32 v97, v102, v103
    v_cvt_pk_bf16_f32 v98, v104, v105
    v_cvt_pk_bf16_f32 v99, v106, v107
    buffer_store_dwordx4 v[96:99], v13, s[4:7], s47 offen offset:2048 sc1
    v_accvgpr_read_b32 v112, a52
    v_accvgpr_read_b32 v113, a53
    v_accvgpr_read_b32 v114, a54
    v_accvgpr_read_b32 v115, a55
    v_accvgpr_read_b32 v116, a60
    v_accvgpr_read_b32 v117, a61
    v_accvgpr_read_b32 v118, a62
    v_accvgpr_read_b32 v119, a63
    v_cvt_pk_bf16_f32 v108, v112, v113
    v_cvt_pk_bf16_f32 v109, v114, v115
    v_cvt_pk_bf16_f32 v110, v116, v117
    v_cvt_pk_bf16_f32 v111, v118, v119
    v_lshlrev_b32 v112, 16, v108
    v_and_b32 v113, 0xffff0000, v108
    v_lshlrev_b32 v114, 16, v109
    v_and_b32 v115, 0xffff0000, v109
    v_lshlrev_b32 v116, 16, v110
    v_and_b32 v117, 0xffff0000, v110
    v_lshlrev_b32 v118, 16, v111
    v_and_b32 v119, 0xffff0000, v111
    v_add_f32 v112, v112, v180
    v_add_f32 v113, v113, v181
    v_add_f32 v114, v114, v182
    v_add_f32 v115, v115, v183
    v_add_f32 v116, v116, v188
    v_add_f32 v117, v117, v189
    v_add_f32 v118, v118, v190
    v_add_f32 v119, v119, v191
    v_cvt_pk_bf16_f32 v108, v112, v113
    v_cvt_pk_bf16_f32 v109, v114, v115
    v_cvt_pk_bf16_f32 v110, v116, v117
    v_cvt_pk_bf16_f32 v111, v118, v119
    v_lshlrev_b32 v112, 16, v108
    v_and_b32 v113, 0xffff0000, v108
    v_lshlrev_b32 v114, 16, v109
    v_and_b32 v115, 0xffff0000, v109
    v_lshlrev_b32 v116, 16, v110
    v_and_b32 v117, 0xffff0000, v110
    v_lshlrev_b32 v118, 16, v111
    v_and_b32 v119, 0xffff0000, v111
    v_max_f32 v112, 0, v112
    v_max_f32 v113, 0, v113
    v_max_f32 v114, 0, v114
    v_max_f32 v115, 0, v115
    v_max_f32 v116, 0, v116
    v_max_f32 v117, 0, v117
    v_max_f32 v118, 0, v118
    v_max_f32 v119, 0, v119
    v_mul_f32 v112, v112, v112
    v_mul_f32 v113, v113, v113
    v_mul_f32 v114, v114, v114
    v_mul_f32 v115, v115, v115
    v_mul_f32 v116, v116, v116
    v_mul_f32 v117, v117, v117
    v_mul_f32 v118, v118, v118
    v_mul_f32 v119, v119, v119
    v_cvt_pk_bf16_f32 v108, v112, v113
    v_cvt_pk_bf16_f32 v109, v114, v115
    v_cvt_pk_bf16_f32 v110, v116, v117
    v_cvt_pk_bf16_f32 v111, v118, v119
    buffer_store_dwordx4 v[108:111], v13, s[4:7], s47 offen offset:3072 sc1
    s_add_u32 s47, s45, 114688
    v_accvgpr_read_b32 v100, a64
    v_accvgpr_read_b32 v101, a65
    v_accvgpr_read_b32 v102, a66
    v_accvgpr_read_b32 v103, a67
    v_accvgpr_read_b32 v104, a72
    v_accvgpr_read_b32 v105, a73
    v_accvgpr_read_b32 v106, a74
    v_accvgpr_read_b32 v107, a75
    v_cvt_pk_bf16_f32 v96, v100, v101
    v_cvt_pk_bf16_f32 v97, v102, v103
    v_cvt_pk_bf16_f32 v98, v104, v105
    v_cvt_pk_bf16_f32 v99, v106, v107
    v_lshlrev_b32 v100, 16, v96
    v_and_b32 v101, 0xffff0000, v96
    v_lshlrev_b32 v102, 16, v97
    v_and_b32 v103, 0xffff0000, v97
    v_lshlrev_b32 v104, 16, v98
    v_and_b32 v105, 0xffff0000, v98
    v_lshlrev_b32 v106, 16, v99
    v_and_b32 v107, 0xffff0000, v99
    v_add_f32 v100, v100, v128
    v_add_f32 v101, v101, v129
    v_add_f32 v102, v102, v130
    v_add_f32 v103, v103, v131
    v_add_f32 v104, v104, v136
    v_add_f32 v105, v105, v137
    v_add_f32 v106, v106, v138
    v_add_f32 v107, v107, v139
    v_cvt_pk_bf16_f32 v96, v100, v101
    v_cvt_pk_bf16_f32 v97, v102, v103
    v_cvt_pk_bf16_f32 v98, v104, v105
    v_cvt_pk_bf16_f32 v99, v106, v107
    v_lshlrev_b32 v100, 16, v96
    v_and_b32 v101, 0xffff0000, v96
    v_lshlrev_b32 v102, 16, v97
    v_and_b32 v103, 0xffff0000, v97
    v_lshlrev_b32 v104, 16, v98
    v_and_b32 v105, 0xffff0000, v98
    v_lshlrev_b32 v106, 16, v99
    v_and_b32 v107, 0xffff0000, v99
    v_max_f32 v100, 0, v100
    v_max_f32 v101, 0, v101
    v_max_f32 v102, 0, v102
    v_max_f32 v103, 0, v103
    v_max_f32 v104, 0, v104
    v_max_f32 v105, 0, v105
    v_max_f32 v106, 0, v106
    v_max_f32 v107, 0, v107
    v_mul_f32 v100, v100, v100
    v_mul_f32 v101, v101, v101
    v_mul_f32 v102, v102, v102
    v_mul_f32 v103, v103, v103
    v_mul_f32 v104, v104, v104
    v_mul_f32 v105, v105, v105
    v_mul_f32 v106, v106, v106
    v_mul_f32 v107, v107, v107
    v_cvt_pk_bf16_f32 v96, v100, v101
    v_cvt_pk_bf16_f32 v97, v102, v103
    v_cvt_pk_bf16_f32 v98, v104, v105
    v_cvt_pk_bf16_f32 v99, v106, v107
    buffer_store_dwordx4 v[96:99], v13, s[4:7], s47 offen offset:0 sc1
    v_accvgpr_read_b32 v112, a68
    v_accvgpr_read_b32 v113, a69
    v_accvgpr_read_b32 v114, a70
    v_accvgpr_read_b32 v115, a71
    v_accvgpr_read_b32 v116, a76
    v_accvgpr_read_b32 v117, a77
    v_accvgpr_read_b32 v118, a78
    v_accvgpr_read_b32 v119, a79
    v_cvt_pk_bf16_f32 v108, v112, v113
    v_cvt_pk_bf16_f32 v109, v114, v115
    v_cvt_pk_bf16_f32 v110, v116, v117
    v_cvt_pk_bf16_f32 v111, v118, v119
    v_lshlrev_b32 v112, 16, v108
    v_and_b32 v113, 0xffff0000, v108
    v_lshlrev_b32 v114, 16, v109
    v_and_b32 v115, 0xffff0000, v109
    v_lshlrev_b32 v116, 16, v110
    v_and_b32 v117, 0xffff0000, v110
    v_lshlrev_b32 v118, 16, v111
    v_and_b32 v119, 0xffff0000, v111
    v_add_f32 v112, v112, v132
    v_add_f32 v113, v113, v133
    v_add_f32 v114, v114, v134
    v_add_f32 v115, v115, v135
    v_add_f32 v116, v116, v140
    v_add_f32 v117, v117, v141
    v_add_f32 v118, v118, v142
    v_add_f32 v119, v119, v143
    v_cvt_pk_bf16_f32 v108, v112, v113
    v_cvt_pk_bf16_f32 v109, v114, v115
    v_cvt_pk_bf16_f32 v110, v116, v117
    v_cvt_pk_bf16_f32 v111, v118, v119
    v_lshlrev_b32 v112, 16, v108
    v_and_b32 v113, 0xffff0000, v108
    v_lshlrev_b32 v114, 16, v109
    v_and_b32 v115, 0xffff0000, v109
    v_lshlrev_b32 v116, 16, v110
    v_and_b32 v117, 0xffff0000, v110
    v_lshlrev_b32 v118, 16, v111
    v_and_b32 v119, 0xffff0000, v111
    v_max_f32 v112, 0, v112
    v_max_f32 v113, 0, v113
    v_max_f32 v114, 0, v114
    v_max_f32 v115, 0, v115
    v_max_f32 v116, 0, v116
    v_max_f32 v117, 0, v117
    v_max_f32 v118, 0, v118
    v_max_f32 v119, 0, v119
    v_mul_f32 v112, v112, v112
    v_mul_f32 v113, v113, v113
    v_mul_f32 v114, v114, v114
    v_mul_f32 v115, v115, v115
    v_mul_f32 v116, v116, v116
    v_mul_f32 v117, v117, v117
    v_mul_f32 v118, v118, v118
    v_mul_f32 v119, v119, v119
    v_cvt_pk_bf16_f32 v108, v112, v113
    v_cvt_pk_bf16_f32 v109, v114, v115
    v_cvt_pk_bf16_f32 v110, v116, v117
    v_cvt_pk_bf16_f32 v111, v118, v119
    buffer_store_dwordx4 v[108:111], v13, s[4:7], s47 offen offset:1024 sc1
    v_accvgpr_read_b32 v100, a80
    v_accvgpr_read_b32 v101, a81
    v_accvgpr_read_b32 v102, a82
    v_accvgpr_read_b32 v103, a83
    v_accvgpr_read_b32 v104, a88
    v_accvgpr_read_b32 v105, a89
    v_accvgpr_read_b32 v106, a90
    v_accvgpr_read_b32 v107, a91
    v_cvt_pk_bf16_f32 v96, v100, v101
    v_cvt_pk_bf16_f32 v97, v102, v103
    v_cvt_pk_bf16_f32 v98, v104, v105
    v_cvt_pk_bf16_f32 v99, v106, v107
    v_lshlrev_b32 v100, 16, v96
    v_and_b32 v101, 0xffff0000, v96
    v_lshlrev_b32 v102, 16, v97
    v_and_b32 v103, 0xffff0000, v97
    v_lshlrev_b32 v104, 16, v98
    v_and_b32 v105, 0xffff0000, v98
    v_lshlrev_b32 v106, 16, v99
    v_and_b32 v107, 0xffff0000, v99
    v_add_f32 v100, v100, v144
    v_add_f32 v101, v101, v145
    v_add_f32 v102, v102, v146
    v_add_f32 v103, v103, v147
    v_add_f32 v104, v104, v152
    v_add_f32 v105, v105, v153
    v_add_f32 v106, v106, v154
    v_add_f32 v107, v107, v155
    v_cvt_pk_bf16_f32 v96, v100, v101
    v_cvt_pk_bf16_f32 v97, v102, v103
    v_cvt_pk_bf16_f32 v98, v104, v105
    v_cvt_pk_bf16_f32 v99, v106, v107
    v_lshlrev_b32 v100, 16, v96
    v_and_b32 v101, 0xffff0000, v96
    v_lshlrev_b32 v102, 16, v97
    v_and_b32 v103, 0xffff0000, v97
    v_lshlrev_b32 v104, 16, v98
    v_and_b32 v105, 0xffff0000, v98
    v_lshlrev_b32 v106, 16, v99
    v_and_b32 v107, 0xffff0000, v99
    v_max_f32 v100, 0, v100
    v_max_f32 v101, 0, v101
    v_max_f32 v102, 0, v102
    v_max_f32 v103, 0, v103
    v_max_f32 v104, 0, v104
    v_max_f32 v105, 0, v105
    v_max_f32 v106, 0, v106
    v_max_f32 v107, 0, v107
    v_mul_f32 v100, v100, v100
    v_mul_f32 v101, v101, v101
    v_mul_f32 v102, v102, v102
    v_mul_f32 v103, v103, v103
    v_mul_f32 v104, v104, v104
    v_mul_f32 v105, v105, v105
    v_mul_f32 v106, v106, v106
    v_mul_f32 v107, v107, v107
    v_cvt_pk_bf16_f32 v96, v100, v101
    v_cvt_pk_bf16_f32 v97, v102, v103
    v_cvt_pk_bf16_f32 v98, v104, v105
    v_cvt_pk_bf16_f32 v99, v106, v107
    buffer_store_dwordx4 v[96:99], v13, s[4:7], s47 offen offset:2048 sc1
    v_accvgpr_read_b32 v112, a84
    v_accvgpr_read_b32 v113, a85
    v_accvgpr_read_b32 v114, a86
    v_accvgpr_read_b32 v115, a87
    v_accvgpr_read_b32 v116, a92
    v_accvgpr_read_b32 v117, a93
    v_accvgpr_read_b32 v118, a94
    v_accvgpr_read_b32 v119, a95
    v_cvt_pk_bf16_f32 v108, v112, v113
    v_cvt_pk_bf16_f32 v109, v114, v115
    v_cvt_pk_bf16_f32 v110, v116, v117
    v_cvt_pk_bf16_f32 v111, v118, v119
    v_lshlrev_b32 v112, 16, v108
    v_and_b32 v113, 0xffff0000, v108
    v_lshlrev_b32 v114, 16, v109
    v_and_b32 v115, 0xffff0000, v109
    v_lshlrev_b32 v116, 16, v110
    v_and_b32 v117, 0xffff0000, v110
    v_lshlrev_b32 v118, 16, v111
    v_and_b32 v119, 0xffff0000, v111
    v_add_f32 v112, v112, v148
    v_add_f32 v113, v113, v149
    v_add_f32 v114, v114, v150
    v_add_f32 v115, v115, v151
    v_add_f32 v116, v116, v156
    v_add_f32 v117, v117, v157
    v_add_f32 v118, v118, v158
    v_add_f32 v119, v119, v159
    v_cvt_pk_bf16_f32 v108, v112, v113
    v_cvt_pk_bf16_f32 v109, v114, v115
    v_cvt_pk_bf16_f32 v110, v116, v117
    v_cvt_pk_bf16_f32 v111, v118, v119
    v_lshlrev_b32 v112, 16, v108
    v_and_b32 v113, 0xffff0000, v108
    v_lshlrev_b32 v114, 16, v109
    v_and_b32 v115, 0xffff0000, v109
    v_lshlrev_b32 v116, 16, v110
    v_and_b32 v117, 0xffff0000, v110
    v_lshlrev_b32 v118, 16, v111
    v_and_b32 v119, 0xffff0000, v111
    v_max_f32 v112, 0, v112
    v_max_f32 v113, 0, v113
    v_max_f32 v114, 0, v114
    v_max_f32 v115, 0, v115
    v_max_f32 v116, 0, v116
    v_max_f32 v117, 0, v117
    v_max_f32 v118, 0, v118
    v_max_f32 v119, 0, v119
    v_mul_f32 v112, v112, v112
    v_mul_f32 v113, v113, v113
    v_mul_f32 v114, v114, v114
    v_mul_f32 v115, v115, v115
    v_mul_f32 v116, v116, v116
    v_mul_f32 v117, v117, v117
    v_mul_f32 v118, v118, v118
    v_mul_f32 v119, v119, v119
    v_cvt_pk_bf16_f32 v108, v112, v113
    v_cvt_pk_bf16_f32 v109, v114, v115
    v_cvt_pk_bf16_f32 v110, v116, v117
    v_cvt_pk_bf16_f32 v111, v118, v119
    buffer_store_dwordx4 v[108:111], v13, s[4:7], s47 offen offset:3072 sc1
    s_add_u32 s47, s45, 118784
    v_accvgpr_read_b32 v100, a96
    v_accvgpr_read_b32 v101, a97
    v_accvgpr_read_b32 v102, a98
    v_accvgpr_read_b32 v103, a99
    v_accvgpr_read_b32 v104, a104
    v_accvgpr_read_b32 v105, a105
    v_accvgpr_read_b32 v106, a106
    v_accvgpr_read_b32 v107, a107
    v_cvt_pk_bf16_f32 v96, v100, v101
    v_cvt_pk_bf16_f32 v97, v102, v103
    v_cvt_pk_bf16_f32 v98, v104, v105
    v_cvt_pk_bf16_f32 v99, v106, v107
    v_lshlrev_b32 v100, 16, v96
    v_and_b32 v101, 0xffff0000, v96
    v_lshlrev_b32 v102, 16, v97
    v_and_b32 v103, 0xffff0000, v97
    v_lshlrev_b32 v104, 16, v98
    v_and_b32 v105, 0xffff0000, v98
    v_lshlrev_b32 v106, 16, v99
    v_and_b32 v107, 0xffff0000, v99
    v_add_f32 v100, v100, v160
    v_add_f32 v101, v101, v161
    v_add_f32 v102, v102, v162
    v_add_f32 v103, v103, v163
    v_add_f32 v104, v104, v168
    v_add_f32 v105, v105, v169
    v_add_f32 v106, v106, v170
    v_add_f32 v107, v107, v171
    v_cvt_pk_bf16_f32 v96, v100, v101
    v_cvt_pk_bf16_f32 v97, v102, v103
    v_cvt_pk_bf16_f32 v98, v104, v105
    v_cvt_pk_bf16_f32 v99, v106, v107
    v_lshlrev_b32 v100, 16, v96
    v_and_b32 v101, 0xffff0000, v96
    v_lshlrev_b32 v102, 16, v97
    v_and_b32 v103, 0xffff0000, v97
    v_lshlrev_b32 v104, 16, v98
    v_and_b32 v105, 0xffff0000, v98
    v_lshlrev_b32 v106, 16, v99
    v_and_b32 v107, 0xffff0000, v99
    v_max_f32 v100, 0, v100
    v_max_f32 v101, 0, v101
    v_max_f32 v102, 0, v102
    v_max_f32 v103, 0, v103
    v_max_f32 v104, 0, v104
    v_max_f32 v105, 0, v105
    v_max_f32 v106, 0, v106
    v_max_f32 v107, 0, v107
    v_mul_f32 v100, v100, v100
    v_mul_f32 v101, v101, v101
    v_mul_f32 v102, v102, v102
    v_mul_f32 v103, v103, v103
    v_mul_f32 v104, v104, v104
    v_mul_f32 v105, v105, v105
    v_mul_f32 v106, v106, v106
    v_mul_f32 v107, v107, v107
    v_cvt_pk_bf16_f32 v96, v100, v101
    v_cvt_pk_bf16_f32 v97, v102, v103
    v_cvt_pk_bf16_f32 v98, v104, v105
    v_cvt_pk_bf16_f32 v99, v106, v107
    buffer_store_dwordx4 v[96:99], v13, s[4:7], s47 offen offset:0 sc1
    v_accvgpr_read_b32 v112, a100
    v_accvgpr_read_b32 v113, a101
    v_accvgpr_read_b32 v114, a102
    v_accvgpr_read_b32 v115, a103
    v_accvgpr_read_b32 v116, a108
    v_accvgpr_read_b32 v117, a109
    v_accvgpr_read_b32 v118, a110
    v_accvgpr_read_b32 v119, a111
    v_cvt_pk_bf16_f32 v108, v112, v113
    v_cvt_pk_bf16_f32 v109, v114, v115
    v_cvt_pk_bf16_f32 v110, v116, v117
    v_cvt_pk_bf16_f32 v111, v118, v119
    v_lshlrev_b32 v112, 16, v108
    v_and_b32 v113, 0xffff0000, v108
    v_lshlrev_b32 v114, 16, v109
    v_and_b32 v115, 0xffff0000, v109
    v_lshlrev_b32 v116, 16, v110
    v_and_b32 v117, 0xffff0000, v110
    v_lshlrev_b32 v118, 16, v111
    v_and_b32 v119, 0xffff0000, v111
    v_add_f32 v112, v112, v164
    v_add_f32 v113, v113, v165
    v_add_f32 v114, v114, v166
    v_add_f32 v115, v115, v167
    v_add_f32 v116, v116, v172
    v_add_f32 v117, v117, v173
    v_add_f32 v118, v118, v174
    v_add_f32 v119, v119, v175
    v_cvt_pk_bf16_f32 v108, v112, v113
    v_cvt_pk_bf16_f32 v109, v114, v115
    v_cvt_pk_bf16_f32 v110, v116, v117
    v_cvt_pk_bf16_f32 v111, v118, v119
    v_lshlrev_b32 v112, 16, v108
    v_and_b32 v113, 0xffff0000, v108
    v_lshlrev_b32 v114, 16, v109
    v_and_b32 v115, 0xffff0000, v109
    v_lshlrev_b32 v116, 16, v110
    v_and_b32 v117, 0xffff0000, v110
    v_lshlrev_b32 v118, 16, v111
    v_and_b32 v119, 0xffff0000, v111
    v_max_f32 v112, 0, v112
    v_max_f32 v113, 0, v113
    v_max_f32 v114, 0, v114
    v_max_f32 v115, 0, v115
    v_max_f32 v116, 0, v116
    v_max_f32 v117, 0, v117
    v_max_f32 v118, 0, v118
    v_max_f32 v119, 0, v119
    v_mul_f32 v112, v112, v112
    v_mul_f32 v113, v113, v113
    v_mul_f32 v114, v114, v114
    v_mul_f32 v115, v115, v115
    v_mul_f32 v116, v116, v116
    v_mul_f32 v117, v117, v117
    v_mul_f32 v118, v118, v118
    v_mul_f32 v119, v119, v119
    v_cvt_pk_bf16_f32 v108, v112, v113
    v_cvt_pk_bf16_f32 v109, v114, v115
    v_cvt_pk_bf16_f32 v110, v116, v117
    v_cvt_pk_bf16_f32 v111, v118, v119
    buffer_store_dwordx4 v[108:111], v13, s[4:7], s47 offen offset:1024 sc1
    v_accvgpr_read_b32 v100, a112
    v_accvgpr_read_b32 v101, a113
    v_accvgpr_read_b32 v102, a114
    v_accvgpr_read_b32 v103, a115
    v_accvgpr_read_b32 v104, a120
    v_accvgpr_read_b32 v105, a121
    v_accvgpr_read_b32 v106, a122
    v_accvgpr_read_b32 v107, a123
    v_cvt_pk_bf16_f32 v96, v100, v101
    v_cvt_pk_bf16_f32 v97, v102, v103
    v_cvt_pk_bf16_f32 v98, v104, v105
    v_cvt_pk_bf16_f32 v99, v106, v107
    v_lshlrev_b32 v100, 16, v96
    v_and_b32 v101, 0xffff0000, v96
    v_lshlrev_b32 v102, 16, v97
    v_and_b32 v103, 0xffff0000, v97
    v_lshlrev_b32 v104, 16, v98
    v_and_b32 v105, 0xffff0000, v98
    v_lshlrev_b32 v106, 16, v99
    v_and_b32 v107, 0xffff0000, v99
    v_add_f32 v100, v100, v176
    v_add_f32 v101, v101, v177
    v_add_f32 v102, v102, v178
    v_add_f32 v103, v103, v179
    v_add_f32 v104, v104, v184
    v_add_f32 v105, v105, v185
    v_add_f32 v106, v106, v186
    v_add_f32 v107, v107, v187
    v_cvt_pk_bf16_f32 v96, v100, v101
    v_cvt_pk_bf16_f32 v97, v102, v103
    v_cvt_pk_bf16_f32 v98, v104, v105
    v_cvt_pk_bf16_f32 v99, v106, v107
    v_lshlrev_b32 v100, 16, v96
    v_and_b32 v101, 0xffff0000, v96
    v_lshlrev_b32 v102, 16, v97
    v_and_b32 v103, 0xffff0000, v97
    v_lshlrev_b32 v104, 16, v98
    v_and_b32 v105, 0xffff0000, v98
    v_lshlrev_b32 v106, 16, v99
    v_and_b32 v107, 0xffff0000, v99
    v_max_f32 v100, 0, v100
    v_max_f32 v101, 0, v101
    v_max_f32 v102, 0, v102
    v_max_f32 v103, 0, v103
    v_max_f32 v104, 0, v104
    v_max_f32 v105, 0, v105
    v_max_f32 v106, 0, v106
    v_max_f32 v107, 0, v107
    v_mul_f32 v100, v100, v100
    v_mul_f32 v101, v101, v101
    v_mul_f32 v102, v102, v102
    v_mul_f32 v103, v103, v103
    v_mul_f32 v104, v104, v104
    v_mul_f32 v105, v105, v105
    v_mul_f32 v106, v106, v106
    v_mul_f32 v107, v107, v107
    v_cvt_pk_bf16_f32 v96, v100, v101
    v_cvt_pk_bf16_f32 v97, v102, v103
    v_cvt_pk_bf16_f32 v98, v104, v105
    v_cvt_pk_bf16_f32 v99, v106, v107
    buffer_store_dwordx4 v[96:99], v13, s[4:7], s47 offen offset:2048 sc1
    v_accvgpr_read_b32 v112, a116
    v_accvgpr_read_b32 v113, a117
    v_accvgpr_read_b32 v114, a118
    v_accvgpr_read_b32 v115, a119
    v_accvgpr_read_b32 v116, a124
    v_accvgpr_read_b32 v117, a125
    v_accvgpr_read_b32 v118, a126
    v_accvgpr_read_b32 v119, a127
    v_cvt_pk_bf16_f32 v108, v112, v113
    v_cvt_pk_bf16_f32 v109, v114, v115
    v_cvt_pk_bf16_f32 v110, v116, v117
    v_cvt_pk_bf16_f32 v111, v118, v119
    v_lshlrev_b32 v112, 16, v108
    v_and_b32 v113, 0xffff0000, v108
    v_lshlrev_b32 v114, 16, v109
    v_and_b32 v115, 0xffff0000, v109
    v_lshlrev_b32 v116, 16, v110
    v_and_b32 v117, 0xffff0000, v110
    v_lshlrev_b32 v118, 16, v111
    v_and_b32 v119, 0xffff0000, v111
    v_add_f32 v112, v112, v180
    v_add_f32 v113, v113, v181
    v_add_f32 v114, v114, v182
    v_add_f32 v115, v115, v183
    v_add_f32 v116, v116, v188
    v_add_f32 v117, v117, v189
    v_add_f32 v118, v118, v190
    v_add_f32 v119, v119, v191
    v_cvt_pk_bf16_f32 v108, v112, v113
    v_cvt_pk_bf16_f32 v109, v114, v115
    v_cvt_pk_bf16_f32 v110, v116, v117
    v_cvt_pk_bf16_f32 v111, v118, v119
    v_lshlrev_b32 v112, 16, v108
    v_and_b32 v113, 0xffff0000, v108
    v_lshlrev_b32 v114, 16, v109
    v_and_b32 v115, 0xffff0000, v109
    v_lshlrev_b32 v116, 16, v110
    v_and_b32 v117, 0xffff0000, v110
    v_lshlrev_b32 v118, 16, v111
    v_and_b32 v119, 0xffff0000, v111
    v_max_f32 v112, 0, v112
    v_max_f32 v113, 0, v113
    v_max_f32 v114, 0, v114
    v_max_f32 v115, 0, v115
    v_max_f32 v116, 0, v116
    v_max_f32 v117, 0, v117
    v_max_f32 v118, 0, v118
    v_max_f32 v119, 0, v119
    v_mul_f32 v112, v112, v112
    v_mul_f32 v113, v113, v113
    v_mul_f32 v114, v114, v114
    v_mul_f32 v115, v115, v115
    v_mul_f32 v116, v116, v116
    v_mul_f32 v117, v117, v117
    v_mul_f32 v118, v118, v118
    v_mul_f32 v119, v119, v119
    v_cvt_pk_bf16_f32 v108, v112, v113
    v_cvt_pk_bf16_f32 v109, v114, v115
    v_cvt_pk_bf16_f32 v110, v116, v117
    v_cvt_pk_bf16_f32 v111, v118, v119
    buffer_store_dwordx4 v[108:111], v13, s[4:7], s47 offen offset:3072 sc1
    s_add_u32 s47, s45, 229376
    v_accvgpr_read_b32 v100, a128
    v_accvgpr_read_b32 v101, a129
    v_accvgpr_read_b32 v102, a130
    v_accvgpr_read_b32 v103, a131
    v_accvgpr_read_b32 v104, a136
    v_accvgpr_read_b32 v105, a137
    v_accvgpr_read_b32 v106, a138
    v_accvgpr_read_b32 v107, a139
    v_cvt_pk_bf16_f32 v96, v100, v101
    v_cvt_pk_bf16_f32 v97, v102, v103
    v_cvt_pk_bf16_f32 v98, v104, v105
    v_cvt_pk_bf16_f32 v99, v106, v107
    v_lshlrev_b32 v100, 16, v96
    v_and_b32 v101, 0xffff0000, v96
    v_lshlrev_b32 v102, 16, v97
    v_and_b32 v103, 0xffff0000, v97
    v_lshlrev_b32 v104, 16, v98
    v_and_b32 v105, 0xffff0000, v98
    v_lshlrev_b32 v106, 16, v99
    v_and_b32 v107, 0xffff0000, v99
    v_add_f32 v100, v100, v128
    v_add_f32 v101, v101, v129
    v_add_f32 v102, v102, v130
    v_add_f32 v103, v103, v131
    v_add_f32 v104, v104, v136
    v_add_f32 v105, v105, v137
    v_add_f32 v106, v106, v138
    v_add_f32 v107, v107, v139
    v_cvt_pk_bf16_f32 v96, v100, v101
    v_cvt_pk_bf16_f32 v97, v102, v103
    v_cvt_pk_bf16_f32 v98, v104, v105
    v_cvt_pk_bf16_f32 v99, v106, v107
    v_lshlrev_b32 v100, 16, v96
    v_and_b32 v101, 0xffff0000, v96
    v_lshlrev_b32 v102, 16, v97
    v_and_b32 v103, 0xffff0000, v97
    v_lshlrev_b32 v104, 16, v98
    v_and_b32 v105, 0xffff0000, v98
    v_lshlrev_b32 v106, 16, v99
    v_and_b32 v107, 0xffff0000, v99
    v_max_f32 v100, 0, v100
    v_max_f32 v101, 0, v101
    v_max_f32 v102, 0, v102
    v_max_f32 v103, 0, v103
    v_max_f32 v104, 0, v104
    v_max_f32 v105, 0, v105
    v_max_f32 v106, 0, v106
    v_max_f32 v107, 0, v107
    v_mul_f32 v100, v100, v100
    v_mul_f32 v101, v101, v101
    v_mul_f32 v102, v102, v102
    v_mul_f32 v103, v103, v103
    v_mul_f32 v104, v104, v104
    v_mul_f32 v105, v105, v105
    v_mul_f32 v106, v106, v106
    v_mul_f32 v107, v107, v107
    v_cvt_pk_bf16_f32 v96, v100, v101
    v_cvt_pk_bf16_f32 v97, v102, v103
    v_cvt_pk_bf16_f32 v98, v104, v105
    v_cvt_pk_bf16_f32 v99, v106, v107
    buffer_store_dwordx4 v[96:99], v13, s[4:7], s47 offen offset:0 sc1
    v_accvgpr_read_b32 v112, a132
    v_accvgpr_read_b32 v113, a133
    v_accvgpr_read_b32 v114, a134
    v_accvgpr_read_b32 v115, a135
    v_accvgpr_read_b32 v116, a140
    v_accvgpr_read_b32 v117, a141
    v_accvgpr_read_b32 v118, a142
    v_accvgpr_read_b32 v119, a143
    v_cvt_pk_bf16_f32 v108, v112, v113
    v_cvt_pk_bf16_f32 v109, v114, v115
    v_cvt_pk_bf16_f32 v110, v116, v117
    v_cvt_pk_bf16_f32 v111, v118, v119
    v_lshlrev_b32 v112, 16, v108
    v_and_b32 v113, 0xffff0000, v108
    v_lshlrev_b32 v114, 16, v109
    v_and_b32 v115, 0xffff0000, v109
    v_lshlrev_b32 v116, 16, v110
    v_and_b32 v117, 0xffff0000, v110
    v_lshlrev_b32 v118, 16, v111
    v_and_b32 v119, 0xffff0000, v111
    v_add_f32 v112, v112, v132
    v_add_f32 v113, v113, v133
    v_add_f32 v114, v114, v134
    v_add_f32 v115, v115, v135
    v_add_f32 v116, v116, v140
    v_add_f32 v117, v117, v141
    v_add_f32 v118, v118, v142
    v_add_f32 v119, v119, v143
    v_cvt_pk_bf16_f32 v108, v112, v113
    v_cvt_pk_bf16_f32 v109, v114, v115
    v_cvt_pk_bf16_f32 v110, v116, v117
    v_cvt_pk_bf16_f32 v111, v118, v119
    v_lshlrev_b32 v112, 16, v108
    v_and_b32 v113, 0xffff0000, v108
    v_lshlrev_b32 v114, 16, v109
    v_and_b32 v115, 0xffff0000, v109
    v_lshlrev_b32 v116, 16, v110
    v_and_b32 v117, 0xffff0000, v110
    v_lshlrev_b32 v118, 16, v111
    v_and_b32 v119, 0xffff0000, v111
    v_max_f32 v112, 0, v112
    v_max_f32 v113, 0, v113
    v_max_f32 v114, 0, v114
    v_max_f32 v115, 0, v115
    v_max_f32 v116, 0, v116
    v_max_f32 v117, 0, v117
    v_max_f32 v118, 0, v118
    v_max_f32 v119, 0, v119
    v_mul_f32 v112, v112, v112
    v_mul_f32 v113, v113, v113
    v_mul_f32 v114, v114, v114
    v_mul_f32 v115, v115, v115
    v_mul_f32 v116, v116, v116
    v_mul_f32 v117, v117, v117
    v_mul_f32 v118, v118, v118
    v_mul_f32 v119, v119, v119
    v_cvt_pk_bf16_f32 v108, v112, v113
    v_cvt_pk_bf16_f32 v109, v114, v115
    v_cvt_pk_bf16_f32 v110, v116, v117
    v_cvt_pk_bf16_f32 v111, v118, v119
    buffer_store_dwordx4 v[108:111], v13, s[4:7], s47 offen offset:1024 sc1
    v_accvgpr_read_b32 v100, a144
    v_accvgpr_read_b32 v101, a145
    v_accvgpr_read_b32 v102, a146
    v_accvgpr_read_b32 v103, a147
    v_accvgpr_read_b32 v104, a152
    v_accvgpr_read_b32 v105, a153
    v_accvgpr_read_b32 v106, a154
    v_accvgpr_read_b32 v107, a155
    v_cvt_pk_bf16_f32 v96, v100, v101
    v_cvt_pk_bf16_f32 v97, v102, v103
    v_cvt_pk_bf16_f32 v98, v104, v105
    v_cvt_pk_bf16_f32 v99, v106, v107
    v_lshlrev_b32 v100, 16, v96
    v_and_b32 v101, 0xffff0000, v96
    v_lshlrev_b32 v102, 16, v97
    v_and_b32 v103, 0xffff0000, v97
    v_lshlrev_b32 v104, 16, v98
    v_and_b32 v105, 0xffff0000, v98
    v_lshlrev_b32 v106, 16, v99
    v_and_b32 v107, 0xffff0000, v99
    v_add_f32 v100, v100, v144
    v_add_f32 v101, v101, v145
    v_add_f32 v102, v102, v146
    v_add_f32 v103, v103, v147
    v_add_f32 v104, v104, v152
    v_add_f32 v105, v105, v153
    v_add_f32 v106, v106, v154
    v_add_f32 v107, v107, v155
    v_cvt_pk_bf16_f32 v96, v100, v101
    v_cvt_pk_bf16_f32 v97, v102, v103
    v_cvt_pk_bf16_f32 v98, v104, v105
    v_cvt_pk_bf16_f32 v99, v106, v107
    v_lshlrev_b32 v100, 16, v96
    v_and_b32 v101, 0xffff0000, v96
    v_lshlrev_b32 v102, 16, v97
    v_and_b32 v103, 0xffff0000, v97
    v_lshlrev_b32 v104, 16, v98
    v_and_b32 v105, 0xffff0000, v98
    v_lshlrev_b32 v106, 16, v99
    v_and_b32 v107, 0xffff0000, v99
    v_max_f32 v100, 0, v100
    v_max_f32 v101, 0, v101
    v_max_f32 v102, 0, v102
    v_max_f32 v103, 0, v103
    v_max_f32 v104, 0, v104
    v_max_f32 v105, 0, v105
    v_max_f32 v106, 0, v106
    v_max_f32 v107, 0, v107
    v_mul_f32 v100, v100, v100
    v_mul_f32 v101, v101, v101
    v_mul_f32 v102, v102, v102
    v_mul_f32 v103, v103, v103
    v_mul_f32 v104, v104, v104
    v_mul_f32 v105, v105, v105
    v_mul_f32 v106, v106, v106
    v_mul_f32 v107, v107, v107
    v_cvt_pk_bf16_f32 v96, v100, v101
    v_cvt_pk_bf16_f32 v97, v102, v103
    v_cvt_pk_bf16_f32 v98, v104, v105
    v_cvt_pk_bf16_f32 v99, v106, v107
    buffer_store_dwordx4 v[96:99], v13, s[4:7], s47 offen offset:2048 sc1
    v_accvgpr_read_b32 v112, a148
    v_accvgpr_read_b32 v113, a149
    v_accvgpr_read_b32 v114, a150
    v_accvgpr_read_b32 v115, a151
    v_accvgpr_read_b32 v116, a156
    v_accvgpr_read_b32 v117, a157
    v_accvgpr_read_b32 v118, a158
    v_accvgpr_read_b32 v119, a159
    v_cvt_pk_bf16_f32 v108, v112, v113
    v_cvt_pk_bf16_f32 v109, v114, v115
    v_cvt_pk_bf16_f32 v110, v116, v117
    v_cvt_pk_bf16_f32 v111, v118, v119
    v_lshlrev_b32 v112, 16, v108
    v_and_b32 v113, 0xffff0000, v108
    v_lshlrev_b32 v114, 16, v109
    v_and_b32 v115, 0xffff0000, v109
    v_lshlrev_b32 v116, 16, v110
    v_and_b32 v117, 0xffff0000, v110
    v_lshlrev_b32 v118, 16, v111
    v_and_b32 v119, 0xffff0000, v111
    v_add_f32 v112, v112, v148
    v_add_f32 v113, v113, v149
    v_add_f32 v114, v114, v150
    v_add_f32 v115, v115, v151
    v_add_f32 v116, v116, v156
    v_add_f32 v117, v117, v157
    v_add_f32 v118, v118, v158
    v_add_f32 v119, v119, v159
    v_cvt_pk_bf16_f32 v108, v112, v113
    v_cvt_pk_bf16_f32 v109, v114, v115
    v_cvt_pk_bf16_f32 v110, v116, v117
    v_cvt_pk_bf16_f32 v111, v118, v119
    v_lshlrev_b32 v112, 16, v108
    v_and_b32 v113, 0xffff0000, v108
    v_lshlrev_b32 v114, 16, v109
    v_and_b32 v115, 0xffff0000, v109
    v_lshlrev_b32 v116, 16, v110
    v_and_b32 v117, 0xffff0000, v110
    v_lshlrev_b32 v118, 16, v111
    v_and_b32 v119, 0xffff0000, v111
    v_max_f32 v112, 0, v112
    v_max_f32 v113, 0, v113
    v_max_f32 v114, 0, v114
    v_max_f32 v115, 0, v115
    v_max_f32 v116, 0, v116
    v_max_f32 v117, 0, v117
    v_max_f32 v118, 0, v118
    v_max_f32 v119, 0, v119
    v_mul_f32 v112, v112, v112
    v_mul_f32 v113, v113, v113
    v_mul_f32 v114, v114, v114
    v_mul_f32 v115, v115, v115
    v_mul_f32 v116, v116, v116
    v_mul_f32 v117, v117, v117
    v_mul_f32 v118, v118, v118
    v_mul_f32 v119, v119, v119
    v_cvt_pk_bf16_f32 v108, v112, v113
    v_cvt_pk_bf16_f32 v109, v114, v115
    v_cvt_pk_bf16_f32 v110, v116, v117
    v_cvt_pk_bf16_f32 v111, v118, v119
    buffer_store_dwordx4 v[108:111], v13, s[4:7], s47 offen offset:3072 sc1
    s_add_u32 s47, s45, 233472
    v_accvgpr_read_b32 v100, a160
    v_accvgpr_read_b32 v101, a161
    v_accvgpr_read_b32 v102, a162
    v_accvgpr_read_b32 v103, a163
    v_accvgpr_read_b32 v104, a168
    v_accvgpr_read_b32 v105, a169
    v_accvgpr_read_b32 v106, a170
    v_accvgpr_read_b32 v107, a171
    v_cvt_pk_bf16_f32 v96, v100, v101
    v_cvt_pk_bf16_f32 v97, v102, v103
    v_cvt_pk_bf16_f32 v98, v104, v105
    v_cvt_pk_bf16_f32 v99, v106, v107
    v_lshlrev_b32 v100, 16, v96
    v_and_b32 v101, 0xffff0000, v96
    v_lshlrev_b32 v102, 16, v97
    v_and_b32 v103, 0xffff0000, v97
    v_lshlrev_b32 v104, 16, v98
    v_and_b32 v105, 0xffff0000, v98
    v_lshlrev_b32 v106, 16, v99
    v_and_b32 v107, 0xffff0000, v99
    v_add_f32 v100, v100, v160
    v_add_f32 v101, v101, v161
    v_add_f32 v102, v102, v162
    v_add_f32 v103, v103, v163
    v_add_f32 v104, v104, v168
    v_add_f32 v105, v105, v169
    v_add_f32 v106, v106, v170
    v_add_f32 v107, v107, v171
    v_cvt_pk_bf16_f32 v96, v100, v101
    v_cvt_pk_bf16_f32 v97, v102, v103
    v_cvt_pk_bf16_f32 v98, v104, v105
    v_cvt_pk_bf16_f32 v99, v106, v107
    v_lshlrev_b32 v100, 16, v96
    v_and_b32 v101, 0xffff0000, v96
    v_lshlrev_b32 v102, 16, v97
    v_and_b32 v103, 0xffff0000, v97
    v_lshlrev_b32 v104, 16, v98
    v_and_b32 v105, 0xffff0000, v98
    v_lshlrev_b32 v106, 16, v99
    v_and_b32 v107, 0xffff0000, v99
    v_max_f32 v100, 0, v100
    v_max_f32 v101, 0, v101
    v_max_f32 v102, 0, v102
    v_max_f32 v103, 0, v103
    v_max_f32 v104, 0, v104
    v_max_f32 v105, 0, v105
    v_max_f32 v106, 0, v106
    v_max_f32 v107, 0, v107
    v_mul_f32 v100, v100, v100
    v_mul_f32 v101, v101, v101
    v_mul_f32 v102, v102, v102
    v_mul_f32 v103, v103, v103
    v_mul_f32 v104, v104, v104
    v_mul_f32 v105, v105, v105
    v_mul_f32 v106, v106, v106
    v_mul_f32 v107, v107, v107
    v_cvt_pk_bf16_f32 v96, v100, v101
    v_cvt_pk_bf16_f32 v97, v102, v103
    v_cvt_pk_bf16_f32 v98, v104, v105
    v_cvt_pk_bf16_f32 v99, v106, v107
    buffer_store_dwordx4 v[96:99], v13, s[4:7], s47 offen offset:0 sc1
    v_accvgpr_read_b32 v112, a164
    v_accvgpr_read_b32 v113, a165
    v_accvgpr_read_b32 v114, a166
    v_accvgpr_read_b32 v115, a167
    v_accvgpr_read_b32 v116, a172
    v_accvgpr_read_b32 v117, a173
    v_accvgpr_read_b32 v118, a174
    v_accvgpr_read_b32 v119, a175
    v_cvt_pk_bf16_f32 v108, v112, v113
    v_cvt_pk_bf16_f32 v109, v114, v115
    v_cvt_pk_bf16_f32 v110, v116, v117
    v_cvt_pk_bf16_f32 v111, v118, v119
    v_lshlrev_b32 v112, 16, v108
    v_and_b32 v113, 0xffff0000, v108
    v_lshlrev_b32 v114, 16, v109
    v_and_b32 v115, 0xffff0000, v109
    v_lshlrev_b32 v116, 16, v110
    v_and_b32 v117, 0xffff0000, v110
    v_lshlrev_b32 v118, 16, v111
    v_and_b32 v119, 0xffff0000, v111
    v_add_f32 v112, v112, v164
    v_add_f32 v113, v113, v165
    v_add_f32 v114, v114, v166
    v_add_f32 v115, v115, v167
    v_add_f32 v116, v116, v172
    v_add_f32 v117, v117, v173
    v_add_f32 v118, v118, v174
    v_add_f32 v119, v119, v175
    v_cvt_pk_bf16_f32 v108, v112, v113
    v_cvt_pk_bf16_f32 v109, v114, v115
    v_cvt_pk_bf16_f32 v110, v116, v117
    v_cvt_pk_bf16_f32 v111, v118, v119
    v_lshlrev_b32 v112, 16, v108
    v_and_b32 v113, 0xffff0000, v108
    v_lshlrev_b32 v114, 16, v109
    v_and_b32 v115, 0xffff0000, v109
    v_lshlrev_b32 v116, 16, v110
    v_and_b32 v117, 0xffff0000, v110
    v_lshlrev_b32 v118, 16, v111
    v_and_b32 v119, 0xffff0000, v111
    v_max_f32 v112, 0, v112
    v_max_f32 v113, 0, v113
    v_max_f32 v114, 0, v114
    v_max_f32 v115, 0, v115
    v_max_f32 v116, 0, v116
    v_max_f32 v117, 0, v117
    v_max_f32 v118, 0, v118
    v_max_f32 v119, 0, v119
    v_mul_f32 v112, v112, v112
    v_mul_f32 v113, v113, v113
    v_mul_f32 v114, v114, v114
    v_mul_f32 v115, v115, v115
    v_mul_f32 v116, v116, v116
    v_mul_f32 v117, v117, v117
    v_mul_f32 v118, v118, v118
    v_mul_f32 v119, v119, v119
    v_cvt_pk_bf16_f32 v108, v112, v113
    v_cvt_pk_bf16_f32 v109, v114, v115
    v_cvt_pk_bf16_f32 v110, v116, v117
    v_cvt_pk_bf16_f32 v111, v118, v119
    buffer_store_dwordx4 v[108:111], v13, s[4:7], s47 offen offset:1024 sc1
    v_accvgpr_read_b32 v100, a176
    v_accvgpr_read_b32 v101, a177
    v_accvgpr_read_b32 v102, a178
    v_accvgpr_read_b32 v103, a179
    v_accvgpr_read_b32 v104, a184
    v_accvgpr_read_b32 v105, a185
    v_accvgpr_read_b32 v106, a186
    v_accvgpr_read_b32 v107, a187
    v_cvt_pk_bf16_f32 v96, v100, v101
    v_cvt_pk_bf16_f32 v97, v102, v103
    v_cvt_pk_bf16_f32 v98, v104, v105
    v_cvt_pk_bf16_f32 v99, v106, v107
    v_lshlrev_b32 v100, 16, v96
    v_and_b32 v101, 0xffff0000, v96
    v_lshlrev_b32 v102, 16, v97
    v_and_b32 v103, 0xffff0000, v97
    v_lshlrev_b32 v104, 16, v98
    v_and_b32 v105, 0xffff0000, v98
    v_lshlrev_b32 v106, 16, v99
    v_and_b32 v107, 0xffff0000, v99
    v_add_f32 v100, v100, v176
    v_add_f32 v101, v101, v177
    v_add_f32 v102, v102, v178
    v_add_f32 v103, v103, v179
    v_add_f32 v104, v104, v184
    v_add_f32 v105, v105, v185
    v_add_f32 v106, v106, v186
    v_add_f32 v107, v107, v187
    v_cvt_pk_bf16_f32 v96, v100, v101
    v_cvt_pk_bf16_f32 v97, v102, v103
    v_cvt_pk_bf16_f32 v98, v104, v105
    v_cvt_pk_bf16_f32 v99, v106, v107
    v_lshlrev_b32 v100, 16, v96
    v_and_b32 v101, 0xffff0000, v96
    v_lshlrev_b32 v102, 16, v97
    v_and_b32 v103, 0xffff0000, v97
    v_lshlrev_b32 v104, 16, v98
    v_and_b32 v105, 0xffff0000, v98
    v_lshlrev_b32 v106, 16, v99
    v_and_b32 v107, 0xffff0000, v99
    v_max_f32 v100, 0, v100
    v_max_f32 v101, 0, v101
    v_max_f32 v102, 0, v102
    v_max_f32 v103, 0, v103
    v_max_f32 v104, 0, v104
    v_max_f32 v105, 0, v105
    v_max_f32 v106, 0, v106
    v_max_f32 v107, 0, v107
    v_mul_f32 v100, v100, v100
    v_mul_f32 v101, v101, v101
    v_mul_f32 v102, v102, v102
    v_mul_f32 v103, v103, v103
    v_mul_f32 v104, v104, v104
    v_mul_f32 v105, v105, v105
    v_mul_f32 v106, v106, v106
    v_mul_f32 v107, v107, v107
    v_cvt_pk_bf16_f32 v96, v100, v101
    v_cvt_pk_bf16_f32 v97, v102, v103
    v_cvt_pk_bf16_f32 v98, v104, v105
    v_cvt_pk_bf16_f32 v99, v106, v107
    buffer_store_dwordx4 v[96:99], v13, s[4:7], s47 offen offset:2048 sc1
    v_accvgpr_read_b32 v112, a180
    v_accvgpr_read_b32 v113, a181
    v_accvgpr_read_b32 v114, a182
    v_accvgpr_read_b32 v115, a183
    v_accvgpr_read_b32 v116, a188
    v_accvgpr_read_b32 v117, a189
    v_accvgpr_read_b32 v118, a190
    v_accvgpr_read_b32 v119, a191
    v_cvt_pk_bf16_f32 v108, v112, v113
    v_cvt_pk_bf16_f32 v109, v114, v115
    v_cvt_pk_bf16_f32 v110, v116, v117
    v_cvt_pk_bf16_f32 v111, v118, v119
    v_lshlrev_b32 v112, 16, v108
    v_and_b32 v113, 0xffff0000, v108
    v_lshlrev_b32 v114, 16, v109
    v_and_b32 v115, 0xffff0000, v109
    v_lshlrev_b32 v116, 16, v110
    v_and_b32 v117, 0xffff0000, v110
    v_lshlrev_b32 v118, 16, v111
    v_and_b32 v119, 0xffff0000, v111
    v_add_f32 v112, v112, v180
    v_add_f32 v113, v113, v181
    v_add_f32 v114, v114, v182
    v_add_f32 v115, v115, v183
    v_add_f32 v116, v116, v188
    v_add_f32 v117, v117, v189
    v_add_f32 v118, v118, v190
    v_add_f32 v119, v119, v191
    v_cvt_pk_bf16_f32 v108, v112, v113
    v_cvt_pk_bf16_f32 v109, v114, v115
    v_cvt_pk_bf16_f32 v110, v116, v117
    v_cvt_pk_bf16_f32 v111, v118, v119
    v_lshlrev_b32 v112, 16, v108
    v_and_b32 v113, 0xffff0000, v108
    v_lshlrev_b32 v114, 16, v109
    v_and_b32 v115, 0xffff0000, v109
    v_lshlrev_b32 v116, 16, v110
    v_and_b32 v117, 0xffff0000, v110
    v_lshlrev_b32 v118, 16, v111
    v_and_b32 v119, 0xffff0000, v111
    v_max_f32 v112, 0, v112
    v_max_f32 v113, 0, v113
    v_max_f32 v114, 0, v114
    v_max_f32 v115, 0, v115
    v_max_f32 v116, 0, v116
    v_max_f32 v117, 0, v117
    v_max_f32 v118, 0, v118
    v_max_f32 v119, 0, v119
    v_mul_f32 v112, v112, v112
    v_mul_f32 v113, v113, v113
    v_mul_f32 v114, v114, v114
    v_mul_f32 v115, v115, v115
    v_mul_f32 v116, v116, v116
    v_mul_f32 v117, v117, v117
    v_mul_f32 v118, v118, v118
    v_mul_f32 v119, v119, v119
    v_cvt_pk_bf16_f32 v108, v112, v113
    v_cvt_pk_bf16_f32 v109, v114, v115
    v_cvt_pk_bf16_f32 v110, v116, v117
    v_cvt_pk_bf16_f32 v111, v118, v119
    buffer_store_dwordx4 v[108:111], v13, s[4:7], s47 offen offset:3072 sc1
    s_add_u32 s47, s45, 344064
    v_accvgpr_read_b32 v100, a192
    v_accvgpr_read_b32 v101, a193
    v_accvgpr_read_b32 v102, a194
    v_accvgpr_read_b32 v103, a195
    v_accvgpr_read_b32 v104, a200
    v_accvgpr_read_b32 v105, a201
    v_accvgpr_read_b32 v106, a202
    v_accvgpr_read_b32 v107, a203
    v_cvt_pk_bf16_f32 v96, v100, v101
    v_cvt_pk_bf16_f32 v97, v102, v103
    v_cvt_pk_bf16_f32 v98, v104, v105
    v_cvt_pk_bf16_f32 v99, v106, v107
    v_lshlrev_b32 v100, 16, v96
    v_and_b32 v101, 0xffff0000, v96
    v_lshlrev_b32 v102, 16, v97
    v_and_b32 v103, 0xffff0000, v97
    v_lshlrev_b32 v104, 16, v98
    v_and_b32 v105, 0xffff0000, v98
    v_lshlrev_b32 v106, 16, v99
    v_and_b32 v107, 0xffff0000, v99
    v_add_f32 v100, v100, v128
    v_add_f32 v101, v101, v129
    v_add_f32 v102, v102, v130
    v_add_f32 v103, v103, v131
    v_add_f32 v104, v104, v136
    v_add_f32 v105, v105, v137
    v_add_f32 v106, v106, v138
    v_add_f32 v107, v107, v139
    v_cvt_pk_bf16_f32 v96, v100, v101
    v_cvt_pk_bf16_f32 v97, v102, v103
    v_cvt_pk_bf16_f32 v98, v104, v105
    v_cvt_pk_bf16_f32 v99, v106, v107
    v_lshlrev_b32 v100, 16, v96
    v_and_b32 v101, 0xffff0000, v96
    v_lshlrev_b32 v102, 16, v97
    v_and_b32 v103, 0xffff0000, v97
    v_lshlrev_b32 v104, 16, v98
    v_and_b32 v105, 0xffff0000, v98
    v_lshlrev_b32 v106, 16, v99
    v_and_b32 v107, 0xffff0000, v99
    v_max_f32 v100, 0, v100
    v_max_f32 v101, 0, v101
    v_max_f32 v102, 0, v102
    v_max_f32 v103, 0, v103
    v_max_f32 v104, 0, v104
    v_max_f32 v105, 0, v105
    v_max_f32 v106, 0, v106
    v_max_f32 v107, 0, v107
    v_mul_f32 v100, v100, v100
    v_mul_f32 v101, v101, v101
    v_mul_f32 v102, v102, v102
    v_mul_f32 v103, v103, v103
    v_mul_f32 v104, v104, v104
    v_mul_f32 v105, v105, v105
    v_mul_f32 v106, v106, v106
    v_mul_f32 v107, v107, v107
    v_cvt_pk_bf16_f32 v96, v100, v101
    v_cvt_pk_bf16_f32 v97, v102, v103
    v_cvt_pk_bf16_f32 v98, v104, v105
    v_cvt_pk_bf16_f32 v99, v106, v107
    buffer_store_dwordx4 v[96:99], v13, s[4:7], s47 offen offset:0 sc1
    v_accvgpr_read_b32 v112, a196
    v_accvgpr_read_b32 v113, a197
    v_accvgpr_read_b32 v114, a198
    v_accvgpr_read_b32 v115, a199
    v_accvgpr_read_b32 v116, a204
    v_accvgpr_read_b32 v117, a205
    v_accvgpr_read_b32 v118, a206
    v_accvgpr_read_b32 v119, a207
    v_cvt_pk_bf16_f32 v108, v112, v113
    v_cvt_pk_bf16_f32 v109, v114, v115
    v_cvt_pk_bf16_f32 v110, v116, v117
    v_cvt_pk_bf16_f32 v111, v118, v119
    v_lshlrev_b32 v112, 16, v108
    v_and_b32 v113, 0xffff0000, v108
    v_lshlrev_b32 v114, 16, v109
    v_and_b32 v115, 0xffff0000, v109
    v_lshlrev_b32 v116, 16, v110
    v_and_b32 v117, 0xffff0000, v110
    v_lshlrev_b32 v118, 16, v111
    v_and_b32 v119, 0xffff0000, v111
    v_add_f32 v112, v112, v132
    v_add_f32 v113, v113, v133
    v_add_f32 v114, v114, v134
    v_add_f32 v115, v115, v135
    v_add_f32 v116, v116, v140
    v_add_f32 v117, v117, v141
    v_add_f32 v118, v118, v142
    v_add_f32 v119, v119, v143
    v_cvt_pk_bf16_f32 v108, v112, v113
    v_cvt_pk_bf16_f32 v109, v114, v115
    v_cvt_pk_bf16_f32 v110, v116, v117
    v_cvt_pk_bf16_f32 v111, v118, v119
    v_lshlrev_b32 v112, 16, v108
    v_and_b32 v113, 0xffff0000, v108
    v_lshlrev_b32 v114, 16, v109
    v_and_b32 v115, 0xffff0000, v109
    v_lshlrev_b32 v116, 16, v110
    v_and_b32 v117, 0xffff0000, v110
    v_lshlrev_b32 v118, 16, v111
    v_and_b32 v119, 0xffff0000, v111
    v_max_f32 v112, 0, v112
    v_max_f32 v113, 0, v113
    v_max_f32 v114, 0, v114
    v_max_f32 v115, 0, v115
    v_max_f32 v116, 0, v116
    v_max_f32 v117, 0, v117
    v_max_f32 v118, 0, v118
    v_max_f32 v119, 0, v119
    v_mul_f32 v112, v112, v112
    v_mul_f32 v113, v113, v113
    v_mul_f32 v114, v114, v114
    v_mul_f32 v115, v115, v115
    v_mul_f32 v116, v116, v116
    v_mul_f32 v117, v117, v117
    v_mul_f32 v118, v118, v118
    v_mul_f32 v119, v119, v119
    v_cvt_pk_bf16_f32 v108, v112, v113
    v_cvt_pk_bf16_f32 v109, v114, v115
    v_cvt_pk_bf16_f32 v110, v116, v117
    v_cvt_pk_bf16_f32 v111, v118, v119
    buffer_store_dwordx4 v[108:111], v13, s[4:7], s47 offen offset:1024 sc1
    v_accvgpr_read_b32 v100, a208
    v_accvgpr_read_b32 v101, a209
    v_accvgpr_read_b32 v102, a210
    v_accvgpr_read_b32 v103, a211
    v_accvgpr_read_b32 v104, a216
    v_accvgpr_read_b32 v105, a217
    v_accvgpr_read_b32 v106, a218
    v_accvgpr_read_b32 v107, a219
    v_cvt_pk_bf16_f32 v96, v100, v101
    v_cvt_pk_bf16_f32 v97, v102, v103
    v_cvt_pk_bf16_f32 v98, v104, v105
    v_cvt_pk_bf16_f32 v99, v106, v107
    v_lshlrev_b32 v100, 16, v96
    v_and_b32 v101, 0xffff0000, v96
    v_lshlrev_b32 v102, 16, v97
    v_and_b32 v103, 0xffff0000, v97
    v_lshlrev_b32 v104, 16, v98
    v_and_b32 v105, 0xffff0000, v98
    v_lshlrev_b32 v106, 16, v99
    v_and_b32 v107, 0xffff0000, v99
    v_add_f32 v100, v100, v144
    v_add_f32 v101, v101, v145
    v_add_f32 v102, v102, v146
    v_add_f32 v103, v103, v147
    v_add_f32 v104, v104, v152
    v_add_f32 v105, v105, v153
    v_add_f32 v106, v106, v154
    v_add_f32 v107, v107, v155
    v_cvt_pk_bf16_f32 v96, v100, v101
    v_cvt_pk_bf16_f32 v97, v102, v103
    v_cvt_pk_bf16_f32 v98, v104, v105
    v_cvt_pk_bf16_f32 v99, v106, v107
    v_lshlrev_b32 v100, 16, v96
    v_and_b32 v101, 0xffff0000, v96
    v_lshlrev_b32 v102, 16, v97
    v_and_b32 v103, 0xffff0000, v97
    v_lshlrev_b32 v104, 16, v98
    v_and_b32 v105, 0xffff0000, v98
    v_lshlrev_b32 v106, 16, v99
    v_and_b32 v107, 0xffff0000, v99
    v_max_f32 v100, 0, v100
    v_max_f32 v101, 0, v101
    v_max_f32 v102, 0, v102
    v_max_f32 v103, 0, v103
    v_max_f32 v104, 0, v104
    v_max_f32 v105, 0, v105
    v_max_f32 v106, 0, v106
    v_max_f32 v107, 0, v107
    v_mul_f32 v100, v100, v100
    v_mul_f32 v101, v101, v101
    v_mul_f32 v102, v102, v102
    v_mul_f32 v103, v103, v103
    v_mul_f32 v104, v104, v104
    v_mul_f32 v105, v105, v105
    v_mul_f32 v106, v106, v106
    v_mul_f32 v107, v107, v107
    v_cvt_pk_bf16_f32 v96, v100, v101
    v_cvt_pk_bf16_f32 v97, v102, v103
    v_cvt_pk_bf16_f32 v98, v104, v105
    v_cvt_pk_bf16_f32 v99, v106, v107
    buffer_store_dwordx4 v[96:99], v13, s[4:7], s47 offen offset:2048 sc1
    v_accvgpr_read_b32 v112, a212
    v_accvgpr_read_b32 v113, a213
    v_accvgpr_read_b32 v114, a214
    v_accvgpr_read_b32 v115, a215
    v_accvgpr_read_b32 v116, a220
    v_accvgpr_read_b32 v117, a221
    v_accvgpr_read_b32 v118, a222
    v_accvgpr_read_b32 v119, a223
    v_cvt_pk_bf16_f32 v108, v112, v113
    v_cvt_pk_bf16_f32 v109, v114, v115
    v_cvt_pk_bf16_f32 v110, v116, v117
    v_cvt_pk_bf16_f32 v111, v118, v119
    v_lshlrev_b32 v112, 16, v108
    v_and_b32 v113, 0xffff0000, v108
    v_lshlrev_b32 v114, 16, v109
    v_and_b32 v115, 0xffff0000, v109
    v_lshlrev_b32 v116, 16, v110
    v_and_b32 v117, 0xffff0000, v110
    v_lshlrev_b32 v118, 16, v111
    v_and_b32 v119, 0xffff0000, v111
    v_add_f32 v112, v112, v148
    v_add_f32 v113, v113, v149
    v_add_f32 v114, v114, v150
    v_add_f32 v115, v115, v151
    v_add_f32 v116, v116, v156
    v_add_f32 v117, v117, v157
    v_add_f32 v118, v118, v158
    v_add_f32 v119, v119, v159
    v_cvt_pk_bf16_f32 v108, v112, v113
    v_cvt_pk_bf16_f32 v109, v114, v115
    v_cvt_pk_bf16_f32 v110, v116, v117
    v_cvt_pk_bf16_f32 v111, v118, v119
    v_lshlrev_b32 v112, 16, v108
    v_and_b32 v113, 0xffff0000, v108
    v_lshlrev_b32 v114, 16, v109
    v_and_b32 v115, 0xffff0000, v109
    v_lshlrev_b32 v116, 16, v110
    v_and_b32 v117, 0xffff0000, v110
    v_lshlrev_b32 v118, 16, v111
    v_and_b32 v119, 0xffff0000, v111
    v_max_f32 v112, 0, v112
    v_max_f32 v113, 0, v113
    v_max_f32 v114, 0, v114
    v_max_f32 v115, 0, v115
    v_max_f32 v116, 0, v116
    v_max_f32 v117, 0, v117
    v_max_f32 v118, 0, v118
    v_max_f32 v119, 0, v119
    v_mul_f32 v112, v112, v112
    v_mul_f32 v113, v113, v113
    v_mul_f32 v114, v114, v114
    v_mul_f32 v115, v115, v115
    v_mul_f32 v116, v116, v116
    v_mul_f32 v117, v117, v117
    v_mul_f32 v118, v118, v118
    v_mul_f32 v119, v119, v119
    v_cvt_pk_bf16_f32 v108, v112, v113
    v_cvt_pk_bf16_f32 v109, v114, v115
    v_cvt_pk_bf16_f32 v110, v116, v117
    v_cvt_pk_bf16_f32 v111, v118, v119
    buffer_store_dwordx4 v[108:111], v13, s[4:7], s47 offen offset:3072 sc1
    s_add_u32 s47, s45, 348160
    v_accvgpr_read_b32 v100, a224
    v_accvgpr_read_b32 v101, a225
    v_accvgpr_read_b32 v102, a226
    v_accvgpr_read_b32 v103, a227
    v_accvgpr_read_b32 v104, a232
    v_accvgpr_read_b32 v105, a233
    v_accvgpr_read_b32 v106, a234
    v_accvgpr_read_b32 v107, a235
    v_cvt_pk_bf16_f32 v96, v100, v101
    v_cvt_pk_bf16_f32 v97, v102, v103
    v_cvt_pk_bf16_f32 v98, v104, v105
    v_cvt_pk_bf16_f32 v99, v106, v107
    v_lshlrev_b32 v100, 16, v96
    v_and_b32 v101, 0xffff0000, v96
    v_lshlrev_b32 v102, 16, v97
    v_and_b32 v103, 0xffff0000, v97
    v_lshlrev_b32 v104, 16, v98
    v_and_b32 v105, 0xffff0000, v98
    v_lshlrev_b32 v106, 16, v99
    v_and_b32 v107, 0xffff0000, v99
    v_add_f32 v100, v100, v160
    v_add_f32 v101, v101, v161
    v_add_f32 v102, v102, v162
    v_add_f32 v103, v103, v163
    v_add_f32 v104, v104, v168
    v_add_f32 v105, v105, v169
    v_add_f32 v106, v106, v170
    v_add_f32 v107, v107, v171
    v_cvt_pk_bf16_f32 v96, v100, v101
    v_cvt_pk_bf16_f32 v97, v102, v103
    v_cvt_pk_bf16_f32 v98, v104, v105
    v_cvt_pk_bf16_f32 v99, v106, v107
    v_lshlrev_b32 v100, 16, v96
    v_and_b32 v101, 0xffff0000, v96
    v_lshlrev_b32 v102, 16, v97
    v_and_b32 v103, 0xffff0000, v97
    v_lshlrev_b32 v104, 16, v98
    v_and_b32 v105, 0xffff0000, v98
    v_lshlrev_b32 v106, 16, v99
    v_and_b32 v107, 0xffff0000, v99
    v_max_f32 v100, 0, v100
    v_max_f32 v101, 0, v101
    v_max_f32 v102, 0, v102
    v_max_f32 v103, 0, v103
    v_max_f32 v104, 0, v104
    v_max_f32 v105, 0, v105
    v_max_f32 v106, 0, v106
    v_max_f32 v107, 0, v107
    v_mul_f32 v100, v100, v100
    v_mul_f32 v101, v101, v101
    v_mul_f32 v102, v102, v102
    v_mul_f32 v103, v103, v103
    v_mul_f32 v104, v104, v104
    v_mul_f32 v105, v105, v105
    v_mul_f32 v106, v106, v106
    v_mul_f32 v107, v107, v107
    v_cvt_pk_bf16_f32 v96, v100, v101
    v_cvt_pk_bf16_f32 v97, v102, v103
    v_cvt_pk_bf16_f32 v98, v104, v105
    v_cvt_pk_bf16_f32 v99, v106, v107
    buffer_store_dwordx4 v[96:99], v13, s[4:7], s47 offen offset:0 sc1
    v_accvgpr_read_b32 v112, a228
    v_accvgpr_read_b32 v113, a229
    v_accvgpr_read_b32 v114, a230
    v_accvgpr_read_b32 v115, a231
    v_accvgpr_read_b32 v116, a236
    v_accvgpr_read_b32 v117, a237
    v_accvgpr_read_b32 v118, a238
    v_accvgpr_read_b32 v119, a239
    v_cvt_pk_bf16_f32 v108, v112, v113
    v_cvt_pk_bf16_f32 v109, v114, v115
    v_cvt_pk_bf16_f32 v110, v116, v117
    v_cvt_pk_bf16_f32 v111, v118, v119
    v_lshlrev_b32 v112, 16, v108
    v_and_b32 v113, 0xffff0000, v108
    v_lshlrev_b32 v114, 16, v109
    v_and_b32 v115, 0xffff0000, v109
    v_lshlrev_b32 v116, 16, v110
    v_and_b32 v117, 0xffff0000, v110
    v_lshlrev_b32 v118, 16, v111
    v_and_b32 v119, 0xffff0000, v111
    v_add_f32 v112, v112, v164
    v_add_f32 v113, v113, v165
    v_add_f32 v114, v114, v166
    v_add_f32 v115, v115, v167
    v_add_f32 v116, v116, v172
    v_add_f32 v117, v117, v173
    v_add_f32 v118, v118, v174
    v_add_f32 v119, v119, v175
    v_cvt_pk_bf16_f32 v108, v112, v113
    v_cvt_pk_bf16_f32 v109, v114, v115
    v_cvt_pk_bf16_f32 v110, v116, v117
    v_cvt_pk_bf16_f32 v111, v118, v119
    v_lshlrev_b32 v112, 16, v108
    v_and_b32 v113, 0xffff0000, v108
    v_lshlrev_b32 v114, 16, v109
    v_and_b32 v115, 0xffff0000, v109
    v_lshlrev_b32 v116, 16, v110
    v_and_b32 v117, 0xffff0000, v110
    v_lshlrev_b32 v118, 16, v111
    v_and_b32 v119, 0xffff0000, v111
    v_max_f32 v112, 0, v112
    v_max_f32 v113, 0, v113
    v_max_f32 v114, 0, v114
    v_max_f32 v115, 0, v115
    v_max_f32 v116, 0, v116
    v_max_f32 v117, 0, v117
    v_max_f32 v118, 0, v118
    v_max_f32 v119, 0, v119
    v_mul_f32 v112, v112, v112
    v_mul_f32 v113, v113, v113
    v_mul_f32 v114, v114, v114
    v_mul_f32 v115, v115, v115
    v_mul_f32 v116, v116, v116
    v_mul_f32 v117, v117, v117
    v_mul_f32 v118, v118, v118
    v_mul_f32 v119, v119, v119
    v_cvt_pk_bf16_f32 v108, v112, v113
    v_cvt_pk_bf16_f32 v109, v114, v115
    v_cvt_pk_bf16_f32 v110, v116, v117
    v_cvt_pk_bf16_f32 v111, v118, v119
    buffer_store_dwordx4 v[108:111], v13, s[4:7], s47 offen offset:1024 sc1
    v_accvgpr_read_b32 v100, a240
    v_accvgpr_read_b32 v101, a241
    v_accvgpr_read_b32 v102, a242
    v_accvgpr_read_b32 v103, a243
    v_accvgpr_read_b32 v104, a248
    v_accvgpr_read_b32 v105, a249
    v_accvgpr_read_b32 v106, a250
    v_accvgpr_read_b32 v107, a251
    v_cvt_pk_bf16_f32 v96, v100, v101
    v_cvt_pk_bf16_f32 v97, v102, v103
    v_cvt_pk_bf16_f32 v98, v104, v105
    v_cvt_pk_bf16_f32 v99, v106, v107
    v_lshlrev_b32 v100, 16, v96
    v_and_b32 v101, 0xffff0000, v96
    v_lshlrev_b32 v102, 16, v97
    v_and_b32 v103, 0xffff0000, v97
    v_lshlrev_b32 v104, 16, v98
    v_and_b32 v105, 0xffff0000, v98
    v_lshlrev_b32 v106, 16, v99
    v_and_b32 v107, 0xffff0000, v99
    v_add_f32 v100, v100, v176
    v_add_f32 v101, v101, v177
    v_add_f32 v102, v102, v178
    v_add_f32 v103, v103, v179
    v_add_f32 v104, v104, v184
    v_add_f32 v105, v105, v185
    v_add_f32 v106, v106, v186
    v_add_f32 v107, v107, v187
    v_cvt_pk_bf16_f32 v96, v100, v101
    v_cvt_pk_bf16_f32 v97, v102, v103
    v_cvt_pk_bf16_f32 v98, v104, v105
    v_cvt_pk_bf16_f32 v99, v106, v107
    v_lshlrev_b32 v100, 16, v96
    v_and_b32 v101, 0xffff0000, v96
    v_lshlrev_b32 v102, 16, v97
    v_and_b32 v103, 0xffff0000, v97
    v_lshlrev_b32 v104, 16, v98
    v_and_b32 v105, 0xffff0000, v98
    v_lshlrev_b32 v106, 16, v99
    v_and_b32 v107, 0xffff0000, v99
    v_max_f32 v100, 0, v100
    v_max_f32 v101, 0, v101
    v_max_f32 v102, 0, v102
    v_max_f32 v103, 0, v103
    v_max_f32 v104, 0, v104
    v_max_f32 v105, 0, v105
    v_max_f32 v106, 0, v106
    v_max_f32 v107, 0, v107
    v_mul_f32 v100, v100, v100
    v_mul_f32 v101, v101, v101
    v_mul_f32 v102, v102, v102
    v_mul_f32 v103, v103, v103
    v_mul_f32 v104, v104, v104
    v_mul_f32 v105, v105, v105
    v_mul_f32 v106, v106, v106
    v_mul_f32 v107, v107, v107
    v_cvt_pk_bf16_f32 v96, v100, v101
    v_cvt_pk_bf16_f32 v97, v102, v103
    v_cvt_pk_bf16_f32 v98, v104, v105
    v_cvt_pk_bf16_f32 v99, v106, v107
    buffer_store_dwordx4 v[96:99], v13, s[4:7], s47 offen offset:2048 sc1
    v_accvgpr_read_b32 v112, a244
    v_accvgpr_read_b32 v113, a245
    v_accvgpr_read_b32 v114, a246
    v_accvgpr_read_b32 v115, a247
    v_accvgpr_read_b32 v116, a252
    v_accvgpr_read_b32 v117, a253
    v_accvgpr_read_b32 v118, a254
    v_accvgpr_read_b32 v119, a255
    v_cvt_pk_bf16_f32 v108, v112, v113
    v_cvt_pk_bf16_f32 v109, v114, v115
    v_cvt_pk_bf16_f32 v110, v116, v117
    v_cvt_pk_bf16_f32 v111, v118, v119
    v_lshlrev_b32 v112, 16, v108
    v_and_b32 v113, 0xffff0000, v108
    v_lshlrev_b32 v114, 16, v109
    v_and_b32 v115, 0xffff0000, v109
    v_lshlrev_b32 v116, 16, v110
    v_and_b32 v117, 0xffff0000, v110
    v_lshlrev_b32 v118, 16, v111
    v_and_b32 v119, 0xffff0000, v111
    v_add_f32 v112, v112, v180
    v_add_f32 v113, v113, v181
    v_add_f32 v114, v114, v182
    v_add_f32 v115, v115, v183
    v_add_f32 v116, v116, v188
    v_add_f32 v117, v117, v189
    v_add_f32 v118, v118, v190
    v_add_f32 v119, v119, v191
    v_cvt_pk_bf16_f32 v108, v112, v113
    v_cvt_pk_bf16_f32 v109, v114, v115
    v_cvt_pk_bf16_f32 v110, v116, v117
    v_cvt_pk_bf16_f32 v111, v118, v119
    v_lshlrev_b32 v112, 16, v108
    v_and_b32 v113, 0xffff0000, v108
    v_lshlrev_b32 v114, 16, v109
    v_and_b32 v115, 0xffff0000, v109
    v_lshlrev_b32 v116, 16, v110
    v_and_b32 v117, 0xffff0000, v110
    v_lshlrev_b32 v118, 16, v111
    v_and_b32 v119, 0xffff0000, v111
    v_max_f32 v112, 0, v112
    v_max_f32 v113, 0, v113
    v_max_f32 v114, 0, v114
    v_max_f32 v115, 0, v115
    v_max_f32 v116, 0, v116
    v_max_f32 v117, 0, v117
    v_max_f32 v118, 0, v118
    v_max_f32 v119, 0, v119
    v_mul_f32 v112, v112, v112
    v_mul_f32 v113, v113, v113
    v_mul_f32 v114, v114, v114
    v_mul_f32 v115, v115, v115
    v_mul_f32 v116, v116, v116
    v_mul_f32 v117, v117, v117
    v_mul_f32 v118, v118, v118
    v_mul_f32 v119, v119, v119
    v_cvt_pk_bf16_f32 v108, v112, v113
    v_cvt_pk_bf16_f32 v109, v114, v115
    v_cvt_pk_bf16_f32 v110, v116, v117
    v_cvt_pk_bf16_f32 v111, v118, v119
    buffer_store_dwordx4 v[108:111], v13, s[4:7], s47 offen offset:3072 sc1
L_sa_done:
    s_cmp_lt_u32 s40, 96
    s_cselect_b32 s47, 36, 37
    s_add_u32 s48, s41, 8
    s_cmp_lt_u32 s40, 256
    s_cselect_b32 s47, s47, s48
    s_lshl_b32 s47, s47, 2
    v_mov_b32 v14, s47
    v_mov_b32 v15, 1
    s_waitcnt vmcnt(0)
    s_barrier
    s_cmp_lg_u32 s16, 0
    s_cbranch_scc1 L_w_nosig
    s_mov_b64 exec, 1
    buffer_atomic_add v15, v14, s[8:11], 0 offen
    s_mov_b64 exec, -1
L_w_nosig:
    s_add_u32 s40, s40, s53
    s_cmp_lt_u32 s40, 440
    s_cbranch_scc1 L_sa_tile
    v_and_b32 v1, 63, v0
    v_lshlrev_b32 v2, 4, v1
    v_bfe_u32 v13, v1, 4, 1
    v_lshlrev_b32 v3, 10, v13
    v_lshrrev_b32 v14, 5, v1
    v_lshl_add_u32 v3, v14, 8, v3
    v_and_b32 v15, 15, v1
    v_lshl_add_u32 v3, v15, 4, v3
    v_bfe_u32 v16, v1, 2, 2
    v_lshl_add_u32 v16, v14, 2, v16
    v_lshlrev_b32 v4, 6, v16
    v_lshl_add_u32 v4, v13, 5, v4
    v_and_b32 v5, 3, v1
    v_lshl_add_u32 v4, v5, 3, v4
    s_lshl_b32 s82, s16, 12
    s_add_u32 s82, s82, 114688
    v_and_b32 v6, 1, v1
    v_lshlrev_b32 v6, 3, v6
    v_lshl_add_u32 v6, v16, 4, v6
    v_add_u32 v6, s82, v6
    v_lshrrev_b32 v5, 4, v1
    v_lshlrev_b32 v5, 2, v5
    v_lshl_add_u32 v5, v15, 4, v5
    v_add_u32 v5, s82, v5
    v_and_b32 v15, 31, v1
    v_lshlrev_b32 v7, 4, v15
    v_lshl_add_u32 v7, v14, 3, v7
    s_and_b32 s83, s16, 1
    s_lshl_b32 s83, s83, 10
    s_add_u32 s82, s82, s83
    s_add_u32 s82, s82, 2048
    v_add_u32 v7, s82, v7
    v_and_b32 v16, 7, v1
    v_xor_b32 v16, v16, v14
    v_lshlrev_b32 v8, 4, v16
    v_lshl_add_u32 v8, v15, 7, v8
    s_lshl_b32 s82, s16, 13
    s_add_u32 s82, s82, 131072
    v_add_u32 v8, s82, v8
    v_lshrrev_b32 v13, 3, v0
    v_and_b32 v16, 7, v0
    v_and_b32 v9, 7, v13
    v_xor_b32 v9, v9, v16
    v_lshlrev_b32 v9, 4, v9
    v_lshl_add_u32 v9, v13, 7, v9
    v_add_u32 v9, 131072, v9
    v_lshlrev_b32 v10, 10, v13
    v_lshl_add_u32 v11, v16, 3, v10
    v_lshl_add_u32 v10, v16, 4, v10
    s_lshl_b32 s82, s78, 6
    v_lshlrev_b32 v16, 3, v16
    buffer_load_dwordx2 v[22:23], v16, s[64:67], s82 offen
    s_mov_b32 s86, 0x3e0293ee
    s_mov_b32 s87, 0xbfb8aa3b
    s_lshr_b32 s81, s16, 1
    s_lshl_b32 s82, s78, 1
    s_add_u32 s81, s81, s82
    s_mov_b32 s89, 0
    v_lshlrev_b32 v14, 2, v14
    v_mov_b32 v13, 0xf149f2ca
    v_add_u32 v16, 0, v14
    v_cmp_gt_u32 vcc, v16, v15
    s_nop 1
    v_cndmask_b32 v24, 0, v13, vcc
    v_add_u32 v16, 1, v14
    v_cmp_gt_u32 vcc, v16, v15
    s_nop 1
    v_cndmask_b32 v25, 0, v13, vcc
    v_add_u32 v16, 2, v14
    v_cmp_gt_u32 vcc, v16, v15
    s_nop 1
    v_cndmask_b32 v26, 0, v13, vcc
    v_add_u32 v16, 3, v14
    v_cmp_gt_u32 vcc, v16, v15
    s_nop 1
    v_cndmask_b32 v27, 0, v13, vcc
    v_add_u32 v16, 8, v14
    v_cmp_gt_u32 vcc, v16, v15
    s_nop 1
    v_cndmask_b32 v28, 0, v13, vcc
    v_add_u32 v16, 9, v14
    v_cmp_gt_u32 vcc, v16, v15
    s_nop 1
    v_cndmask_b32 v29, 0, v13, vcc
    v_add_u32 v16, 10, v14
    v_cmp_gt_u32 vcc, v16, v15
    s_nop 1
    v_cndmask_b32 v30, 0, v13, vcc
    v_add_u32 v16, 11, v14
    v_cmp_gt_u32 vcc, v16, v15
    s_nop 1
    v_cndmask_b32 v31, 0, v13, vcc
    v_add_u32 v16, 16, v14
    v_cmp_gt_u32 vcc, v16, v15
    s_nop 1
    v_cndmask_b32 v32, 0, v13, vcc
    v_add_u32 v16, 17, v14
    v_cmp_gt_u32 vcc, v16, v15
    s_nop 1
    v_cndmask_b32 v33, 0, v13, vcc
    v_add_u32 v16, 18, v14
    v_cmp_gt_u32 vcc, v16, v15
    s_nop 1
    v_cndmask_b32 v34, 0, v13, vcc
    v_add_u32 v16, 19, v14
    v_cmp_gt_u32 vcc, v16, v15
    s_nop 1
    v_cndmask_b32 v35, 0, v13, vcc
    v_add_u32 v16, 24, v14
    v_cmp_gt_u32 vcc, v16, v15
    s_nop 1
    v_cndmask_b32 v36, 0, v13, vcc
    v_add_u32 v16, 25, v14
    v_cmp_gt_u32 vcc, v16, v15
    s_nop 1
    v_cndmask_b32 v37, 0, v13, vcc
    v_add_u32 v16, 26, v14
    v_cmp_gt_u32 vcc, v16, v15
    s_nop 1
    v_cndmask_b32 v38, 0, v13, vcc
    v_add_u32 v16, 27, v14
    v_cmp_gt_u32 vcc, v16, v15
    s_nop 1
    v_cndmask_b32 v39, 0, v13, vcc
    s_waitcnt vmcnt(0)
    v_lshlrev_b32 v18, 16, v22
    v_and_b32 v19, 0xffff0000, v22
    v_lshlrev_b32 v20, 16, v23
    v_and_b32 v21, 0xffff0000, v23
    s_barrier
    v_lshrrev_b32 v13, 2, v1
    v_lshlrev_b32 v13, 10, v13
    v_and_b32 v14, 3, v1
    v_lshl_add_u32 v13, v14, 4, v13
    s_lshl_b32 s82, s78, 6
    v_add_u32 v13, s82, v13
    s_mul_i32 s88, s16, 40960
    s_lshl_b32 s84, s16, 20
    v_add_u32 v14, s88, v4
    s_add_u32 m0, s88, 0
    s_add_u32 s82, s84, 0
    buffer_load_dwordx4 v13, s[56:59], s82 offen lds
    s_add_u32 m0, s88, 1024
    s_add_u32 s82, s84, 16384
    buffer_load_dwordx4 v13, s[56:59], s82 offen lds
    s_add_u32 m0, s88, 2048
    s_add_u32 s82, s84, 32768
    buffer_load_dwordx4 v13, s[56:59], s82 offen lds
    s_add_u32 m0, s88, 3072
    s_add_u32 s82, s84, 49152
    buffer_load_dwordx4 v13, s[56:59], s82 offen lds
    s_add_u32 m0, s88, 4096
    s_add_u32 s82, s84, 65536
    buffer_load_dwordx4 v13, s[56:59], s82 offen lds
    s_add_u32 m0, s88, 5120
    s_add_u32 s82, s84, 81920
    buffer_load_dwordx4 v13, s[56:59], s82 offen lds
    s_add_u32 m0, s88, 6144
    s_add_u32 s82, s84, 98304
    buffer_load_dwordx4 v13, s[56:59], s82 offen lds
    s_add_u32 m0, s88, 7168
    s_add_u32 s82, s84, 114688
    buffer_load_dwordx4 v13, s[56:59], s82 offen lds
    s_add_u32 m0, s88, 8192
    s_add_u32 s82, s84, 131072
    buffer_load_dwordx4 v13, s[56:59], s82 offen lds
    s_add_u32 m0, s88, 9216
    s_add_u32 s82, s84, 147456
    buffer_load_dwordx4 v13, s[56:59], s82 offen lds
    s_add_u32 m0, s88, 10240
    s_add_u32 s82, s84, 163840
    buffer_load_dwordx4 v13, s[56:59], s82 offen lds
    s_add_u32 m0, s88, 11264
    s_add_u32 s82, s84, 180224
    buffer_load_dwordx4 v13, s[56:59], s82 offen lds
    s_add_u32 m0, s88, 12288
    s_add_u32 s82, s84, 196608
    buffer_load_dwordx4 v13, s[56:59], s82 offen lds
    s_add_u32 m0, s88, 13312
    s_add_u32 s82, s84, 212992
    buffer_load_dwordx4 v13, s[56:59], s82 offen lds
    s_add_u32 m0, s88, 14336
    s_add_u32 s82, s84, 229376
    buffer_load_dwordx4 v13, s[56:59], s82 offen lds
    s_add_u32 m0, s88, 15360
    s_add_u32 s82, s84, 245760
    buffer_load_dwordx4 v13, s[56:59], s82 offen lds
    s_add_u32 m0, s88, 16384
    s_add_u32 s82, s84, 262144
    buffer_load_dwordx4 v13, s[56:59], s82 offen lds
    s_add_u32 m0, s88, 17408
    s_add_u32 s82, s84, 278528
    buffer_load_dwordx4 v13, s[56:59], s82 offen lds
    s_add_u32 m0, s88, 18432
    s_add_u32 s82, s84, 294912
    buffer_load_dwordx4 v13, s[56:59], s82 offen lds
    s_add_u32 m0, s88, 19456
    s_add_u32 s82, s84, 311296
    buffer_load_dwordx4 v13, s[56:59], s82 offen lds
    s_add_u32 m0, s88, 20480
    s_add_u32 s82, s84, 327680
    buffer_load_dwordx4 v13, s[56:59], s82 offen lds
    s_add_u32 m0, s88, 21504
    s_add_u32 s82, s84, 344064
    buffer_load_dwordx4 v13, s[56:59], s82 offen lds
    s_add_u32 m0, s88, 22528
    s_add_u32 s82, s84, 360448
    buffer_load_dwordx4 v13, s[56:59], s82 offen lds
    s_add_u32 m0, s88, 23552
    s_add_u32 s82, s84, 376832
    buffer_load_dwordx4 v13, s[56:59], s82 offen lds
    s_add_u32 m0, s88, 24576
    s_add_u32 s82, s84, 393216
    buffer_load_dwordx4 v13, s[56:59], s82 offen lds
    s_add_u32 m0, s88, 25600
    s_add_u32 s82, s84, 409600
    buffer_load_dwordx4 v13, s[56:59], s82 offen lds
    s_add_u32 m0, s88, 26624
    s_add_u32 s82, s84, 425984
    buffer_load_dwordx4 v13, s[56:59], s82 offen lds
    s_add_u32 m0, s88, 27648
    s_add_u32 s82, s84, 442368
    buffer_load_dwordx4 v13, s[56:59], s82 offen lds
    s_add_u32 m0, s88, 28672
    s_add_u32 s82, s84, 458752
    buffer_load_dwordx4 v13, s[56:59], s82 offen lds
    s_add_u32 m0, s88, 29696
    s_add_u32 s82, s84, 475136
    buffer_load_dwordx4 v13, s[56:59], s82 offen lds
    s_add_u32 m0, s88, 30720
    s_add_u32 s82, s84, 491520
    buffer_load_dwordx4 v13, s[56:59], s82 offen lds
    s_add_u32 m0, s88, 31744
    s_add_u32 s82, s84, 507904
    buffer_load_dwordx4 v13, s[56:59], s82 offen lds
    s_add_u32 m0, s88, 32768
    s_add_u32 s82, s84, 524288
    buffer_load_dwordx4 v13, s[56:59], s82 offen lds
    s_add_u32 m0, s88, 33792
    s_add_u32 s82, s84, 540672
    buffer_load_dwordx4 v13, s[56:59], s82 offen lds
    s_add_u32 m0, s88, 34816
    s_add_u32 s82, s84, 557056
    buffer_load_dwordx4 v13, s[56:59], s82 offen lds
    s_add_u32 m0, s88, 35840
    s_add_u32 s82, s84, 573440
    buffer_load_dwordx4 v13, s[56:59], s82 offen lds
    s_add_u32 m0, s88, 36864
    s_add_u32 s82, s84, 589824
    buffer_load_dwordx4 v13, s[56:59], s82 offen lds
    s_add_u32 m0, s88, 37888
    s_add_u32 s82, s84, 606208
    buffer_load_dwordx4 v13, s[56:59], s82 offen lds
    s_add_u32 m0, s88, 38912
    s_add_u32 s82, s84, 622592
    buffer_load_dwordx4 v13, s[56:59], s82 offen lds
    s_add_u32 m0, s88, 39936
    s_add_u32 s82, s84, 638976
    buffer_load_dwordx4 v13, s[56:59], s82 offen lds
    s_waitcnt vmcnt(32)
    ds_read_b64_tr_b16 a[0:1], v14 offset:0
    ds_read_b64_tr_b16 a[2:3], v14 offset:1024
    ds_read_b64_tr_b16 a[4:5], v14 offset:512
    ds_read_b64_tr_b16 a[6:7], v14 offset:1536
    ds_read_b64_tr_b16 a[8:9], v14 offset:2048
    ds_read_b64_tr_b16 a[10:11], v14 offset:3072
    ds_read_b64_tr_b16 a[12:13], v14 offset:2560
    ds_read_b64_tr_b16 a[14:15], v14 offset:3584
    ds_read_b64_tr_b16 a[16:17], v14 offset:4096
    ds_read_b64_tr_b16 a[18:19], v14 offset:5120
    ds_read_b64_tr_b16 a[20:21], v14 offset:4608
    ds_read_b64_tr_b16 a[22:23], v14 offset:5632
    ds_read_b64_tr_b16 a[24:25], v14 offset:6144
    ds_read_b64_tr_b16 a[26:27], v14 offset:7168
    ds_read_b64_tr_b16 a[28:29], v14 offset:6656
    ds_read_b64_tr_b16 a[30:31], v14 offset:7680
    s_waitcnt lgkmcnt(0)
    s_add_u32 m0, s88, 0
    s_add_u32 s82, s84, 655360
    buffer_load_dwordx4 v13, s[56:59], s82 offen lds
    s_add_u32 m0, s88, 1024
    s_add_u32 s82, s84, 671744
    buffer_load_dwordx4 v13, s[56:59], s82 offen lds
    s_add_u32 m0, s88, 2048
    s_add_u32 s82, s84, 688128
    buffer_load_dwordx4 v13, s[56:59], s82 offen lds
    s_add_u32 m0, s88, 3072
    s_add_u32 s82, s84, 704512
    buffer_load_dwordx4 v13, s[56:59], s82 offen lds
    s_add_u32 m0, s88, 4096
    s_add_u32 s82, s84, 720896
    buffer_load_dwordx4 v13, s[56:59], s82 offen lds
    s_add_u32 m0, s88, 5120
    s_add_u32 s82, s84, 737280
    buffer_load_dwordx4 v13, s[56:59], s82 offen lds
    s_add_u32 m0, s88, 6144
    s_add_u32 s82, s84, 753664
    buffer_load_dwordx4 v13, s[56:59], s82 offen lds
    s_add_u32 m0, s88, 7168
    s_add_u32 s82, s84, 770048
    buffer_load_dwordx4 v13, s[56:59], s82 offen lds
    s_waitcnt vmcnt(32)
    ds_read_b64_tr_b16 a[32:33], v14 offset:8192
    ds_read_b64_tr_b16 a[34:35], v14 offset:9216
    ds_read_b64_tr_b16 a[36:37], v14 offset:8704
    ds_read_b64_tr_b16 a[38:39], v14 offset:9728
    ds_read_b64_tr_b16 a[40:41], v14 offset:10240
    ds_read_b64_tr_b16 a[42:43], v14 offset:11264
    ds_read_b64_tr_b16 a[44:45], v14 offset:10752
    ds_read_b64_tr_b16 a[46:47], v14 offset:11776
    ds_read_b64_tr_b16 a[48:49], v14 offset:12288
    ds_read_b64_tr_b16 a[50:51], v14 offset:13312
    ds_read_b64_tr_b16 a[52:53], v14 offset:12800
    ds_read_b64_tr_b16 a[54:55], v14 offset:13824
    ds_read_b64_tr_b16 a[56:57], v14 offset:14336
    ds_read_b64_tr_b16 a[58:59], v14 offset:15360
    ds_read_b64_tr_b16 a[60:61], v14 offset:14848
    ds_read_b64_tr_b16 a[62:63], v14 offset:15872
    s_waitcnt lgkmcnt(0)
    s_add_u32 m0, s88, 8192
    s_add_u32 s82, s84, 786432
    buffer_load_dwordx4 v13, s[56:59], s82 offen lds
    s_add_u32 m0, s88, 9216
    s_add_u32 s82, s84, 802816
    buffer_load_dwordx4 v13, s[56:59], s82 offen lds
    s_add_u32 m0, s88, 10240
    s_add_u32 s82, s84, 819200
    buffer_load_dwordx4 v13, s[56:59], s82 offen lds
    s_add_u32 m0, s88, 11264
    s_add_u32 s82, s84, 835584
    buffer_load_dwordx4 v13, s[56:59], s82 offen lds
    s_add_u32 m0, s88, 12288
    s_add_u32 s82, s84, 851968
    buffer_load_dwordx4 v13, s[56:59], s82 offen lds
    s_add_u32 m0, s88, 13312
    s_add_u32 s82, s84, 868352
    buffer_load_dwordx4 v13, s[56:59], s82 offen lds
    s_add_u32 m0, s88, 14336
    s_add_u32 s82, s84, 884736
    buffer_load_dwordx4 v13, s[56:59], s82 offen lds
    s_add_u32 m0, s88, 15360
    s_add_u32 s82, s84, 901120
    buffer_load_dwordx4 v13, s[56:59], s82 offen lds
    s_waitcnt vmcnt(32)
    ds_read_b64_tr_b16 a[64:65], v14 offset:16384
    ds_read_b64_tr_b16 a[66:67], v14 offset:17408
    ds_read_b64_tr_b16 a[68:69], v14 offset:16896
    ds_read_b64_tr_b16 a[70:71], v14 offset:17920
    ds_read_b64_tr_b16 a[72:73], v14 offset:18432
    ds_read_b64_tr_b16 a[74:75], v14 offset:19456
    ds_read_b64_tr_b16 a[76:77], v14 offset:18944
    ds_read_b64_tr_b16 a[78:79], v14 offset:19968
    ds_read_b64_tr_b16 a[80:81], v14 offset:20480
    ds_read_b64_tr_b16 a[82:83], v14 offset:21504
    ds_read_b64_tr_b16 a[84:85], v14 offset:20992
    ds_read_b64_tr_b16 a[86:87], v14 offset:22016
    ds_read_b64_tr_b16 a[88:89], v14 offset:22528
    ds_read_b64_tr_b16 a[90:91], v14 offset:23552
    ds_read_b64_tr_b16 a[92:93], v14 offset:23040
    ds_read_b64_tr_b16 a[94:95], v14 offset:24064
    s_waitcnt lgkmcnt(0)
    s_add_u32 m0, s88, 16384
    s_add_u32 s82, s84, 917504
    buffer_load_dwordx4 v13, s[56:59], s82 offen lds
    s_add_u32 m0, s88, 17408
    s_add_u32 s82, s84, 933888
    buffer_load_dwordx4 v13, s[56:59], s82 offen lds
    s_add_u32 m0, s88, 18432
    s_add_u32 s82, s84, 950272
    buffer_load_dwordx4 v13, s[56:59], s82 offen lds
    s_add_u32 m0, s88, 19456
    s_add_u32 s82, s84, 966656
    buffer_load_dwordx4 v13, s[56:59], s82 offen lds
    s_add_u32 m0, s88, 20480
    s_add_u32 s82, s84, 983040
    buffer_load_dwordx4 v13, s[56:59], s82 offen lds
    s_add_u32 m0, s88, 21504
    s_add_u32 s82, s84, 999424
    buffer_load_dwordx4 v13, s[56:59], s82 offen lds
    s_add_u32 m0, s88, 22528
    s_add_u32 s82, s84, 1015808
    buffer_load_dwordx4 v13, s[56:59], s82 offen lds
    s_add_u32 m0, s88, 23552
    s_add_u32 s82, s84, 1032192
    buffer_load_dwordx4 v13, s[56:59], s82 offen lds
    s_waitcnt vmcnt(32)
    ds_read_b64_tr_b16 a[96:97], v14 offset:24576
    ds_read_b64_tr_b16 a[98:99], v14 offset:25600
    ds_read_b64_tr_b16 a[100:101], v14 offset:25088
    ds_read_b64_tr_b16 a[102:103], v14 offset:26112
    ds_read_b64_tr_b16 a[104:105], v14 offset:26624
    ds_read_b64_tr_b16 a[106:107], v14 offset:27648
    ds_read_b64_tr_b16 a[108:109], v14 offset:27136
    ds_read_b64_tr_b16 a[110:111], v14 offset:28160
    ds_read_b64_tr_b16 a[112:113], v14 offset:28672
    ds_read_b64_tr_b16 a[114:115], v14 offset:29696
    ds_read_b64_tr_b16 a[116:117], v14 offset:29184
    ds_read_b64_tr_b16 a[118:119], v14 offset:30208
    ds_read_b64_tr_b16 a[120:121], v14 offset:30720
    ds_read_b64_tr_b16 a[122:123], v14 offset:31744
    ds_read_b64_tr_b16 a[124:125], v14 offset:31232
    ds_read_b64_tr_b16 a[126:127], v14 offset:32256
    s_waitcnt lgkmcnt(0)
    s_waitcnt vmcnt(24)
    ds_read_b64_tr_b16 a[128:129], v14 offset:32768
    ds_read_b64_tr_b16 a[130:131], v14 offset:33792
    ds_read_b64_tr_b16 a[132:133], v14 offset:33280
    ds_read_b64_tr_b16 a[134:135], v14 offset:34304
    ds_read_b64_tr_b16 a[136:137], v14 offset:34816
    ds_read_b64_tr_b16 a[138:139], v14 offset:35840
    ds_read_b64_tr_b16 a[140:141], v14 offset:35328
    ds_read_b64_tr_b16 a[142:143], v14 offset:36352
    ds_read_b64_tr_b16 a[144:145], v14 offset:36864
    ds_read_b64_tr_b16 a[146:147], v14 offset:37888
    ds_read_b64_tr_b16 a[148:149], v14 offset:37376
    ds_read_b64_tr_b16 a[150:151], v14 offset:38400
    ds_read_b64_tr_b16 a[152:153], v14 offset:38912
    ds_read_b64_tr_b16 a[154:155], v14 offset:39936
    ds_read_b64_tr_b16 a[156:157], v14 offset:39424
    ds_read_b64_tr_b16 a[158:159], v14 offset:40448
    s_waitcnt lgkmcnt(0)
    s_waitcnt vmcnt(16)
    ds_read_b64_tr_b16 a[160:161], v14 offset:0
    ds_read_b64_tr_b16 a[162:163], v14 offset:1024
    ds_read_b64_tr_b16 a[164:165], v14 offset:512
    ds_read_b64_tr_b16 a[166:167], v14 offset:1536
    ds_read_b64_tr_b16 a[168:169], v14 offset:2048
    ds_read_b64_tr_b16 a[170:171], v14 offset:3072
    ds_read_b64_tr_b16 a[172:173], v14 offset:2560
    ds_read_b64_tr_b16 a[174:175], v14 offset:3584
    ds_read_b64_tr_b16 a[176:177], v14 offset:4096
    ds_read_b64_tr_b16 a[178:179], v14 offset:5120
    ds_read_b64_tr_b16 a[180:181], v14 offset:4608
    ds_read_b64_tr_b16 a[182:183], v14 offset:5632
    ds_read_b64_tr_b16 a[184:185], v14 offset:6144
    ds_read_b64_tr_b16 a[186:187], v14 offset:7168
    ds_read_b64_tr_b16 a[188:189], v14 offset:6656
    ds_read_b64_tr_b16 a[190:191], v14 offset:7680
    s_waitcnt lgkmcnt(0)
    s_waitcnt vmcnt(8)
    ds_read_b64_tr_b16 a[192:193], v14 offset:8192
    ds_read_b64_tr_b16 a[194:195], v14 offset:9216
    ds_read_b64_tr_b16 a[196:197], v14 offset:8704
    ds_read_b64_tr_b16 a[198:199], v14 offset:9728
    ds_read_b64_tr_b16 a[200:201], v14 offset:10240
    ds_read_b64_tr_b16 a[202:203], v14 offset:11264
    ds_read_b64_tr_b16 a[204:205], v14 offset:10752
    ds_read_b64_tr_b16 a[206:207], v14 offset:11776
    ds_read_b64_tr_b16 a[208:209], v14 offset:12288
    ds_read_b64_tr_b16 a[210:211], v14 offset:13312
    ds_read_b64_tr_b16 a[212:213], v14 offset:12800
    ds_read_b64_tr_b16 a[214:215], v14 offset:13824
    ds_read_b64_tr_b16 a[216:217], v14 offset:14336
    ds_read_b64_tr_b16 a[218:219], v14 offset:15360
    ds_read_b64_tr_b16 a[220:221], v14 offset:14848
    ds_read_b64_tr_b16 a[222:223], v14 offset:15872
    s_waitcnt lgkmcnt(0)
    s_waitcnt vmcnt(0)
    ds_read_b64_tr_b16 a[224:225], v14 offset:16384
    ds_read_b64_tr_b16 a[226:227], v14 offset:17408
    ds_read_b64_tr_b16 a[228:229], v14 offset:16896
    ds_read_b64_tr_b16 a[230:231], v14 offset:17920
    ds_read_b64_tr_b16 a[232:233], v14 offset:18432
    ds_read_b64_tr_b16 a[234:235], v14 offset:19456
    ds_read_b64_tr_b16 a[236:237], v14 offset:18944
    ds_read_b64_tr_b16 a[238:239], v14 offset:19968
    ds_read_b64_tr_b16 a[240:241], v14 offset:20480
    ds_read_b64_tr_b16 a[242:243], v14 offset:21504
    ds_read_b64_tr_b16 a[244:245], v14 offset:20992
    ds_read_b64_tr_b16 a[246:247], v14 offset:22016
    ds_read_b64_tr_b16 a[248:249], v14 offset:22528
    ds_read_b64_tr_b16 a[250:251], v14 offset:23552
    ds_read_b64_tr_b16 a[252:253], v14 offset:23040
    ds_read_b64_tr_b16 a[254:255], v14 offset:24064
    s_waitcnt lgkmcnt(0)
    s_barrier
    s_mul_i32 s88, s16, 28672
    s_mul_i32 s84, s16, 458752
    s_add_u32 m0, s88, 0
    s_add_u32 s82, s84, 0
    buffer_load_dwordx4 v13, s[60:63], s82 offen lds
    s_add_u32 m0, s88, 1024
    s_add_u32 s82, s84, 16384
    buffer_load_dwordx4 v13, s[60:63], s82 offen lds
    s_add_u32 m0, s88, 2048
    s_add_u32 s82, s84, 32768
    buffer_load_dwordx4 v13, s[60:63], s82 offen lds
    s_add_u32 m0, s88, 3072
    s_add_u32 s82, s84, 49152
    buffer_load_dwordx4 v13, s[60:63], s82 offen lds
    s_add_u32 m0, s88, 4096
    s_add_u32 s82, s84, 65536
    buffer_load_dwordx4 v13, s[60:63], s82 offen lds
    s_add_u32 m0, s88, 5120
    s_add_u32 s82, s84, 81920
    buffer_load_dwordx4 v13, s[60:63], s82 offen lds
    s_add_u32 m0, s88, 6144
    s_add_u32 s82, s84, 98304
    buffer_load_dwordx4 v13, s[60:63], s82 offen lds
    s_add_u32 m0, s88, 7168
    s_add_u32 s82, s84, 114688
    buffer_load_dwordx4 v13, s[60:63], s82 offen lds
    s_add_u32 m0, s88, 8192
    s_add_u32 s82, s84, 131072
    buffer_load_dwordx4 v13, s[60:63], s82 offen lds
    s_add_u32 m0, s88, 9216
    s_add_u32 s82, s84, 147456
    buffer_load_dwordx4 v13, s[60:63], s82 offen lds
    s_add_u32 m0, s88, 10240
    s_add_u32 s82, s84, 163840
    buffer_load_dwordx4 v13, s[60:63], s82 offen lds
    s_add_u32 m0, s88, 11264
    s_add_u32 s82, s84, 180224
    buffer_load_dwordx4 v13, s[60:63], s82 offen lds
    s_add_u32 m0, s88, 12288
    s_add_u32 s82, s84, 196608
    buffer_load_dwordx4 v13, s[60:63], s82 offen lds
    s_add_u32 m0, s88, 13312
    s_add_u32 s82, s84, 212992
    buffer_load_dwordx4 v13, s[60:63], s82 offen lds
    s_add_u32 m0, s88, 14336
    s_add_u32 s82, s84, 229376
    buffer_load_dwordx4 v13, s[60:63], s82 offen lds
    s_add_u32 m0, s88, 15360
    s_add_u32 s82, s84, 245760
    buffer_load_dwordx4 v13, s[60:63], s82 offen lds
    s_add_u32 m0, s88, 16384
    s_add_u32 s82, s84, 262144
    buffer_load_dwordx4 v13, s[60:63], s82 offen lds
    s_add_u32 m0, s88, 17408
    s_add_u32 s82, s84, 278528
    buffer_load_dwordx4 v13, s[60:63], s82 offen lds
    s_add_u32 m0, s88, 18432
    s_add_u32 s82, s84, 294912
    buffer_load_dwordx4 v13, s[60:63], s82 offen lds
    s_add_u32 m0, s88, 19456
    s_add_u32 s82, s84, 311296
    buffer_load_dwordx4 v13, s[60:63], s82 offen lds
    s_add_u32 m0, s88, 20480
    s_add_u32 s82, s84, 327680
    buffer_load_dwordx4 v13, s[60:63], s82 offen lds
    s_add_u32 m0, s88, 21504
    s_add_u32 s82, s84, 344064
    buffer_load_dwordx4 v13, s[60:63], s82 offen lds
    s_add_u32 m0, s88, 22528
    s_add_u32 s82, s84, 360448
    buffer_load_dwordx4 v13, s[60:63], s82 offen lds
    s_add_u32 m0, s88, 23552
    s_add_u32 s82, s84, 376832
    buffer_load_dwordx4 v13, s[60:63], s82 offen lds
    s_add_u32 m0, s88, 24576
    s_add_u32 s82, s84, 393216
    buffer_load_dwordx4 v13, s[60:63], s82 offen lds
    s_add_u32 m0, s88, 25600
    s_add_u32 s82, s84, 409600
    buffer_load_dwordx4 v13, s[60:63], s82 offen lds
    s_add_u32 m0, s88, 26624
    s_add_u32 s82, s84, 425984
    buffer_load_dwordx4 v13, s[60:63], s82 offen lds
    s_add_u32 m0, s88, 27648
    s_add_u32 s82, s84, 442368
    buffer_load_dwordx4 v13, s[60:63], s82 offen lds
    v_add_u32 v4, s88, v4
    s_mov_b32 s76, s79
    s_mov_b32 s80, 0
L_tl_seg:
    s_lshl_b32 s82, s76, 15
    v_and_b32 v13, 0x70, v10
    buffer_load_dwordx4 v[72:75], v10, s[20:23], s82 offen offset:0
    buffer_load_dwordx4 v[104:107], v13, s[68:71], 0 offen offset:0
    buffer_load_dwordx4 v[76:79], v10, s[20:23], s82 offen offset:128
    buffer_load_dwordx4 v[108:111], v13, s[68:71], 0 offen offset:128
    buffer_load_dwordx4 v[80:83], v10, s[20:23], s82 offen offset:256
    buffer_load_dwordx4 v[112:115], v13, s[68:71], 0 offen offset:256
    buffer_load_dwordx4 v[84:87], v10, s[20:23], s82 offen offset:384
    buffer_load_dwordx4 v[116:119], v13, s[68:71], 0 offen offset:384
    buffer_load_dwordx4 v[88:91], v10, s[20:23], s82 offen offset:512
    buffer_load_dwordx4 v[120:123], v13, s[68:71], 0 offen offset:512
    buffer_load_dwordx4 v[92:95], v10, s[20:23], s82 offen offset:640
    buffer_load_dwordx4 v[124:127], v13, s[68:71], 0 offen offset:640
    buffer_load_dwordx4 v[96:99], v10, s[20:23], s82 offen offset:768
    buffer_load_dwordx4 v[128:131], v13, s[68:71], 0 offen offset:768
    buffer_load_dwordx4 v[100:103], v10, s[20:23], s82 offen offset:896
    buffer_load_dwordx4 v[132:135], v13, s[68:71], 0 offen offset:896
    s_lshl_b32 s83, s76, 5
    s_add_u32 s83, s83, s81
    s_lshl_b32 s83, s83, 13
    s_and_b32 s84, s16, 1
    s_lshl_b32 s84, s84, 12
    s_add_u32 s83, s83, s84
    s_add_u32 s83, s83, 83886080
    v_lshlrev_b32 v14, 2, v2
    buffer_load_dword v15, v14, s[4:7], s83 offen sc1
    v_mov_b32 v12, 0
    s_waitcnt vmcnt(0)
    v_lshlrev_b32 v13, 16, v72
    v_and_b32 v14, 0xffff0000, v72
    v_lshlrev_b32 v15, 16, v104
    v_and_b32 v16, 0xffff0000, v104
    v_mul_f32 v13, v13, v15
    v_mul_f32 v14, v14, v16
    v_cvt_pk_bf16_f32 v13, v13, v14
    v_lshlrev_b32 v14, 16, v13
    v_and_b32 v13, 0xffff0000, v13
    v_add_f32 v12, v12, v14
    v_add_f32 v12, v12, v13
    v_lshlrev_b32 v13, 16, v73
    v_and_b32 v14, 0xffff0000, v73
    v_lshlrev_b32 v15, 16, v105
    v_and_b32 v16, 0xffff0000, v105
    v_mul_f32 v13, v13, v15
    v_mul_f32 v14, v14, v16
    v_cvt_pk_bf16_f32 v13, v13, v14
    v_lshlrev_b32 v14, 16, v13
    v_and_b32 v13, 0xffff0000, v13
    v_add_f32 v12, v12, v14
    v_add_f32 v12, v12, v13
    v_lshlrev_b32 v13, 16, v74
    v_and_b32 v14, 0xffff0000, v74
    v_lshlrev_b32 v15, 16, v106
    v_and_b32 v16, 0xffff0000, v106
    v_mul_f32 v13, v13, v15
    v_mul_f32 v14, v14, v16
    v_cvt_pk_bf16_f32 v13, v13, v14
    v_lshlrev_b32 v14, 16, v13
    v_and_b32 v13, 0xffff0000, v13
    v_add_f32 v12, v12, v14
    v_add_f32 v12, v12, v13
    v_lshlrev_b32 v13, 16, v75
    v_and_b32 v14, 0xffff0000, v75
    v_lshlrev_b32 v15, 16, v107
    v_and_b32 v16, 0xffff0000, v107
    v_mul_f32 v13, v13, v15
    v_mul_f32 v14, v14, v16
    v_cvt_pk_bf16_f32 v13, v13, v14
    v_lshlrev_b32 v14, 16, v13
    v_and_b32 v13, 0xffff0000, v13
    v_add_f32 v12, v12, v14
    v_add_f32 v12, v12, v13
    v_lshlrev_b32 v13, 16, v76
    v_and_b32 v14, 0xffff0000, v76
    v_lshlrev_b32 v15, 16, v108
    v_and_b32 v16, 0xffff0000, v108
    v_mul_f32 v13, v13, v15
    v_mul_f32 v14, v14, v16
    v_cvt_pk_bf16_f32 v13, v13, v14
    v_lshlrev_b32 v14, 16, v13
    v_and_b32 v13, 0xffff0000, v13
    v_add_f32 v12, v12, v14
    v_add_f32 v12, v12, v13
    v_lshlrev_b32 v13, 16, v77
    v_and_b32 v14, 0xffff0000, v77
    v_lshlrev_b32 v15, 16, v109
    v_and_b32 v16, 0xffff0000, v109
    v_mul_f32 v13, v13, v15
    v_mul_f32 v14, v14, v16
    v_cvt_pk_bf16_f32 v13, v13, v14
    v_lshlrev_b32 v14, 16, v13
    v_and_b32 v13, 0xffff0000, v13
    v_add_f32 v12, v12, v14
    v_add_f32 v12, v12, v13
    v_lshlrev_b32 v13, 16, v78
    v_and_b32 v14, 0xffff0000, v78
    v_lshlrev_b32 v15, 16, v110
    v_and_b32 v16, 0xffff0000, v110
    v_mul_f32 v13, v13, v15
    v_mul_f32 v14, v14, v16
    v_cvt_pk_bf16_f32 v13, v13, v14
    v_lshlrev_b32 v14, 16, v13
    v_and_b32 v13, 0xffff0000, v13
    v_add_f32 v12, v12, v14
    v_add_f32 v12, v12, v13
    v_lshlrev_b32 v13, 16, v79
    v_and_b32 v14, 0xffff0000, v79
    v_lshlrev_b32 v15, 16, v111
    v_and_b32 v16, 0xffff0000, v111
    v_mul_f32 v13, v13, v15
    v_mul_f32 v14, v14, v16
    v_cvt_pk_bf16_f32 v13, v13, v14
    v_lshlrev_b32 v14, 16, v13
    v_and_b32 v13, 0xffff0000, v13
    v_add_f32 v12, v12, v14
    v_add_f32 v12, v12, v13
    v_lshlrev_b32 v13, 16, v80
    v_and_b32 v14, 0xffff0000, v80
    v_lshlrev_b32 v15, 16, v112
    v_and_b32 v16, 0xffff0000, v112
    v_mul_f32 v13, v13, v15
    v_mul_f32 v14, v14, v16
    v_cvt_pk_bf16_f32 v13, v13, v14
    v_lshlrev_b32 v14, 16, v13
    v_and_b32 v13, 0xffff0000, v13
    v_add_f32 v12, v12, v14
    v_add_f32 v12, v12, v13
    v_lshlrev_b32 v13, 16, v81
    v_and_b32 v14, 0xffff0000, v81
    v_lshlrev_b32 v15, 16, v113
    v_and_b32 v16, 0xffff0000, v113
    v_mul_f32 v13, v13, v15
    v_mul_f32 v14, v14, v16
    v_cvt_pk_bf16_f32 v13, v13, v14
    v_lshlrev_b32 v14, 16, v13
    v_and_b32 v13, 0xffff0000, v13
    v_add_f32 v12, v12, v14
    v_add_f32 v12, v12, v13
    v_lshlrev_b32 v13, 16, v82
    v_and_b32 v14, 0xffff0000, v82
    v_lshlrev_b32 v15, 16, v114
    v_and_b32 v16, 0xffff0000, v114
    v_mul_f32 v13, v13, v15
    v_mul_f32 v14, v14, v16
    v_cvt_pk_bf16_f32 v13, v13, v14
    v_lshlrev_b32 v14, 16, v13
    v_and_b32 v13, 0xffff0000, v13
    v_add_f32 v12, v12, v14
    v_add_f32 v12, v12, v13
    v_lshlrev_b32 v13, 16, v83
    v_and_b32 v14, 0xffff0000, v83
    v_lshlrev_b32 v15, 16, v115
    v_and_b32 v16, 0xffff0000, v115
    v_mul_f32 v13, v13, v15
    v_mul_f32 v14, v14, v16
    v_cvt_pk_bf16_f32 v13, v13, v14
    v_lshlrev_b32 v14, 16, v13
    v_and_b32 v13, 0xffff0000, v13
    v_add_f32 v12, v12, v14
    v_add_f32 v12, v12, v13
    v_lshlrev_b32 v13, 16, v84
    v_and_b32 v14, 0xffff0000, v84
    v_lshlrev_b32 v15, 16, v116
    v_and_b32 v16, 0xffff0000, v116
    v_mul_f32 v13, v13, v15
    v_mul_f32 v14, v14, v16
    v_cvt_pk_bf16_f32 v13, v13, v14
    v_lshlrev_b32 v14, 16, v13
    v_and_b32 v13, 0xffff0000, v13
    v_add_f32 v12, v12, v14
    v_add_f32 v12, v12, v13
    v_lshlrev_b32 v13, 16, v85
    v_and_b32 v14, 0xffff0000, v85
    v_lshlrev_b32 v15, 16, v117
    v_and_b32 v16, 0xffff0000, v117
    v_mul_f32 v13, v13, v15
    v_mul_f32 v14, v14, v16
    v_cvt_pk_bf16_f32 v13, v13, v14
    v_lshlrev_b32 v14, 16, v13
    v_and_b32 v13, 0xffff0000, v13
    v_add_f32 v12, v12, v14
    v_add_f32 v12, v12, v13
    v_lshlrev_b32 v13, 16, v86
    v_and_b32 v14, 0xffff0000, v86
    v_lshlrev_b32 v15, 16, v118
    v_and_b32 v16, 0xffff0000, v118
    v_mul_f32 v13, v13, v15
    v_mul_f32 v14, v14, v16
    v_cvt_pk_bf16_f32 v13, v13, v14
    v_lshlrev_b32 v14, 16, v13
    v_and_b32 v13, 0xffff0000, v13
    v_add_f32 v12, v12, v14
    v_add_f32 v12, v12, v13
    v_lshlrev_b32 v13, 16, v87
    v_and_b32 v14, 0xffff0000, v87
    v_lshlrev_b32 v15, 16, v119
    v_and_b32 v16, 0xffff0000, v119
    v_mul_f32 v13, v13, v15
    v_mul_f32 v14, v14, v16
    v_cvt_pk_bf16_f32 v13, v13, v14
    v_lshlrev_b32 v14, 16, v13
    v_and_b32 v13, 0xffff0000, v13
    v_add_f32 v12, v12, v14
    v_add_f32 v12, v12, v13
    v_lshlrev_b32 v13, 16, v88
    v_and_b32 v14, 0xffff0000, v88
    v_lshlrev_b32 v15, 16, v120
    v_and_b32 v16, 0xffff0000, v120
    v_mul_f32 v13, v13, v15
    v_mul_f32 v14, v14, v16
    v_cvt_pk_bf16_f32 v13, v13, v14
    v_lshlrev_b32 v14, 16, v13
    v_and_b32 v13, 0xffff0000, v13
    v_add_f32 v12, v12, v14
    v_add_f32 v12, v12, v13
    v_lshlrev_b32 v13, 16, v89
    v_and_b32 v14, 0xffff0000, v89
    v_lshlrev_b32 v15, 16, v121
    v_and_b32 v16, 0xffff0000, v121
    v_mul_f32 v13, v13, v15
    v_mul_f32 v14, v14, v16
    v_cvt_pk_bf16_f32 v13, v13, v14
    v_lshlrev_b32 v14, 16, v13
    v_and_b32 v13, 0xffff0000, v13
    v_add_f32 v12, v12, v14
    v_add_f32 v12, v12, v13
    v_lshlrev_b32 v13, 16, v90
    v_and_b32 v14, 0xffff0000, v90
    v_lshlrev_b32 v15, 16, v122
    v_and_b32 v16, 0xffff0000, v122
    v_mul_f32 v13, v13, v15
    v_mul_f32 v14, v14, v16
    v_cvt_pk_bf16_f32 v13, v13, v14
    v_lshlrev_b32 v14, 16, v13
    v_and_b32 v13, 0xffff0000, v13
    v_add_f32 v12, v12, v14
    v_add_f32 v12, v12, v13
    v_lshlrev_b32 v13, 16, v91
    v_and_b32 v14, 0xffff0000, v91
    v_lshlrev_b32 v15, 16, v123
    v_and_b32 v16, 0xffff0000, v123
    v_mul_f32 v13, v13, v15
    v_mul_f32 v14, v14, v16
    v_cvt_pk_bf16_f32 v13, v13, v14
    v_lshlrev_b32 v14, 16, v13
    v_and_b32 v13, 0xffff0000, v13
    v_add_f32 v12, v12, v14
    v_add_f32 v12, v12, v13
    v_lshlrev_b32 v13, 16, v92
    v_and_b32 v14, 0xffff0000, v92
    v_lshlrev_b32 v15, 16, v124
    v_and_b32 v16, 0xffff0000, v124
    v_mul_f32 v13, v13, v15
    v_mul_f32 v14, v14, v16
    v_cvt_pk_bf16_f32 v13, v13, v14
    v_lshlrev_b32 v14, 16, v13
    v_and_b32 v13, 0xffff0000, v13
    v_add_f32 v12, v12, v14
    v_add_f32 v12, v12, v13
    v_lshlrev_b32 v13, 16, v93
    v_and_b32 v14, 0xffff0000, v93
    v_lshlrev_b32 v15, 16, v125
    v_and_b32 v16, 0xffff0000, v125
    v_mul_f32 v13, v13, v15
    v_mul_f32 v14, v14, v16
    v_cvt_pk_bf16_f32 v13, v13, v14
    v_lshlrev_b32 v14, 16, v13
    v_and_b32 v13, 0xffff0000, v13
    v_add_f32 v12, v12, v14
    v_add_f32 v12, v12, v13
    v_lshlrev_b32 v13, 16, v94
    v_and_b32 v14, 0xffff0000, v94
    v_lshlrev_b32 v15, 16, v126
    v_and_b32 v16, 0xffff0000, v126
    v_mul_f32 v13, v13, v15
    v_mul_f32 v14, v14, v16
    v_cvt_pk_bf16_f32 v13, v13, v14
    v_lshlrev_b32 v14, 16, v13
    v_and_b32 v13, 0xffff0000, v13
    v_add_f32 v12, v12, v14
    v_add_f32 v12, v12, v13
    v_lshlrev_b32 v13, 16, v95
    v_and_b32 v14, 0xffff0000, v95
    v_lshlrev_b32 v15, 16, v127
    v_and_b32 v16, 0xffff0000, v127
    v_mul_f32 v13, v13, v15
    v_mul_f32 v14, v14, v16
    v_cvt_pk_bf16_f32 v13, v13, v14
    v_lshlrev_b32 v14, 16, v13
    v_and_b32 v13, 0xffff0000, v13
    v_add_f32 v12, v12, v14
    v_add_f32 v12, v12, v13
    v_lshlrev_b32 v13, 16, v96
    v_and_b32 v14, 0xffff0000, v96
    v_lshlrev_b32 v15, 16, v128
    v_and_b32 v16, 0xffff0000, v128
    v_mul_f32 v13, v13, v15
    v_mul_f32 v14, v14, v16
    v_cvt_pk_bf16_f32 v13, v13, v14
    v_lshlrev_b32 v14, 16, v13
    v_and_b32 v13, 0xffff0000, v13
    v_add_f32 v12, v12, v14
    v_add_f32 v12, v12, v13
    v_lshlrev_b32 v13, 16, v97
    v_and_b32 v14, 0xffff0000, v97
    v_lshlrev_b32 v15, 16, v129
    v_and_b32 v16, 0xffff0000, v129
    v_mul_f32 v13, v13, v15
    v_mul_f32 v14, v14, v16
    v_cvt_pk_bf16_f32 v13, v13, v14
    v_lshlrev_b32 v14, 16, v13
    v_and_b32 v13, 0xffff0000, v13
    v_add_f32 v12, v12, v14
    v_add_f32 v12, v12, v13
    v_lshlrev_b32 v13, 16, v98
    v_and_b32 v14, 0xffff0000, v98
    v_lshlrev_b32 v15, 16, v130
    v_and_b32 v16, 0xffff0000, v130
    v_mul_f32 v13, v13, v15
    v_mul_f32 v14, v14, v16
    v_cvt_pk_bf16_f32 v13, v13, v14
    v_lshlrev_b32 v14, 16, v13
    v_and_b32 v13, 0xffff0000, v13
    v_add_f32 v12, v12, v14
    v_add_f32 v12, v12, v13
    v_lshlrev_b32 v13, 16, v99
    v_and_b32 v14, 0xffff0000, v99
    v_lshlrev_b32 v15, 16, v131
    v_and_b32 v16, 0xffff0000, v131
    v_mul_f32 v13, v13, v15
    v_mul_f32 v14, v14, v16
    v_cvt_pk_bf16_f32 v13, v13, v14
    v_lshlrev_b32 v14, 16, v13
    v_and_b32 v13, 0xffff0000, v13
    v_add_f32 v12, v12, v14
    v_add_f32 v12, v12, v13
    v_lshlrev_b32 v13, 16, v100
    v_and_b32 v14, 0xffff0000, v100
    v_lshlrev_b32 v15, 16, v132
    v_and_b32 v16, 0xffff0000, v132
    v_mul_f32 v13, v13, v15
    v_mul_f32 v14, v14, v16
    v_cvt_pk_bf16_f32 v13, v13, v14
    v_lshlrev_b32 v14, 16, v13
    v_and_b32 v13, 0xffff0000, v13
    v_add_f32 v12, v12, v14
    v_add_f32 v12, v12, v13
    v_lshlrev_b32 v13, 16, v101
    v_and_b32 v14, 0xffff0000, v101
    v_lshlrev_b32 v15, 16, v133
    v_and_b32 v16, 0xffff0000, v133
    v_mul_f32 v13, v13, v15
    v_mul_f32 v14, v14, v16
    v_cvt_pk_bf16_f32 v13, v13, v14
    v_lshlrev_b32 v14, 16, v13
    v_and_b32 v13, 0xffff0000, v13
    v_add_f32 v12, v12, v14
    v_add_f32 v12, v12, v13
    v_lshlrev_b32 v13, 16, v102
    v_and_b32 v14, 0xffff0000, v102
    v_lshlrev_b32 v15, 16, v134
    v_and_b32 v16, 0xffff0000, v134
    v_mul_f32 v13, v13, v15
    v_mul_f32 v14, v14, v16
    v_cvt_pk_bf16_f32 v13, v13, v14
    v_lshlrev_b32 v14, 16, v13
    v_and_b32 v13, 0xffff0000, v13
    v_add_f32 v12, v12, v14
    v_add_f32 v12, v12, v13
    v_lshlrev_b32 v13, 16, v103
    v_and_b32 v14, 0xffff0000, v103
    v_lshlrev_b32 v15, 16, v135
    v_and_b32 v16, 0xffff0000, v135
    v_mul_f32 v13, v13, v15
    v_mul_f32 v14, v14, v16
    v_cvt_pk_bf16_f32 v13, v13, v14
    v_lshlrev_b32 v14, 16, v13
    v_and_b32 v13, 0xffff0000, v13
    v_add_f32 v12, v12, v14
    v_add_f32 v12, v12, v13
    s_nop 1
    v_add_f32_dpp v12, v12, v12 quad_perm:[1,0,3,2] row_mask:0xf bank_mask:0xf
    s_nop 1
    v_add_f32_dpp v12, v12, v12 quad_perm:[2,3,0,1] row_mask:0xf bank_mask:0xf
    s_nop 1
    v_add_f32_dpp v12, v12, v12 row_half_mirror row_mask:0xf bank_mask:0xf
    v_cvt_pk_bf16_f32 v12, v12, v12
    v_lshlrev_b32 v12, 16, v12
    v_mul_f32 v12, s87, v12
    v_exp_f32 v12, v12
    s_nop 0
    v_add_f32 v12, 1.0, v12
    v_rcp_f32 v12, v12
    s_nop 0
    v_cvt_pk_bf16_f32 v12, v12, v12
    v_lshlrev_b32 v12, 16, v12
    s_lshr_b32 s82, s76, 3
    s_add_u32 s83, s82, 8
    s_lshl_b32 s83, s83, 2
    s_cmp_ge_u32 s82, 4
    s_mov_b32 s84, 144
    s_mov_b32 s85, 96
    s_cselect_b32 s84, 148, s84
    s_cselect_b32 s85, 128, s85
    s_cmp_eq_u32 s82, 0
    s_cselect_b32 s84, 140, s84
    s_cselect_b32 s85, 128, s85
    v_mov_b32 v13, s84
    v_mov_b32 v15, s85
    v_writelane_b32 v13, s83, 1
    v_writelane_b32 v15, 23, 1
    s_mov_b32 s83, 136
    s_mov_b32 s84, 224
    v_writelane_b32 v13, s83, 2
    v_writelane_b32 v15, s84, 2
    s_mov_b32 s85, 0
    s_mov_b64 exec, 7
L_w_wi:
    buffer_load_dword v14, v13, s[8:11], 0 offen sc1
    s_add_u32 s85, s85, 1
    s_cmp_gt_u32 s85, 400000
    s_cbranch_scc1 L_w_wix
    s_waitcnt vmcnt(0)
    v_cmp_gt_u32 vcc, v15, v14
    s_cbranch_vccz L_w_wix
    s_sleep 16
    s_branch L_w_wi
L_w_wix:
    s_waitcnt vmcnt(0)
    s_mov_b64 exec, -1
    s_mul_i32 s82, s76, 114688
    s_add_u32 s82, s82, s88
    s_add_u32 s82, s82, 67108864
    buffer_load_dwordx4 v[72:75], v2, s[4:7], s82 offen offset:0 sc1
    buffer_load_dwordx4 v[76:79], v2, s[4:7], s82 offen offset:1024 sc1
    buffer_load_dwordx4 v[80:83], v2, s[4:7], s82 offen offset:2048 sc1
    buffer_load_dwordx4 v[84:87], v2, s[4:7], s82 offen offset:3072 sc1
    s_add_u32 s82, s82, 4096
    buffer_load_dwordx4 v[88:91], v2, s[4:7], s82 offen offset:0 sc1
    buffer_load_dwordx4 v[92:95], v2, s[4:7], s82 offen offset:1024 sc1
    buffer_load_dwordx4 v[96:99], v2, s[4:7], s82 offen offset:2048 sc1
    buffer_load_dwordx4 v[100:103], v2, s[4:7], s82 offen offset:3072 sc1
    s_add_u32 s82, s82, 4096
    buffer_load_dwordx4 v[104:107], v2, s[4:7], s82 offen offset:0 sc1
    buffer_load_dwordx4 v[108:111], v2, s[4:7], s82 offen offset:1024 sc1
    buffer_load_dwordx4 v[112:115], v2, s[4:7], s82 offen offset:2048 sc1
    buffer_load_dwordx4 v[116:119], v2, s[4:7], s82 offen offset:3072 sc1
    s_add_u32 s82, s82, 4096
    buffer_load_dwordx4 v[120:123], v2, s[4:7], s82 offen offset:0 sc1
    buffer_load_dwordx4 v[124:127], v2, s[4:7], s82 offen offset:1024 sc1
    buffer_load_dwordx4 v[128:131], v2, s[4:7], s82 offen offset:2048 sc1
    buffer_load_dwordx4 v[132:135], v2, s[4:7], s82 offen offset:3072 sc1
    s_add_u32 s82, s82, 4096
    buffer_load_dwordx4 v[136:139], v2, s[4:7], s82 offen offset:0 sc1
    buffer_load_dwordx4 v[140:143], v2, s[4:7], s82 offen offset:1024 sc1
    buffer_load_dwordx4 v[144:147], v2, s[4:7], s82 offen offset:2048 sc1
    buffer_load_dwordx4 v[148:151], v2, s[4:7], s82 offen offset:3072 sc1
    s_add_u32 s82, s82, 4096
    buffer_load_dwordx4 v[152:155], v2, s[4:7], s82 offen offset:0 sc1
    buffer_load_dwordx4 v[156:159], v2, s[4:7], s82 offen offset:1024 sc1
    buffer_load_dwordx4 v[160:163], v2, s[4:7], s82 offen offset:2048 sc1
    buffer_load_dwordx4 v[164:167], v2, s[4:7], s82 offen offset:3072 sc1
    s_add_u32 s82, s82, 4096
    buffer_load_dwordx4 v[168:171], v2, s[4:7], s82 offen offset:0 sc1
    buffer_load_dwordx4 v[172:175], v2, s[4:7], s82 offen offset:1024 sc1
    buffer_load_dwordx4 v[176:179], v2, s[4:7], s82 offen offset:2048 sc1
    buffer_load_dwordx4 v[180:183], v2, s[4:7], s82 offen offset:3072 sc1
    ds_read_b64_tr_b16 v[200:201], v4 offset:0
    ds_read_b64_tr_b16 v[202:203], v4 offset:1024
    ds_read_b64_tr_b16 v[204:205], v4 offset:512
    ds_read_b64_tr_b16 v[206:207], v4 offset:1536
    ds_read_b64_tr_b16 v[208:209], v4 offset:2048
    ds_read_b64_tr_b16 v[210:211], v4 offset:3072
    ds_read_b64_tr_b16 v[212:213], v4 offset:2560
    ds_read_b64_tr_b16 v[214:215], v4 offset:3584
    s_waitcnt lgkmcnt(6)
    s_waitcnt vmcnt(27)
    v_mfma_f32_32x32x16_bf16 v[56:71], v[200:203], v[72:75], 0
    ds_read_b64_tr_b16 v[200:201], v4 offset:4096
    ds_read_b64_tr_b16 v[202:203], v4 offset:5120
    s_waitcnt lgkmcnt(6)
    s_waitcnt vmcnt(26)
    v_mfma_f32_32x32x16_bf16 v[56:71], v[204:207], v[76:79], v[56:71]
    ds_read_b64_tr_b16 v[204:205], v4 offset:4608
    ds_read_b64_tr_b16 v[206:207], v4 offset:5632
    s_waitcnt lgkmcnt(6)
    s_waitcnt vmcnt(25)
    v_mfma_f32_32x32x16_bf16 v[56:71], v[208:211], v[80:83], v[56:71]
    ds_read_b64_tr_b16 v[208:209], v4 offset:6144
    ds_read_b64_tr_b16 v[210:211], v4 offset:7168
    s_waitcnt lgkmcnt(6)
    s_waitcnt vmcnt(24)
    v_mfma_f32_32x32x16_bf16 v[56:71], v[212:215], v[84:87], v[56:71]
    ds_read_b64_tr_b16 v[212:213], v4 offset:6656
    ds_read_b64_tr_b16 v[214:215], v4 offset:7680
    s_waitcnt lgkmcnt(6)
    s_waitcnt vmcnt(23)
    v_mfma_f32_32x32x16_bf16 v[56:71], v[200:203], v[88:91], v[56:71]
    ds_read_b64_tr_b16 v[200:201], v4 offset:8192
    ds_read_b64_tr_b16 v[202:203], v4 offset:9216
    s_waitcnt lgkmcnt(6)
    s_waitcnt vmcnt(22)
    v_mfma_f32_32x32x16_bf16 v[56:71], v[204:207], v[92:95], v[56:71]
    ds_read_b64_tr_b16 v[204:205], v4 offset:8704
    ds_read_b64_tr_b16 v[206:207], v4 offset:9728
    s_waitcnt lgkmcnt(6)
    s_waitcnt vmcnt(21)
    v_mfma_f32_32x32x16_bf16 v[56:71], v[208:211], v[96:99], v[56:71]
    ds_read_b64_tr_b16 v[208:209], v4 offset:10240
    ds_read_b64_tr_b16 v[210:211], v4 offset:11264
    s_waitcnt lgkmcnt(6)
    s_waitcnt vmcnt(20)
    v_mfma_f32_32x32x16_bf16 v[56:71], v[212:215], v[100:103], v[56:71]
    ds_read_b64_tr_b16 v[212:213], v4 offset:10752
    ds_read_b64_tr_b16 v[214:215], v4 offset:11776
    s_waitcnt lgkmcnt(6)
    s_waitcnt vmcnt(19)
    v_mfma_f32_32x32x16_bf16 v[56:71], v[200:203], v[104:107], v[56:71]
    ds_read_b64_tr_b16 v[200:201], v4 offset:12288
    ds_read_b64_tr_b16 v[202:203], v4 offset:13312
    s_waitcnt lgkmcnt(6)
    s_waitcnt vmcnt(18)
    v_mfma_f32_32x32x16_bf16 v[56:71], v[204:207], v[108:111], v[56:71]
    ds_read_b64_tr_b16 v[204:205], v4 offset:12800
    ds_read_b64_tr_b16 v[206:207], v4 offset:13824
    s_waitcnt lgkmcnt(6)
    s_waitcnt vmcnt(17)
    v_mfma_f32_32x32x16_bf16 v[56:71], v[208:211], v[112:115], v[56:71]
    ds_read_b64_tr_b16 v[208:209], v4 offset:14336
    ds_read_b64_tr_b16 v[210:211], v4 offset:15360
    s_waitcnt lgkmcnt(6)
    s_waitcnt vmcnt(16)
    v_mfma_f32_32x32x16_bf16 v[56:71], v[212:215], v[116:119], v[56:71]
    ds_read_b64_tr_b16 v[212:213], v4 offset:14848
    ds_read_b64_tr_b16 v[214:215], v4 offset:15872
    s_waitcnt lgkmcnt(6)
    s_waitcnt vmcnt(15)
    v_mfma_f32_32x32x16_bf16 v[56:71], v[200:203], v[120:123], v[56:71]
    ds_read_b64_tr_b16 v[200:201], v4 offset:16384
    ds_read_b64_tr_b16 v[202:203], v4 offset:17408
    s_waitcnt lgkmcnt(6)
    s_waitcnt vmcnt(14)
    v_mfma_f32_32x32x16_bf16 v[56:71], v[204:207], v[124:127], v[56:71]
    ds_read_b64_tr_b16 v[204:205], v4 offset:16896
    ds_read_b64_tr_b16 v[206:207], v4 offset:17920
    s_waitcnt lgkmcnt(6)
    s_waitcnt vmcnt(13)
    v_mfma_f32_32x32x16_bf16 v[56:71], v[208:211], v[128:131], v[56:71]
    ds_read_b64_tr_b16 v[208:209], v4 offset:18432
    ds_read_b64_tr_b16 v[210:211], v4 offset:19456
    s_waitcnt lgkmcnt(6)
    s_waitcnt vmcnt(12)
    v_mfma_f32_32x32x16_bf16 v[56:71], v[212:215], v[132:135], v[56:71]
    ds_read_b64_tr_b16 v[212:213], v4 offset:18944
    ds_read_b64_tr_b16 v[214:215], v4 offset:19968
    s_waitcnt lgkmcnt(6)
    s_waitcnt vmcnt(11)
    v_mfma_f32_32x32x16_bf16 v[56:71], v[200:203], v[136:139], v[56:71]
    ds_read_b64_tr_b16 v[200:201], v4 offset:20480
    ds_read_b64_tr_b16 v[202:203], v4 offset:21504
    s_waitcnt lgkmcnt(6)
    s_waitcnt vmcnt(10)
    v_mfma_f32_32x32x16_bf16 v[56:71], v[204:207], v[140:143], v[56:71]
    ds_read_b64_tr_b16 v[204:205], v4 offset:20992
    ds_read_b64_tr_b16 v[206:207], v4 offset:22016
    s_waitcnt lgkmcnt(6)
    s_waitcnt vmcnt(9)
    v_mfma_f32_32x32x16_bf16 v[56:71], v[208:211], v[144:147], v[56:71]
    ds_read_b64_tr_b16 v[208:209], v4 offset:22528
    ds_read_b64_tr_b16 v[210:211], v4 offset:23552
    s_waitcnt lgkmcnt(6)
    s_waitcnt vmcnt(8)
    v_mfma_f32_32x32x16_bf16 v[56:71], v[212:215], v[148:151], v[56:71]
    ds_read_b64_tr_b16 v[212:213], v4 offset:23040
    ds_read_b64_tr_b16 v[214:215], v4 offset:24064
    s_waitcnt lgkmcnt(6)
    s_waitcnt vmcnt(7)
    v_mfma_f32_32x32x16_bf16 v[56:71], v[200:203], v[152:155], v[56:71]
    ds_read_b64_tr_b16 v[200:201], v4 offset:24576
    ds_read_b64_tr_b16 v[202:203], v4 offset:25600
    s_waitcnt lgkmcnt(6)
    s_waitcnt vmcnt(6)
    v_mfma_f32_32x32x16_bf16 v[56:71], v[204:207], v[156:159], v[56:71]
    ds_read_b64_tr_b16 v[204:205], v4 offset:25088
    ds_read_b64_tr_b16 v[206:207], v4 offset:26112
    s_waitcnt lgkmcnt(6)
    s_waitcnt vmcnt(5)
    v_mfma_f32_32x32x16_bf16 v[56:71], v[208:211], v[160:163], v[56:71]
    ds_read_b64_tr_b16 v[208:209], v4 offset:26624
    ds_read_b64_tr_b16 v[210:211], v4 offset:27648
    s_waitcnt lgkmcnt(6)
    s_waitcnt vmcnt(4)
    v_mfma_f32_32x32x16_bf16 v[56:71], v[212:215], v[164:167], v[56:71]
    ds_read_b64_tr_b16 v[212:213], v4 offset:27136
    ds_read_b64_tr_b16 v[214:215], v4 offset:28160
    s_waitcnt lgkmcnt(6)
    s_waitcnt vmcnt(3)
    v_mfma_f32_32x32x16_bf16 v[56:71], v[200:203], v[168:171], v[56:71]
    s_waitcnt lgkmcnt(4)
    s_waitcnt vmcnt(2)
    v_mfma_f32_32x32x16_bf16 v[56:71], v[204:207], v[172:175], v[56:71]
    s_waitcnt lgkmcnt(2)
    s_waitcnt vmcnt(1)
    v_mfma_f32_32x32x16_bf16 v[56:71], v[208:211], v[176:179], v[56:71]
    s_waitcnt lgkmcnt(0)
    s_waitcnt vmcnt(0)
    v_mfma_f32_32x32x16_bf16 v[56:71], v[212:215], v[180:183], v[56:71]
    s_lshl_b32 s84, s76, 5
    s_add_u32 s84, s84, s81
    s_lshl_b32 s83, s84, 13
    s_add_u32 s82, s83, 50331648
    buffer_load_dwordx4 v[72:75], v3, s[4:7], s82 offen offset:0 sc1
    buffer_load_dwordx4 v[76:79], v3, s[4:7], s82 offen offset:512 sc1
    buffer_load_dwordx4 v[80:83], v3, s[4:7], s82 offen offset:2048 sc1
    buffer_load_dwordx4 v[84:87], v3, s[4:7], s82 offen offset:2560 sc1
    s_add_u32 s82, s83, 50335744
    buffer_load_dwordx4 v[88:91], v3, s[4:7], s82 offen offset:0 sc1
    buffer_load_dwordx4 v[92:95], v3, s[4:7], s82 offen offset:512 sc1
    buffer_load_dwordx4 v[96:99], v3, s[4:7], s82 offen offset:2048 sc1
    buffer_load_dwordx4 v[100:103], v3, s[4:7], s82 offen offset:2560 sc1
    s_add_u32 s82, s83, 16777216
    buffer_load_dwordx4 v[104:107], v3, s[4:7], s82 offen offset:0 sc1
    buffer_load_dwordx4 v[108:111], v3, s[4:7], s82 offen offset:512 sc1
    buffer_load_dwordx4 v[112:115], v3, s[4:7], s82 offen offset:2048 sc1
    buffer_load_dwordx4 v[116:119], v3, s[4:7], s82 offen offset:2560 sc1
    s_add_u32 s82, s83, 16781312
    buffer_load_dwordx4 v[120:123], v3, s[4:7], s82 offen offset:0 sc1
    buffer_load_dwordx4 v[124:127], v3, s[4:7], s82 offen offset:512 sc1
    buffer_load_dwordx4 v[128:131], v3, s[4:7], s82 offen offset:2048 sc1
    buffer_load_dwordx4 v[132:135], v3, s[4:7], s82 offen offset:2560 sc1
    s_and_b32 s82, s16, 1
    s_lshl_b32 s82, s82, 12
    s_add_u32 s82, s82, s83
    s_add_u32 s82, s82, 33554432
    buffer_load_dwordx4 v[168:171], v3, s[4:7], s82 offen offset:0 sc1
    buffer_load_dwordx4 v[172:175], v3, s[4:7], s82 offen offset:512 sc1
    buffer_load_dwordx4 v[176:179], v3, s[4:7], s82 offen offset:2048 sc1
    buffer_load_dwordx4 v[180:183], v3, s[4:7], s82 offen offset:2560 sc1
    s_waitcnt vmcnt(11)
    v_mfma_f32_32x32x16_bf16 v[136:151], v[104:107], v[72:75], v[24:39]
    s_waitcnt vmcnt(10)
    v_mfma_f32_32x32x16_bf16 v[136:151], v[108:111], v[76:79], v[136:151]
    s_waitcnt vmcnt(9)
    v_mfma_f32_32x32x16_bf16 v[136:151], v[112:115], v[80:83], v[136:151]
    s_waitcnt vmcnt(8)
    v_mfma_f32_32x32x16_bf16 v[136:151], v[116:119], v[84:87], v[136:151]
    s_waitcnt vmcnt(7)
    v_mfma_f32_32x32x16_bf16 v[136:151], v[120:123], v[88:91], v[136:151]
    s_waitcnt vmcnt(6)
    v_mfma_f32_32x32x16_bf16 v[136:151], v[124:127], v[92:95], v[136:151]
    s_waitcnt vmcnt(5)
    v_mfma_f32_32x32x16_bf16 v[136:151], v[128:131], v[96:99], v[136:151]
    s_waitcnt vmcnt(4)
    v_mfma_f32_32x32x16_bf16 v[136:151], v[132:135], v[100:103], v[136:151]
    s_nop 11
    v_max3_f32 v13, v136, v137, v138
    v_max3_f32 v13, v13, v139, v140
    v_max3_f32 v13, v13, v141, v142
    v_max3_f32 v13, v13, v143, v144
    v_max3_f32 v13, v13, v145, v146
    v_max3_f32 v13, v13, v147, v148
    v_max3_f32 v13, v13, v149, v150
    v_max_f32 v13, v13, v151
    v_mov_b64 v[246:247], 0
    v_mov_b64 v[250:251], 0
    v_mov_b64 v[242:243], 0
    s_lshl_b32 s82, s84, 12
    s_add_u32 s82, s82, 4194304
    s_mov_b32 s85, 0
    s_mov_b64 exec, 1
L_tl_km0:
    buffer_load_dword v184, v2, s[4:7], s82 offen offset:3072 sc1
    s_add_u32 s85, s85, 1
    s_cmp_gt_u32 s85, 400000
    s_cbranch_scc1 L_tl_km0x
    s_waitcnt vmcnt(0)
    v_cmp_eq_u32 vcc, -1, v184
    s_cbranch_vccz L_tl_km0x
    s_sleep 2
    s_branch L_tl_km0
L_tl_km0x:
    s_mov_b64 exec, -1
L_tl_km:
    buffer_load_dwordx4 v[184:187], v2, s[4:7], s82 offen offset:0 sc1
    buffer_load_dwordx4 v[188:191], v2, s[4:7], s82 offen offset:1024 sc1
    buffer_load_dwordx4 v[192:195], v2, s[4:7], s82 offen offset:2048 sc1
    buffer_load_dwordx4 v[196:199], v2, s[4:7], s82 offen offset:3072 sc1
    s_add_u32 s85, s85, 1
    s_cmp_gt_u32 s85, 400000
    s_cbranch_scc1 L_tl_kmok
    s_waitcnt vmcnt(0)
    v_max3_u32 v14, v184, v185, v186
    v_max3_u32 v14, v14, v187, v188
    v_max3_u32 v14, v14, v189, v190
    v_max3_u32 v14, v14, v191, v192
    v_max3_u32 v14, v14, v193, v194
    v_max3_u32 v14, v14, v195, v196
    v_max3_u32 v14, v14, v197, v198
    v_max_u32 v14, v14, v199
    v_cmp_eq_u32 vcc, -1, v14
    s_cbranch_vccz L_tl_kmok
    s_sleep 4
    s_branch L_tl_km
L_tl_kmok:
    s_waitcnt vmcnt(0)
    ds_write2_b32 v5, v184, v185 offset0:0 offset1:64
    v_add_u32 v14, 1024, v5
    v_add_u32 v15, 2048, v5
    v_add_u32 v16, 3072, v5
    ds_write2_b32 v5, v188, v189 offset0:128 offset1:192
    ds_write2_b32 v14, v192, v193 offset0:0 offset1:64
    ds_write2_b32 v14, v196, v197 offset0:128 offset1:192
    ds_write2_b32 v15, v186, v187 offset0:0 offset1:64
    ds_write2_b32 v15, v190, v191 offset0:128 offset1:192
    ds_write2_b32 v16, v194, v195 offset0:0 offset1:64
    ds_write2_b32 v16, v198, v199 offset0:128 offset1:192
    ds_read_b64_tr_b16 v[104:105], v6 offset:0
    ds_read_b64_tr_b16 v[106:107], v6 offset:256
    ds_read_b64_tr_b16 v[108:109], v6 offset:128
    ds_read_b64_tr_b16 v[110:111], v6 offset:384
    ds_read_b64_tr_b16 v[112:113], v6 offset:512
    ds_read_b64_tr_b16 v[114:115], v6 offset:768
    ds_read_b64_tr_b16 v[116:117], v6 offset:640
    ds_read_b64_tr_b16 v[118:119], v6 offset:896
    ds_read_b64_tr_b16 v[120:121], v6 offset:1024
    ds_read_b64_tr_b16 v[122:123], v6 offset:1280
    ds_read_b64_tr_b16 v[124:125], v6 offset:1152
    ds_read_b64_tr_b16 v[126:127], v6 offset:1408
    ds_read_b64_tr_b16 v[128:129], v6 offset:1536
    ds_read_b64_tr_b16 v[130:131], v6 offset:1792
    ds_read_b64_tr_b16 v[132:133], v6 offset:1664
    ds_read_b64_tr_b16 v[134:135], v6 offset:1920
    ds_read_b64 v[244:245], v7 offset:0
    ds_read_b64 v[248:249], v7 offset:512
    s_waitcnt lgkmcnt(15)
    v_mfma_f32_32x32x16_bf16 v[152:167], v[104:107], v[72:75], 0
    s_waitcnt lgkmcnt(14)
    v_mfma_f32_32x32x16_bf16 v[152:167], v[108:111], v[76:79], v[152:167]
    s_waitcnt lgkmcnt(12)
    v_mfma_f32_32x32x16_bf16 v[152:167], v[112:115], v[80:83], v[152:167]
    s_waitcnt lgkmcnt(10)
    v_mfma_f32_32x32x16_bf16 v[152:167], v[116:119], v[84:87], v[152:167]
    s_waitcnt lgkmcnt(8)
    v_mfma_f32_32x32x16_bf16 v[152:167], v[120:123], v[88:91], v[152:167]
    s_waitcnt lgkmcnt(6)
    v_mfma_f32_32x32x16_bf16 v[152:167], v[124:127], v[92:95], v[152:167]
    s_waitcnt lgkmcnt(4)
    v_mfma_f32_32x32x16_bf16 v[152:167], v[128:131], v[96:99], v[152:167]
    s_waitcnt lgkmcnt(2)
    v_mfma_f32_32x32x16_bf16 v[152:167], v[132:135], v[100:103], v[152:167]
    s_nop 11
    v_max3_f32 v13, v13, v152, v153
    v_max3_f32 v13, v13, v154, v155
    v_mov_b32 v14, v13
    s_nop 1
    v_permlane32_swap_b32 v13, v14
    v_max_f32 v13, v13, v14
    v_mul_f32 v13, s86, v13
    v_fma_f32 v136, v136, s86, -v13
    v_fma_f32 v137, v137, s86, -v13
    v_fma_f32 v138, v138, s86, -v13
    v_fma_f32 v139, v139, s86, -v13
    v_fma_f32 v140, v140, s86, -v13
    v_fma_f32 v141, v141, s86, -v13
    v_fma_f32 v142, v142, s86, -v13
    v_fma_f32 v143, v143, s86, -v13
    v_fma_f32 v144, v144, s86, -v13
    v_fma_f32 v145, v145, s86, -v13
    v_fma_f32 v146, v146, s86, -v13
    v_fma_f32 v147, v147, s86, -v13
    v_fma_f32 v148, v148, s86, -v13
    v_fma_f32 v149, v149, s86, -v13
    v_fma_f32 v150, v150, s86, -v13
    v_fma_f32 v151, v151, s86, -v13
    v_fma_f32 v152, v152, s86, -v13
    v_fma_f32 v153, v153, s86, -v13
    v_fma_f32 v154, v154, s86, -v13
    v_fma_f32 v155, v155, s86, -v13
    v_exp_f32 v136, v136
    v_exp_f32 v137, v137
    v_exp_f32 v138, v138
    v_exp_f32 v139, v139
    v_exp_f32 v140, v140
    v_exp_f32 v141, v141
    v_exp_f32 v142, v142
    v_exp_f32 v143, v143
    v_exp_f32 v144, v144
    v_exp_f32 v145, v145
    v_exp_f32 v146, v146
    v_exp_f32 v147, v147
    v_exp_f32 v148, v148
    v_exp_f32 v149, v149
    v_exp_f32 v150, v150
    v_exp_f32 v151, v151
    v_exp_f32 v152, v152
    v_exp_f32 v153, v153
    v_exp_f32 v154, v154
    v_exp_f32 v155, v155
    v_cvt_pk_bf16_f32 v232, v136, v137
    v_cvt_pk_bf16_f32 v233, v138, v139
    v_cvt_pk_bf16_f32 v234, v144, v145
    v_cvt_pk_bf16_f32 v235, v146, v147
    v_cvt_pk_bf16_f32 v236, v140, v141
    v_cvt_pk_bf16_f32 v237, v142, v143
    v_cvt_pk_bf16_f32 v238, v148, v149
    v_cvt_pk_bf16_f32 v239, v150, v151
    v_cvt_pk_bf16_f32 v240, v152, v153
    v_cvt_pk_bf16_f32 v241, v154, v155
    s_waitcnt lgkmcnt(0)
    v_mfma_f32_32x32x16_bf16 v[200:215], v[168:171], v[232:235], 0
    v_mfma_f32_32x32x16_bf16 v[200:215], v[172:175], v[236:239], v[200:215]
    v_mfma_f32_32x32x16_bf16 v[200:215], v[244:247], v[240:243], v[200:215]
    v_mfma_f32_32x32x16_bf16 v[216:231], v[176:179], v[232:235], 0
    v_mfma_f32_32x32x16_bf16 v[216:231], v[180:183], v[236:239], v[216:231]
    v_mfma_f32_32x32x16_bf16 v[216:231], v[248:251], v[240:243], v[216:231]
    v_add_f32 v14, v136, v137
    v_add_f32 v14, v14, v138
    v_add_f32 v14, v14, v139
    v_add_f32 v14, v14, v140
    v_add_f32 v14, v14, v141
    v_add_f32 v14, v14, v142
    v_add_f32 v14, v14, v143
    v_add_f32 v14, v14, v144
    v_add_f32 v14, v14, v145
    v_add_f32 v14, v14, v146
    v_add_f32 v14, v14, v147
    v_add_f32 v14, v14, v148
    v_add_f32 v14, v14, v149
    v_add_f32 v14, v14, v150
    v_add_f32 v14, v14, v151
    v_add_f32 v14, v14, v152
    v_add_f32 v14, v14, v153
    v_add_f32 v14, v14, v154
    v_add_f32 v14, v14, v155
    v_mov_b32 v15, v14
    s_nop 1
    v_permlane32_swap_b32 v14, v15
    v_add_f32 v14, v14, v15
    v_rcp_f32 v14, v14
    s_and_b32 s82, s16, 1
    s_lshl_b32 s82, s82, 12
    s_add_u32 s82, s82, s83
    s_add_u32 s82, s82, 83886080
    v_mul_f32 v200, v200, v14
    v_mul_f32 v201, v201, v14
    v_mul_f32 v202, v202, v14
    v_mul_f32 v203, v203, v14
    v_mul_f32 v204, v204, v14
    v_mul_f32 v205, v205, v14
    v_mul_f32 v206, v206, v14
    v_mul_f32 v207, v207, v14
    v_mul_f32 v208, v208, v14
    v_mul_f32 v209, v209, v14
    v_mul_f32 v210, v210, v14
    v_mul_f32 v211, v211, v14
    v_mul_f32 v212, v212, v14
    v_mul_f32 v213, v213, v14
    v_mul_f32 v214, v214, v14
    v_mul_f32 v215, v215, v14
    v_cvt_pk_bf16_f32 v136, v200, v201
    v_cvt_pk_bf16_f32 v137, v202, v203
    v_cvt_pk_bf16_f32 v138, v208, v209
    v_cvt_pk_bf16_f32 v139, v210, v211
    buffer_store_dwordx4 v[136:139], v2, s[4:7], s82 offen offset:0
    v_cvt_pk_bf16_f32 v140, v204, v205
    v_cvt_pk_bf16_f32 v141, v206, v207
    v_cvt_pk_bf16_f32 v142, v212, v213
    v_cvt_pk_bf16_f32 v143, v214, v215
    buffer_store_dwordx4 v[140:143], v2, s[4:7], s82 offen offset:1024
    v_mul_f32 v216, v216, v14
    v_mul_f32 v217, v217, v14
    v_mul_f32 v218, v218, v14
    v_mul_f32 v219, v219, v14
    v_mul_f32 v220, v220, v14
    v_mul_f32 v221, v221, v14
    v_mul_f32 v222, v222, v14
    v_mul_f32 v223, v223, v14
    v_mul_f32 v224, v224, v14
    v_mul_f32 v225, v225, v14
    v_mul_f32 v226, v226, v14
    v_mul_f32 v227, v227, v14
    v_mul_f32 v228, v228, v14
    v_mul_f32 v229, v229, v14
    v_mul_f32 v230, v230, v14
    v_mul_f32 v231, v231, v14
    v_cvt_pk_bf16_f32 v144, v216, v217
    v_cvt_pk_bf16_f32 v145, v218, v219
    v_cvt_pk_bf16_f32 v146, v224, v225
    v_cvt_pk_bf16_f32 v147, v226, v227
    buffer_store_dwordx4 v[144:147], v2, s[4:7], s82 offen offset:2048
    v_cvt_pk_bf16_f32 v148, v220, v221
    v_cvt_pk_bf16_f32 v149, v222, v223
    v_cvt_pk_bf16_f32 v150, v228, v229
    v_cvt_pk_bf16_f32 v151, v230, v231
    buffer_store_dwordx4 v[148:151], v2, s[4:7], s82 offen offset:3072
    v_xor_b32 v15, 0, v8
    ds_write_b128 v15, v[56:59] offset:4096
    v_xor_b32 v15, 32, v8
    ds_write_b128 v15, v[60:63] offset:4096
    v_xor_b32 v15, 64, v8
    ds_write_b128 v15, v[64:67] offset:4096
    v_xor_b32 v15, 96, v8
    ds_write_b128 v15, v[68:71] offset:4096
    s_add_u32 s80, s80, 1
    s_lshl_b32 s82, s79, 7
    s_add_u32 s82, s82, 2883584
    s_lshl_b32 s83, s78, 2
    v_mov_b32 v13, s83
    v_mov_b32 v14, s80
    v_lshrrev_b32 v16, 2, v2
    s_waitcnt vmcnt(0)
    s_barrier
    s_cmp_lg_u32 s16, 0
    s_cbranch_scc1 L_tl_nost
    s_mov_b64 exec, 1
    buffer_store_dword v14, v13, s[4:7], s82 offen
L_tl_nost:
    s_mov_b64 exec, 0xffff
    s_mov_b32 s85, 0
L_tl_gw:
    buffer_load_dword v14, v16, s[4:7], s82 offen sc1
    s_add_u32 s85, s85, 1
    s_cmp_gt_u32 s85, 400000
    s_cbranch_scc1 L_tl_nosig
    s_waitcnt vmcnt(0)
    v_cmp_gt_u32 vcc, s80, v14
    s_cbranch_vccnz L_tl_gw
L_tl_nosig:
    s_waitcnt vmcnt(0)
    s_mov_b64 exec, -1
    s_lshl_b32 s82, s76, 18
    s_lshl_b32 s83, s16, 16
    s_add_u32 s82, s82, s83
    s_add_u32 s82, s82, 83886080
    buffer_load_dwordx4 v[72:75], v2, s[4:7], s82 offen offset:0 sc1
    buffer_load_dwordx4 v[76:79], v2, s[4:7], s82 offen offset:1024 sc1
    buffer_load_dwordx4 v[80:83], v2, s[4:7], s82 offen offset:2048 sc1
    buffer_load_dwordx4 v[84:87], v2, s[4:7], s82 offen offset:3072 sc1
    s_add_u32 s82, s82, 4096
    buffer_load_dwordx4 v[88:91], v2, s[4:7], s82 offen offset:0 sc1
    buffer_load_dwordx4 v[92:95], v2, s[4:7], s82 offen offset:1024 sc1
    buffer_load_dwordx4 v[96:99], v2, s[4:7], s82 offen offset:2048 sc1
    buffer_load_dwordx4 v[100:103], v2, s[4:7], s82 offen offset:3072 sc1
    s_add_u32 s82, s82, 4096
    buffer_load_dwordx4 v[104:107], v2, s[4:7], s82 offen offset:0 sc1
    buffer_load_dwordx4 v[108:111], v2, s[4:7], s82 offen offset:1024 sc1
    buffer_load_dwordx4 v[112:115], v2, s[4:7], s82 offen offset:2048 sc1
    buffer_load_dwordx4 v[116:119], v2, s[4:7], s82 offen offset:3072 sc1
    s_add_u32 s82, s82, 4096
    buffer_load_dwordx4 v[120:123], v2, s[4:7], s82 offen offset:0 sc1
    buffer_load_dwordx4 v[124:127], v2, s[4:7], s82 offen offset:1024 sc1
    buffer_load_dwordx4 v[128:131], v2, s[4:7], s82 offen offset:2048 sc1
    buffer_load_dwordx4 v[132:135], v2, s[4:7], s82 offen offset:3072 sc1
    s_add_u32 s82, s82, 4096
    buffer_load_dwordx4 v[136:139], v2, s[4:7], s82 offen offset:0 sc1
    buffer_load_dwordx4 v[140:143], v2, s[4:7], s82 offen offset:1024 sc1
    buffer_load_dwordx4 v[144:147], v2, s[4:7], s82 offen offset:2048 sc1
    buffer_load_dwordx4 v[148:151], v2, s[4:7], s82 offen offset:3072 sc1
    s_add_u32 s82, s82, 4096
    buffer_load_dwordx4 v[152:155], v2, s[4:7], s82 offen offset:0 sc1
    buffer_load_dwordx4 v[156:159], v2, s[4:7], s82 offen offset:1024 sc1
    buffer_load_dwordx4 v[160:163], v2, s[4:7], s82 offen offset:2048 sc1
    buffer_load_dwordx4 v[164:167], v2, s[4:7], s82 offen offset:3072 sc1
    s_add_u32 s82, s82, 4096
    buffer_load_dwordx4 v[168:171], v2, s[4:7], s82 offen offset:0 sc1
    buffer_load_dwordx4 v[172:175], v2, s[4:7], s82 offen offset:1024 sc1
    buffer_load_dwordx4 v[176:179], v2, s[4:7], s82 offen offset:2048 sc1
    buffer_load_dwordx4 v[180:183], v2, s[4:7], s82 offen offset:3072 sc1
    s_add_u32 s82, s82, 4096
    buffer_load_dwordx4 v[184:187], v2, s[4:7], s82 offen offset:0 sc1
    buffer_load_dwordx4 v[188:191], v2, s[4:7], s82 offen offset:1024 sc1
    buffer_load_dwordx4 v[192:195], v2, s[4:7], s82 offen offset:2048 sc1
    buffer_load_dwordx4 v[196:199], v2, s[4:7], s82 offen offset:3072 sc1
    s_waitcnt vmcnt(31)
    v_mfma_f32_32x32x16_bf16 v[40:55], a[0:3], v[72:75], 0
    s_waitcnt vmcnt(30)
    v_mfma_f32_32x32x16_bf16 v[40:55], a[4:7], v[76:79], v[40:55]
    s_add_u32 s82, s82, 4096
    buffer_load_dwordx4 v[72:75], v2, s[4:7], s82 offen offset:0 sc1
    s_waitcnt vmcnt(30)
    v_mfma_f32_32x32x16_bf16 v[40:55], a[8:11], v[80:83], v[40:55]
    buffer_load_dwordx4 v[76:79], v2, s[4:7], s82 offen offset:1024 sc1
    s_waitcnt vmcnt(30)
    v_mfma_f32_32x32x16_bf16 v[40:55], a[12:15], v[84:87], v[40:55]
    buffer_load_dwordx4 v[80:83], v2, s[4:7], s82 offen offset:2048 sc1
    s_waitcnt vmcnt(30)
    v_mfma_f32_32x32x16_bf16 v[40:55], a[16:19], v[88:91], v[40:55]
    buffer_load_dwordx4 v[84:87], v2, s[4:7], s82 offen offset:3072 sc1
    s_waitcnt vmcnt(30)
    v_mfma_f32_32x32x16_bf16 v[40:55], a[20:23], v[92:95], v[40:55]
    s_add_u32 s82, s82, 4096
    buffer_load_dwordx4 v[88:91], v2, s[4:7], s82 offen offset:0 sc1
    s_waitcnt vmcnt(30)
    v_mfma_f32_32x32x16_bf16 v[40:55], a[24:27], v[96:99], v[40:55]
    buffer_load_dwordx4 v[92:95], v2, s[4:7], s82 offen offset:1024 sc1
    s_waitcnt vmcnt(30)
    v_mfma_f32_32x32x16_bf16 v[40:55], a[28:31], v[100:103], v[40:55]
    buffer_load_dwordx4 v[96:99], v2, s[4:7], s82 offen offset:2048 sc1
    s_waitcnt vmcnt(30)
    v_mfma_f32_32x32x16_bf16 v[40:55], a[32:35], v[104:107], v[40:55]
    buffer_load_dwordx4 v[100:103], v2, s[4:7], s82 offen offset:3072 sc1
    s_waitcnt vmcnt(30)
    v_mfma_f32_32x32x16_bf16 v[40:55], a[36:39], v[108:111], v[40:55]
    s_add_u32 s82, s82, 4096
    buffer_load_dwordx4 v[104:107], v2, s[4:7], s82 offen offset:0 sc1
    s_waitcnt vmcnt(30)
    v_mfma_f32_32x32x16_bf16 v[40:55], a[40:43], v[112:115], v[40:55]
    buffer_load_dwordx4 v[108:111], v2, s[4:7], s82 offen offset:1024 sc1
    s_waitcnt vmcnt(30)
    v_mfma_f32_32x32x16_bf16 v[40:55], a[44:47], v[116:119], v[40:55]
    buffer_load_dwordx4 v[112:115], v2, s[4:7], s82 offen offset:2048 sc1
    s_waitcnt vmcnt(30)
    v_mfma_f32_32x32x16_bf16 v[40:55], a[48:51], v[120:123], v[40:55]
    buffer_load_dwordx4 v[116:119], v2, s[4:7], s82 offen offset:3072 sc1
    s_waitcnt vmcnt(30)
    v_mfma_f32_32x32x16_bf16 v[40:55], a[52:55], v[124:127], v[40:55]
    s_add_u32 s82, s82, 4096
    buffer_load_dwordx4 v[120:123], v2, s[4:7], s82 offen offset:0 sc1
    s_waitcnt vmcnt(30)
    v_mfma_f32_32x32x16_bf16 v[40:55], a[56:59], v[128:131], v[40:55]
    buffer_load_dwordx4 v[124:127], v2, s[4:7], s82 offen offset:1024 sc1
    s_waitcnt vmcnt(30)
    v_mfma_f32_32x32x16_bf16 v[40:55], a[60:63], v[132:135], v[40:55]
    buffer_load_dwordx4 v[128:131], v2, s[4:7], s82 offen offset:2048 sc1
    s_waitcnt vmcnt(30)
    v_mfma_f32_32x32x16_bf16 v[40:55], a[64:67], v[136:139], v[40:55]
    buffer_load_dwordx4 v[132:135], v2, s[4:7], s82 offen offset:3072 sc1
    s_waitcnt vmcnt(30)
    v_mfma_f32_32x32x16_bf16 v[40:55], a[68:71], v[140:143], v[40:55]
    s_add_u32 s82, s82, 4096
    buffer_load_dwordx4 v[136:139], v2, s[4:7], s82 offen offset:0 sc1
    s_waitcnt vmcnt(30)
    v_mfma_f32_32x32x16_bf16 v[40:55], a[72:75], v[144:147], v[40:55]
    buffer_load_dwordx4 v[140:143], v2, s[4:7], s82 offen offset:1024 sc1
    s_waitcnt vmcnt(30)
    v_mfma_f32_32x32x16_bf16 v[40:55], a[76:79], v[148:151], v[40:55]
    buffer_load_dwordx4 v[144:147], v2, s[4:7], s82 offen offset:2048 sc1
    s_waitcnt vmcnt(30)
    v_mfma_f32_32x32x16_bf16 v[40:55], a[80:83], v[152:155], v[40:55]
    buffer_load_dwordx4 v[148:151], v2, s[4:7], s82 offen offset:3072 sc1
    s_waitcnt vmcnt(30)
    v_mfma_f32_32x32x16_bf16 v[40:55], a[84:87], v[156:159], v[40:55]
    s_add_u32 s82, s82, 4096
    buffer_load_dwordx4 v[152:155], v2, s[4:7], s82 offen offset:0 sc1
    s_waitcnt vmcnt(30)
    v_mfma_f32_32x32x16_bf16 v[40:55], a[88:91], v[160:163], v[40:55]
    buffer_load_dwordx4 v[156:159], v2, s[4:7], s82 offen offset:1024 sc1
    s_waitcnt vmcnt(30)
    v_mfma_f32_32x32x16_bf16 v[40:55], a[92:95], v[164:167], v[40:55]
    buffer_load_dwordx4 v[160:163], v2, s[4:7], s82 offen offset:2048 sc1
    s_waitcnt vmcnt(30)
    v_mfma_f32_32x32x16_bf16 v[40:55], a[96:99], v[168:171], v[40:55]
    buffer_load_dwordx4 v[164:167], v2, s[4:7], s82 offen offset:3072 sc1
    s_waitcnt vmcnt(30)
    v_mfma_f32_32x32x16_bf16 v[40:55], a[100:103], v[172:175], v[40:55]
    s_add_u32 s82, s82, 4096
    buffer_load_dwordx4 v[168:171], v2, s[4:7], s82 offen offset:0 sc1
    s_waitcnt vmcnt(30)
    v_mfma_f32_32x32x16_bf16 v[40:55], a[104:107], v[176:179], v[40:55]
    buffer_load_dwordx4 v[172:175], v2, s[4:7], s82 offen offset:1024 sc1
    s_waitcnt vmcnt(30)
    v_mfma_f32_32x32x16_bf16 v[40:55], a[108:111], v[180:183], v[40:55]
    buffer_load_dwordx4 v[176:179], v2, s[4:7], s82 offen offset:2048 sc1
    s_waitcnt vmcnt(30)
    v_mfma_f32_32x32x16_bf16 v[40:55], a[112:115], v[184:187], v[40:55]
    buffer_load_dwordx4 v[180:183], v2, s[4:7], s82 offen offset:3072 sc1
    s_waitcnt vmcnt(30)
    v_mfma_f32_32x32x16_bf16 v[40:55], a[116:119], v[188:191], v[40:55]
    s_add_u32 s82, s82, 4096
    buffer_load_dwordx4 v[184:187], v2, s[4:7], s82 offen offset:0 sc1
    s_waitcnt vmcnt(30)
    v_mfma_f32_32x32x16_bf16 v[40:55], a[120:123], v[192:195], v[40:55]
    buffer_load_dwordx4 v[188:191], v2, s[4:7], s82 offen offset:1024 sc1
    s_waitcnt vmcnt(30)
    v_mfma_f32_32x32x16_bf16 v[40:55], a[124:127], v[196:199], v[40:55]
    buffer_load_dwordx4 v[192:195], v2, s[4:7], s82 offen offset:2048 sc1
    s_waitcnt vmcnt(30)
    v_mfma_f32_32x32x16_bf16 v[40:55], a[128:131], v[72:75], v[40:55]
    buffer_load_dwordx4 v[196:199], v2, s[4:7], s82 offen offset:3072 sc1
    s_waitcnt vmcnt(30)
    v_mfma_f32_32x32x16_bf16 v[40:55], a[132:135], v[76:79], v[40:55]
    s_waitcnt vmcnt(29)
    v_mfma_f32_32x32x16_bf16 v[40:55], a[136:139], v[80:83], v[40:55]
    s_waitcnt vmcnt(28)
    v_mfma_f32_32x32x16_bf16 v[40:55], a[140:143], v[84:87], v[40:55]
    s_waitcnt vmcnt(27)
    v_mfma_f32_32x32x16_bf16 v[40:55], a[144:147], v[88:91], v[40:55]
    s_waitcnt vmcnt(26)
    v_mfma_f32_32x32x16_bf16 v[40:55], a[148:151], v[92:95], v[40:55]
    s_waitcnt vmcnt(25)
    v_mfma_f32_32x32x16_bf16 v[40:55], a[152:155], v[96:99], v[40:55]
    s_waitcnt vmcnt(24)
    v_mfma_f32_32x32x16_bf16 v[40:55], a[156:159], v[100:103], v[40:55]
    s_waitcnt vmcnt(23)
    v_mfma_f32_32x32x16_bf16 v[40:55], a[160:163], v[104:107], v[40:55]
    s_waitcnt vmcnt(22)
    v_mfma_f32_32x32x16_bf16 v[40:55], a[164:167], v[108:111], v[40:55]
    s_waitcnt vmcnt(21)
    v_mfma_f32_32x32x16_bf16 v[40:55], a[168:171], v[112:115], v[40:55]
    s_waitcnt vmcnt(20)
    v_mfma_f32_32x32x16_bf16 v[40:55], a[172:175], v[116:119], v[40:55]
    s_waitcnt vmcnt(19)
    v_mfma_f32_32x32x16_bf16 v[40:55], a[176:179], v[120:123], v[40:55]
    s_waitcnt vmcnt(18)
    v_mfma_f32_32x32x16_bf16 v[40:55], a[180:183], v[124:127], v[40:55]
    s_waitcnt vmcnt(17)
    v_mfma_f32_32x32x16_bf16 v[40:55], a[184:187], v[128:131], v[40:55]
    s_waitcnt vmcnt(16)
    v_mfma_f32_32x32x16_bf16 v[40:55], a[188:191], v[132:135], v[40:55]
    s_waitcnt vmcnt(15)
    v_mfma_f32_32x32x16_bf16 v[40:55], a[192:195], v[136:139], v[40:55]
    s_waitcnt vmcnt(14)
    v_mfma_f32_32x32x16_bf16 v[40:55], a[196:199], v[140:143], v[40:55]
    s_waitcnt vmcnt(13)
    v_mfma_f32_32x32x16_bf16 v[40:55], a[200:203], v[144:147], v[40:55]
    s_waitcnt vmcnt(12)
    v_mfma_f32_32x32x16_bf16 v[40:55], a[204:207], v[148:151], v[40:55]
    s_waitcnt vmcnt(11)
    v_mfma_f32_32x32x16_bf16 v[40:55], a[208:211], v[152:155], v[40:55]
    s_waitcnt vmcnt(10)
    v_mfma_f32_32x32x16_bf16 v[40:55], a[212:215], v[156:159], v[40:55]
    s_waitcnt vmcnt(9)
    v_mfma_f32_32x32x16_bf16 v[40:55], a[216:219], v[160:163], v[40:55]
    s_waitcnt vmcnt(8)
    v_mfma_f32_32x32x16_bf16 v[40:55], a[220:223], v[164:167], v[40:55]
    s_waitcnt vmcnt(7)
    v_mfma_f32_32x32x16_bf16 v[40:55], a[224:227], v[168:171], v[40:55]
    s_waitcnt vmcnt(6)
    v_mfma_f32_32x32x16_bf16 v[40:55], a[228:231], v[172:175], v[40:55]
    s_waitcnt vmcnt(5)
    v_mfma_f32_32x32x16_bf16 v[40:55], a[232:235], v[176:179], v[40:55]
    s_waitcnt vmcnt(4)
    v_mfma_f32_32x32x16_bf16 v[40:55], a[236:239], v[180:183], v[40:55]
    s_waitcnt vmcnt(3)
    v_mfma_f32_32x32x16_bf16 v[40:55], a[240:243], v[184:187], v[40:55]
    s_waitcnt vmcnt(2)
    v_mfma_f32_32x32x16_bf16 v[40:55], a[244:247], v[188:191], v[40:55]
    s_waitcnt vmcnt(1)
    v_mfma_f32_32x32x16_bf16 v[40:55], a[248:251], v[192:195], v[40:55]
    s_waitcnt vmcnt(0)
    v_mfma_f32_32x32x16_bf16 v[40:55], a[252:255], v[196:199], v[40:55]
    v_xor_b32 v15, 0, v8
    s_nop 10
    ds_write_b128 v15, v[40:43] offset:0
    v_xor_b32 v15, 32, v8
    ds_write_b128 v15, v[44:47] offset:0
    v_xor_b32 v15, 64, v8
    ds_write_b128 v15, v[48:51] offset:0
    v_xor_b32 v15, 96, v8
    ds_write_b128 v15, v[52:55] offset:0
    s_waitcnt lgkmcnt(0)
    s_barrier
    ds_read_b128 v[72:75], v9 offset:0
    ds_read_b128 v[88:91], v9 offset:4096
    ds_read_b128 v[76:79], v9 offset:8192
    ds_read_b128 v[92:95], v9 offset:12288
    ds_read_b128 v[80:83], v9 offset:16384
    ds_read_b128 v[96:99], v9 offset:20480
    ds_read_b128 v[84:87], v9 offset:24576
    ds_read_b128 v[100:103], v9 offset:28672
    s_waitcnt lgkmcnt(0)
    s_barrier
    v_add_f32 v72, v72, v76
    v_add_f32 v80, v80, v84
    v_add_f32 v72, v72, v80
    v_add_f32 v73, v73, v77
    v_add_f32 v81, v81, v85
    v_add_f32 v73, v73, v81
    v_add_f32 v74, v74, v78
    v_add_f32 v82, v82, v86
    v_add_f32 v74, v74, v82
    v_add_f32 v75, v75, v79
    v_add_f32 v83, v83, v87
    v_add_f32 v75, v75, v83
    v_add_f32 v88, v88, v92
    v_add_f32 v96, v96, v100
    v_add_f32 v88, v88, v96
    v_add_f32 v89, v89, v93
    v_add_f32 v97, v97, v101
    v_add_f32 v89, v89, v97
    v_add_f32 v90, v90, v94
    v_add_f32 v98, v98, v102
    v_add_f32 v90, v90, v98
    v_add_f32 v91, v91, v95
    v_add_f32 v99, v99, v103
    v_add_f32 v91, v91, v99
    v_cvt_pk_bf16_f32 v13, v72, v73
    v_lshlrev_b32 v72, 16, v13
    v_and_b32 v73, 0xffff0000, v13
    v_cvt_pk_bf16_f32 v13, v74, v75
    v_lshlrev_b32 v74, 16, v13
    v_and_b32 v75, 0xffff0000, v13
    v_cvt_pk_bf16_f32 v13, v88, v89
    v_lshlrev_b32 v88, 16, v13
    v_and_b32 v89, 0xffff0000, v13
    v_cvt_pk_bf16_f32 v13, v90, v91
    v_lshlrev_b32 v90, 16, v13
    v_and_b32 v91, 0xffff0000, v13
    v_add_f32 v88, v88, v18
    v_add_f32 v89, v89, v19
    v_add_f32 v90, v90, v20
    v_add_f32 v91, v91, v21
    v_cvt_pk_bf16_f32 v13, v88, v89
    v_lshlrev_b32 v88, 16, v13
    v_and_b32 v89, 0xffff0000, v13
    v_cvt_pk_bf16_f32 v13, v90, v91
    v_lshlrev_b32 v90, 16, v13
    v_and_b32 v91, 0xffff0000, v13
    v_sub_f32 v14, 1.0, v12
    v_cvt_pk_bf16_f32 v14, v14, v14
    v_lshlrev_b32 v14, 16, v14
    v_mul_f32 v72, v72, v12
    v_mul_f32 v88, v88, v14
    v_mul_f32 v73, v73, v12
    v_mul_f32 v89, v89, v14
    v_mul_f32 v74, v74, v12
    v_mul_f32 v90, v90, v14
    v_mul_f32 v75, v75, v12
    v_mul_f32 v91, v91, v14
    v_cvt_pk_bf16_f32 v13, v72, v73
    v_lshlrev_b32 v72, 16, v13
    v_and_b32 v73, 0xffff0000, v13
    v_cvt_pk_bf16_f32 v13, v74, v75
    v_lshlrev_b32 v74, 16, v13
    v_and_b32 v75, 0xffff0000, v13
    v_cvt_pk_bf16_f32 v13, v88, v89
    v_lshlrev_b32 v88, 16, v13
    v_and_b32 v89, 0xffff0000, v13
    v_cvt_pk_bf16_f32 v13, v90, v91
    v_lshlrev_b32 v90, 16, v13
    v_and_b32 v91, 0xffff0000, v13
    v_add_f32 v72, v72, v88
    v_add_f32 v73, v73, v89
    v_add_f32 v74, v74, v90
    v_add_f32 v75, v75, v91
    v_cvt_pk_bf16_f32 v72, v72, v73
    v_cvt_pk_bf16_f32 v73, v74, v75
    s_lshl_b32 s82, s76, 15
    s_lshl_b32 s83, s78, 6
    s_add_u32 s82, s82, s83
    buffer_store_dwordx2 v[72:73], v11, s[72:75], s82 offen
    s_add_u32 s76, s76, s77
    s_cmp_lt_u32 s76, 64
    s_cbranch_scc1 L_tl_seg
    s_waitcnt vmcnt(0)
L_end:
    s_endpgm
.section .rodata,"a"
.p2align 6
.amdhsa_kernel gated_mix__memory_aug_recurrent_mem_tr__dense_activation_squared_relu__prompt_kernel
  .amdhsa_next_free_vgpr 512
  .amdhsa_next_free_sgpr 102
  .amdhsa_accum_offset 256
  .amdhsa_group_segment_fixed_size 0
  .amdhsa_kernarg_size 128
  .amdhsa_user_sgpr_count 2
  .amdhsa_user_sgpr_kernarg_segment_ptr 1
  .amdhsa_system_sgpr_workgroup_id_x 1
  .amdhsa_float_denorm_mode_32 3
.end_amdhsa_kernel
```
